```python
import torch

def _softmax(x, axis=-1):
    return torch.softmax(x, dim=axis)
def _gelu(x):
    return torch.nn.functional.gelu(x, approximate="tanh")
def _silu(x):
    return torch.nn.functional.silu(x)
def _sigmoid(x):
    return torch.sigmoid(x)
def _layernorm(x, axis=-1, eps=1e-5):
    m = x.mean(dim=axis, keepdim=True)
    v = x.var(dim=axis, keepdim=True, unbiased=False)
    return (x - m) / torch.sqrt(v + eps)
def _scatter_add(tgt, idx, src, axis=0):
    return tgt.clone().index_add_(axis, idx, src)
def _segment_sum(src, seg, n):
    out = torch.zeros((n,) + src.shape[1:], dtype=src.dtype)
    return out.index_add_(0, seg, src)
def _pad(x, pw):
    flat = tuple(v for pair in reversed(pw) for v in pair)
    return torch.nn.functional.pad(x, flat)

kernel_name = 'interleave_layers__linear_attn_block__mixer_s_mlp__prompt'

def setup_inputs():

    _w = (lambda a: (lambda t: t.to(torch.bfloat16) if t.is_floating_point() else t)(torch.as_tensor(a)))
    def _A_setup():
        B, S, D = 1, 2048, 512
        return {
            "x": _w((lambda *s: torch.randn(*s, dtype=torch.bfloat16) * 0.05)(B, S, D)),
            "wqkv": _w((lambda *s: torch.randn(*s, dtype=torch.bfloat16) * 0.1)(D, 3 * D)),
            "wo": _w((lambda *s: torch.randn(*s, dtype=torch.bfloat16) * 0.1)(D, D)),
        }
    _A_in = _A_setup()

    def _B_setup():
        B, S, D, F = 1, 2048, 512, 1792
        return {
            "x":  _w((lambda *s: torch.randn(*s, dtype=torch.bfloat16) * 0.05)(B, S, D)),
            "w1": _w((lambda *s: torch.randn(*s, dtype=torch.bfloat16) * 3.2)(D, D) * (D ** -0.5)),
            "w2": _w((lambda *s: torch.randn(*s, dtype=torch.bfloat16) * 3.2)(D, D) * (D ** -0.5)),
            "w3": _w((lambda *s: torch.randn(*s, dtype=torch.bfloat16) * 3.2)(D, F) * (D ** -0.5)),
            "w4": _w((lambda *s: torch.randn(*s, dtype=torch.bfloat16) * 3.2)(F, D) * (F ** -0.5)),
        }
    _B_in = _B_setup()

    return {
        "A_x": _A_in["x"],
        "A_wqkv": _A_in["wqkv"],
        "A_wo": _A_in["wo"],
        "B_x": _B_in["x"],
        "B_w1": _B_in["w1"],
        "B_w2": _B_in["w2"],
        "B_w3": _B_in["w3"],
        "B_w4": _B_in["w4"],
    }

def reference(A_x, A_wqkv, A_wo, B_x, B_w1, B_w2, B_w3, B_w4):
    def _A_ref(x, wqkv, wo):
        B, S, D = x.shape
        H = 32; Dh = D // H
        qkv = (lambda x, *d: x.permute(*d))((x @ wqkv).reshape(B, S, 3, H, Dh), 2, 0, 3, 1, 4)
        q, k, v = qkv[0], qkv[1], qkv[2]
        phi = lambda t: torch.where(t > 0, t + 1, torch.exp(t)) + 1e-6
        pq, pk = phi(q), phi(k)
        kv = torch.einsum("bhsd,bhse->bhde", pk, v)
        z = torch.einsum("bhsd->bhd", pk)
        num = torch.einsum("bhqd,bhde->bhqe", pq, kv)
        den = torch.einsum("bhqd,bhd->bhq", pq, z)[..., None] + 1e-6
        o = num / den
        return (lambda x, *d: x.permute(*d))(o, 0, 2, 1, 3).reshape(B, S, D) @ wo

    def _B_ref(x, w1, w2, w3, w4):
        B, S, D = x.shape
        h = _gelu(_layernorm(x, axis=-1) @ w1)
        c = D // 4
        g0 = _pad(h[:, :, 0*c:1*c], ((0, 0), (1, 0), (0, 0)))[:, :S, :]
        g1 = _pad(h[:, :, 1*c:2*c], ((0, 0), (0, 1), (0, 0)))[:, 1:, :]
        g2 = _pad(h[:, :, 2*c:3*c], ((0, 0), (2, 0), (0, 0)))[:, :S, :]
        g3 = _pad(h[:, :, 3*c:   ], ((0, 0), (0, 2), (0, 0)))[:, 2:, :]
        hs = torch.concatenate([g0, g1, g2, g3], axis=-1) @ w2
        x1 = x + hs
        h2 = _gelu(_layernorm(x1, axis=-1) @ w3) @ w4
        return x1 + h2

    x = A_x
    x = x + _A_ref(_layernorm(x, axis=-1), A_wqkv, A_wo)
    x = x + _B_ref(_layernorm(x, axis=-1), B_w1, B_w2, B_w3, B_w4)
    x = x + _A_ref(_layernorm(x, axis=-1), A_wqkv, A_wo)
    x = x + _B_ref(_layernorm(x, axis=-1), B_w1, B_w2, B_w3, B_w4)
    return x
```

```asm
; @launch grid=(256,1,1) block=(512,1,1) lds=163840
.amdgcn_target "amdgcn-amd-amdhsa--gfx950"
.text
.globl interleave_layers__linear_attn_block__mixer_s_mlp__prompt_kernel
.p2align 8
.type interleave_layers__linear_attn_block__mixer_s_mlp__prompt_kernel,@function
interleave_layers__linear_attn_block__mixer_s_mlp__prompt_kernel:
  s_cmp_ge_u32 s2, 256
  s_cbranch_scc1 L_EXIT
  s_load_dwordx16 s[64:79], s[0:1], 0
  s_load_dwordx4 s[80:83], s[0:1], 64
  s_load_dwordx2 s[84:85], s[0:1], 80
  v_lshrrev_b32 v1, 6, v0
  s_nop 0
  s_getpc_b64 s[34:35]
L_PC:
  s_sub_u32 s34, s34, (L_PC - interleave_layers__linear_attn_block__mixer_s_mlp__prompt_kernel)
  s_subb_u32 s35, s35, 0
  s_lshr_b32 s36, s2, 3
  s_mul_i32 s36, s36, 2560
  v_lshlrev_b32 v2, 7, v0
  v_add_u32 v2, s36, v2
  s_mov_b32 s36, (L_CODE_END - interleave_layers__linear_attn_block__mixer_s_mlp__prompt_kernel - 4)
  v_min_u32 v2, s36, v2
  v_and_b32 v2, -4, v2
  v_cmp_gt_u32 vcc, 20, v0
  s_and_saveexec_b64 s[36:37], vcc
  s_cbranch_execz L_NOPF
  global_load_dword v255, v2, s[34:35]
L_NOPF:
  s_mov_b64 exec, s[36:37]
  v_readfirstlane_b32 s22, v1
  v_and_b32 v0, 63, v0
  s_getreg_b32 s32, hwreg(HW_REG_XCC_ID)
  s_and_b32 s32, s32, 7
  s_and_b32 s20, s2, 7
  s_lshr_b32 s21, s2, 3
  s_lshr_b32 s23, s21, 3
  s_and_b32 s24, s21, 7
  s_lshr_b32 s25, s21, 4
  s_and_b32 s26, s21, 15
  s_waitcnt lgkmcnt(0)
  s_add_u32 s34, s84, 0xf07800
  s_addc_u32 s35, s85, 0
  s_load_dword s3, s[34:35], 0
  s_mov_b32 s4, s84
  s_mov_b32 s5, s85
  s_mov_b32 s6, 0xf30000
  s_mov_b32 s7, 0x20000
  s_mov_b32 s8, s64
  s_mov_b32 s9, s65
  s_mov_b32 s10, 0x200000
  s_mov_b32 s11, 0x20000
  s_mov_b32 s12, s80
  s_mov_b32 s13, s81
  s_mov_b32 s14, 0x200000
  s_mov_b32 s15, 0x20000
  s_cmp_lt_u32 s22, 4
  s_cbranch_scc1 L_COMPUTE
  s_cmp_eq_u32 s22, 6
  s_cbranch_scc0 L_NOTP6
  s_getpc_b64 s[34:35]
L_PCP6:
  s_add_u32 s34, s34, (L_PARKER6 - L_PCP6)
  s_addc_u32 s35, s35, 0
  s_setpc_b64 s[34:35]
L_NOTP6:
  s_cmp_eq_u32 s22, 7
  s_cbranch_scc0 L_NOTP7
  s_getpc_b64 s[34:35]
L_PCP7:
  s_add_u32 s34, s34, (L_PARKER7 - L_PCP7)
  s_addc_u32 s35, s35, 0
  s_setpc_b64 s[34:35]
L_NOTP7:
  s_cmp_eq_u32 s22, 5
  s_cbranch_scc0 L_GOLOADER
  s_getpc_b64 s[34:35]
L_PC3:
  s_add_u32 s34, s34, (L_TOUCHER - L_PC3)
  s_addc_u32 s35, s35, 0
  s_setpc_b64 s[34:35]
L_GOLOADER:
  s_getpc_b64 s[34:35]
L_PC2:
  s_add_u32 s34, s34, (L_LOADER - L_PC2)
  s_addc_u32 s35, s35, 0
  s_setpc_b64 s[34:35]
L_EXIT:
  s_endpgm
L_COMPUTE:
  s_lshr_b32 s53, s22, 1
  s_and_b32 s54, s22, 1
  s_lshl_b32 s52, s22, 12
  s_lshl_b32 s55, s20, 4
  s_lshl_b32 s34, s23, 2
  s_add_u32 s55, s55, s34
  s_lshl_b32 s34, s53, 1
  s_add_u32 s57, s55, s34
  s_add_u32 s55, s55, s22
  s_lshl_b32 s56, s20, 4
  s_lshl_b32 s35, s25, 3
  s_add_u32 s56, s56, s35
  s_lshl_b32 s35, s22, 1
  s_add_u32 s56, s56, s35
  v_and_b32 v25, 15, v0
  v_and_b32 v26, 0x30, v0
  s_lshl_b32 s45, s25, 1
  s_add_u32 s45, s45, s26
  s_and_b32 s45, s45, 3
  v_and_b32 v27, 31, v0
  v_lshrrev_b32 v28, 5, v0
  v_lshlrev_b32 v12, 10, v27
  v_lshl_add_u32 v12, v28, 3, v12
  s_lshl_b32 s35, s57, 14
  s_lshl_b32 s36, s24, 7
  s_add_u32 s35, s35, s36
  s_lshl_b32 s36, s54, 6
  s_add_u32 s35, s35, s36
  v_add_u32 v12, s35, v12
  s_waitcnt lgkmcnt(0)
  s_mul_i32 s31, s3, 0x9e3779b1
  s_add_u32 s31, s31, 0x7f4a7c15
  s_and_b32 s31, s31, 0xffffff00
  v_lshlrev_b32 v50, 4, v0
  s_lshl_b32 s35, s56, 14
  v_add_u32 v2, s35, v50
  v_lshlrev_b32 v9, 4, v27
  v_lshl_add_u32 v9, v28, 11, v9
  s_lshl_b32 s35, s57, 11
  v_add_u32 v9, s35, v9
  v_lshlrev_b32 v11, 4, v27
  s_lshl_b32 s37, s24, 9
  s_add_u32 s35, s35, s37
  s_lshl_b32 s37, s54, 3
  s_add_u32 s35, s35, s37
  v_add_u32 v11, s35, v11
  s_lshl_b32 s36, s24, 1
  s_add_u32 s36, s36, s54
  v_lshlrev_b32 v10, 4, v25
  v_lshl_add_u32 v10, v26, 6, v10
  s_lshl_b32 s35, s56, 11
  v_add_u32 v10, s35, v10
  v_lshrrev_b32 v13, 4, v27
  v_lshlrev_b32 v13, 14, v13
  v_lshl_add_u32 v13, v28, 8, v13
  v_lshl_add_u32 v13, v25, 4, v13
  s_lshl_b32 s35, s57, 14
  s_lshl_b32 s37, s36, 10
  s_add_u32 s35, s35, s37
  v_add_u32 v13, s35, v13
  s_lshl_b32 s35, s20, 9
  s_add_u32 s35, s35, 0xf00000
  s_lshl_b32 s36, s22, 7
  s_add_u32 s36, s36, s35
  s_lshl_b32 s37, s21, 2
  s_add_u32 s37, s37, s36
  v_mov_b32 v18, s37
  v_and_b32 v51, 7, v0
  v_lshlrev_b32 v51, 2, v51
  v_bfe_u32 v52, v0, 3, 1
  v_lshl_add_u32 v51, v52, 7, v51
  s_lshl_b32 s37, s25, 1
  s_add_u32 s37, s37, s53
  s_lshl_b32 s37, s37, 5
  s_lshl_b32 s38, s54, 8
  s_add_u32 s37, s37, s38
  s_add_u32 s37, s37, s35
  v_add_u32 v14, s37, v51
  s_lshl_b32 s37, s26, 7
  s_add_u32 s37, s37, 0xf01000
  v_lshlrev_b32 v19, 2, v27
  v_add_u32 v19, s37, v19
  v_bfe_u32 v51, v0, 2, 2
  v_lshrrev_b32 v52, 4, v0
  v_lshl_add_u32 v53, v52, 2, v51
  v_and_b32 v54, 3, v0
  v_lshlrev_b32 v54, 3, v54
  v_bfe_u32 v55, v53, 1, 2
  v_lshl_add_u32 v20, v55, 5, v54
  v_lshl_add_u32 v20, v53, 7, v20
  v_bfe_u32 v55, v53, 2, 1
  v_lshl_add_u32 v21, v55, 5, v54
  v_lshl_add_u32 v21, v53, 6, v21
  v_mul_u32_u24 v22, 224, v53
  v_add_u32 v22, v22, v54
  v_lshrrev_b32 v53, 1, v52
  v_lshl_add_u32 v53, v53, 2, v51
  v_and_b32 v55, 1, v52
  s_lshl_b32 s37, s54, 1
  v_add_u32 v55, s37, v55
  v_and_b32 v51, 2, v51
  v_xor_b32 v55, v55, v51
  v_lshl_add_u32 v23, v55, 5, v54
  v_lshl_add_u32 v23, v53, 7, v23
  v_bfe_u32 v24, v0, 4, 1
  s_lshl_b32 s37, s53, 1
  v_add_u32 v24, s37, v24
  v_lshlrev_b32 v24, 12, v24
  v_lshl_add_u32 v24, v28, 8, v24
  v_lshl_add_u32 v24, v25, 4, v24
  s_mov_b32 s44, 0xc0135761
  s_mov_b32 s46, 0xbdd2d3e8
  s_mov_b32 s47, 0xbdd2d3e8
  s_mov_b32 s48, 0x3f800000
  s_mov_b32 s49, 0x3f800000
  s_mov_b32 s50, 0x3fb8aa3b
  s_mov_b32 s51, 0x358637bd
  s_mov_b32 s88, 0x3fb8aa3b
  s_mov_b32 s89, 0x3fb8aa3b
  s_mov_b32 s86, 0x358637bd
  s_mov_b32 s87, 0x358637bd
  s_mov_b32 s28, 0
  s_mov_b32 s29, 0
  s_mov_b32 s30, 1
  s_mov_b32 s27, 1
  s_mov_b32 s62, 1
  s_lshl_b32 s63, s20, 1
  s_add_u32 s63, s63, 1
  s_lshl_b32 s63, s63, 14
LAYER_LOOP:
  v_mov_b32 v124, 0x3f803f80
  v_mov_b32 v125, 0x3f803f80
  v_mov_b32 v126, 0x3f803f80
  v_mov_b32 v127, 0x3f803f80
  s_cmp_eq_u32 s28, 0
  s_cbranch_scc1 KVL0_1
  s_lshl_b32 s40, s30, 3
  s_add_u32 s40, s40, s31
  s_mov_b32 s39, 131072
POLL_3:
  buffer_load_dword v27, v14, s[4:7], 0 offen sc1
  s_waitcnt vmcnt(0)
  v_subrev_u32 v25, s40, v27
  v_cmp_gt_u32 vcc, 0x80, v25
  s_sub_u32 s39, s39, 1
  s_cbranch_scc1 POLLD_4
  s_cmp_eq_u64 vcc, -1
  s_cbranch_scc0 POLL_3
POLLD_4:
  buffer_load_dwordx4 v[128:131], v2, s[4:7], s90 offen offset:0 sc1
  buffer_load_dwordx4 v[192:195], v2, s[4:7], s94 offen offset:0 sc1
  buffer_load_dwordx4 v[132:135], v2, s[4:7], s90 offen offset:1024 sc1
  buffer_load_dwordx4 v[196:199], v2, s[4:7], s94 offen offset:1024 sc1
  buffer_load_dwordx4 v[136:139], v2, s[4:7], s90 offen offset:2048 sc1
  buffer_load_dwordx4 v[200:203], v2, s[4:7], s94 offen offset:2048 sc1
  buffer_load_dwordx4 v[140:143], v2, s[4:7], s90 offen offset:3072 sc1
  buffer_load_dwordx4 v[204:207], v2, s[4:7], s94 offen offset:3072 sc1
  s_barrier
  v_add_u32 v28, 0x1d000, v20
  v_xor_b32 v29, 32, v20
  v_add_u32 v29, 0x1d000, v29
  v_xor_b32 v30, 64, v20
  v_add_u32 v30, 0x1d000, v30
  v_xor_b32 v31, 96, v20
  v_add_u32 v31, 0x1d000, v31
  ds_read_b64_tr_b16 v[96:97], v28 offset:0
  ds_read_b64_tr_b16 v[98:99], v28 offset:2048
  ds_read_b64_tr_b16 v[100:101], v29 offset:0
  ds_read_b64_tr_b16 v[102:103], v29 offset:2048
  ds_read_b64_tr_b16 v[104:105], v30 offset:0
  ds_read_b64_tr_b16 v[106:107], v30 offset:2048
  ds_read_b64_tr_b16 v[108:109], v31 offset:0
  ds_read_b64_tr_b16 v[110:111], v31 offset:2048
  s_waitcnt vmcnt(6) lgkmcnt(6)
  v_mfma_f32_16x16x32_bf16 v[64:67], v[128:131], v[96:99], 0
  ds_read_b64_tr_b16 v[112:113], v28 offset:4096
  v_mfma_f32_16x16x32_bf16 v[80:83], v[192:195], v[96:99], 0
  ds_read_b64_tr_b16 v[114:115], v28 offset:6144
  s_waitcnt lgkmcnt(6)
  v_mfma_f32_16x16x32_bf16 v[68:71], v[128:131], v[100:103], 0
  ds_read_b64_tr_b16 v[96:97], v29 offset:4096
  v_mfma_f32_16x16x32_bf16 v[84:87], v[192:195], v[100:103], 0
  ds_read_b64_tr_b16 v[98:99], v29 offset:6144
  buffer_load_dwordx4 v[144:147], v2, s[4:7], s91 offen offset:0 sc1
  buffer_load_dwordx4 v[208:211], v2, s[4:7], s95 offen offset:0 sc1
  s_waitcnt lgkmcnt(6)
  v_mfma_f32_16x16x32_bf16 v[72:75], v[128:131], v[104:107], 0
  ds_read_b64_tr_b16 v[100:101], v30 offset:4096
  v_mfma_f32_16x16x32_bf16 v[88:91], v[192:195], v[104:107], 0
  ds_read_b64_tr_b16 v[102:103], v30 offset:6144
  s_waitcnt lgkmcnt(6)
  v_mfma_f32_16x16x32_bf16 v[76:79], v[128:131], v[108:111], 0
  ds_read_b64_tr_b16 v[104:105], v31 offset:4096
  v_mfma_f32_16x16x32_bf16 v[92:95], v[192:195], v[108:111], 0
  ds_read_b64_tr_b16 v[106:107], v31 offset:6144
  s_waitcnt vmcnt(6) lgkmcnt(6)
  v_mfma_f32_16x16x32_bf16 v[64:67], v[132:135], v[112:115], v[64:67]
  ds_read_b64_tr_b16 v[108:109], v28 offset:8192
  v_mfma_f32_16x16x32_bf16 v[80:83], v[196:199], v[112:115], v[80:83]
  ds_read_b64_tr_b16 v[110:111], v28 offset:10240
  s_waitcnt lgkmcnt(6)
  v_mfma_f32_16x16x32_bf16 v[68:71], v[132:135], v[96:99], v[68:71]
  ds_read_b64_tr_b16 v[112:113], v29 offset:8192
  v_mfma_f32_16x16x32_bf16 v[84:87], v[196:199], v[96:99], v[84:87]
  ds_read_b64_tr_b16 v[114:115], v29 offset:10240
  buffer_load_dwordx4 v[148:151], v2, s[4:7], s91 offen offset:1024 sc1
  buffer_load_dwordx4 v[212:215], v2, s[4:7], s95 offen offset:1024 sc1
  s_waitcnt lgkmcnt(6)
  v_mfma_f32_16x16x32_bf16 v[72:75], v[132:135], v[100:103], v[72:75]
  ds_read_b64_tr_b16 v[96:97], v30 offset:8192
  v_mfma_f32_16x16x32_bf16 v[88:91], v[196:199], v[100:103], v[88:91]
  ds_read_b64_tr_b16 v[98:99], v30 offset:10240
  s_waitcnt lgkmcnt(6)
  v_mfma_f32_16x16x32_bf16 v[76:79], v[132:135], v[104:107], v[76:79]
  ds_read_b64_tr_b16 v[100:101], v31 offset:8192
  v_mfma_f32_16x16x32_bf16 v[92:95], v[196:199], v[104:107], v[92:95]
  ds_read_b64_tr_b16 v[102:103], v31 offset:10240
  s_waitcnt vmcnt(6) lgkmcnt(6)
  v_mfma_f32_16x16x32_bf16 v[64:67], v[136:139], v[108:111], v[64:67]
  ds_read_b64_tr_b16 v[104:105], v28 offset:12288
  v_mfma_f32_16x16x32_bf16 v[80:83], v[200:203], v[108:111], v[80:83]
  ds_read_b64_tr_b16 v[106:107], v28 offset:14336
  s_waitcnt lgkmcnt(6)
  v_mfma_f32_16x16x32_bf16 v[68:71], v[136:139], v[112:115], v[68:71]
  ds_read_b64_tr_b16 v[108:109], v29 offset:12288
  v_mfma_f32_16x16x32_bf16 v[84:87], v[200:203], v[112:115], v[84:87]
  ds_read_b64_tr_b16 v[110:111], v29 offset:14336
  buffer_load_dwordx4 v[152:155], v2, s[4:7], s91 offen offset:2048 sc1
  buffer_load_dwordx4 v[216:219], v2, s[4:7], s95 offen offset:2048 sc1
  s_waitcnt lgkmcnt(6)
  v_mfma_f32_16x16x32_bf16 v[72:75], v[136:139], v[96:99], v[72:75]
  ds_read_b64_tr_b16 v[112:113], v30 offset:12288
  v_mfma_f32_16x16x32_bf16 v[88:91], v[200:203], v[96:99], v[88:91]
  ds_read_b64_tr_b16 v[114:115], v30 offset:14336
  s_waitcnt lgkmcnt(6)
  v_mfma_f32_16x16x32_bf16 v[76:79], v[136:139], v[100:103], v[76:79]
  ds_read_b64_tr_b16 v[96:97], v31 offset:12288
  v_mfma_f32_16x16x32_bf16 v[92:95], v[200:203], v[100:103], v[92:95]
  ds_read_b64_tr_b16 v[98:99], v31 offset:14336
  s_waitcnt vmcnt(6) lgkmcnt(6)
  v_mfma_f32_16x16x32_bf16 v[64:67], v[140:143], v[104:107], v[64:67]
  s_barrier
  ds_read_b64_tr_b16 v[100:101], v28 offset:16384
  v_mfma_f32_16x16x32_bf16 v[80:83], v[204:207], v[104:107], v[80:83]
  ds_read_b64_tr_b16 v[102:103], v28 offset:18432
  s_waitcnt lgkmcnt(6)
  v_mfma_f32_16x16x32_bf16 v[68:71], v[140:143], v[108:111], v[68:71]
  ds_read_b64_tr_b16 v[104:105], v29 offset:16384
  v_mfma_f32_16x16x32_bf16 v[84:87], v[204:207], v[108:111], v[84:87]
  ds_read_b64_tr_b16 v[106:107], v29 offset:18432
  buffer_load_dwordx4 v[156:159], v2, s[4:7], s91 offen offset:3072 sc1
  buffer_load_dwordx4 v[220:223], v2, s[4:7], s95 offen offset:3072 sc1
  s_waitcnt lgkmcnt(6)
  v_mfma_f32_16x16x32_bf16 v[72:75], v[140:143], v[112:115], v[72:75]
  ds_read_b64_tr_b16 v[108:109], v30 offset:16384
  v_mfma_f32_16x16x32_bf16 v[88:91], v[204:207], v[112:115], v[88:91]
  ds_read_b64_tr_b16 v[110:111], v30 offset:18432
  s_waitcnt lgkmcnt(6)
  v_mfma_f32_16x16x32_bf16 v[76:79], v[140:143], v[96:99], v[76:79]
  ds_read_b64_tr_b16 v[112:113], v31 offset:16384
  v_mfma_f32_16x16x32_bf16 v[92:95], v[204:207], v[96:99], v[92:95]
  ds_read_b64_tr_b16 v[114:115], v31 offset:18432
  s_waitcnt vmcnt(6) lgkmcnt(6)
  v_mfma_f32_16x16x32_bf16 v[64:67], v[144:147], v[100:103], v[64:67]
  ds_read_b64_tr_b16 v[96:97], v28 offset:20480
  v_mfma_f32_16x16x32_bf16 v[80:83], v[208:211], v[100:103], v[80:83]
  ds_read_b64_tr_b16 v[98:99], v28 offset:22528
  s_waitcnt lgkmcnt(6)
  v_mfma_f32_16x16x32_bf16 v[68:71], v[144:147], v[104:107], v[68:71]
  ds_read_b64_tr_b16 v[100:101], v29 offset:20480
  v_mfma_f32_16x16x32_bf16 v[84:87], v[208:211], v[104:107], v[84:87]
  ds_read_b64_tr_b16 v[102:103], v29 offset:22528
  buffer_load_dwordx4 v[160:163], v2, s[4:7], s92 offen offset:0 sc1
  buffer_load_dwordx4 v[224:227], v2, s[4:7], s96 offen offset:0 sc1
  s_waitcnt lgkmcnt(6)
  v_mfma_f32_16x16x32_bf16 v[72:75], v[144:147], v[108:111], v[72:75]
  ds_read_b64_tr_b16 v[104:105], v30 offset:20480
  v_mfma_f32_16x16x32_bf16 v[88:91], v[208:211], v[108:111], v[88:91]
  ds_read_b64_tr_b16 v[106:107], v30 offset:22528
  s_waitcnt lgkmcnt(6)
  v_mfma_f32_16x16x32_bf16 v[76:79], v[144:147], v[112:115], v[76:79]
  ds_read_b64_tr_b16 v[108:109], v31 offset:20480
  v_mfma_f32_16x16x32_bf16 v[92:95], v[208:211], v[112:115], v[92:95]
  ds_read_b64_tr_b16 v[110:111], v31 offset:22528
  s_waitcnt vmcnt(6) lgkmcnt(6)
  v_mfma_f32_16x16x32_bf16 v[64:67], v[148:151], v[96:99], v[64:67]
  ds_read_b64_tr_b16 v[112:113], v28 offset:24576
  v_mfma_f32_16x16x32_bf16 v[80:83], v[212:215], v[96:99], v[80:83]
  ds_read_b64_tr_b16 v[114:115], v28 offset:26624
  s_waitcnt lgkmcnt(6)
  v_mfma_f32_16x16x32_bf16 v[68:71], v[148:151], v[100:103], v[68:71]
  ds_read_b64_tr_b16 v[96:97], v29 offset:24576
  v_mfma_f32_16x16x32_bf16 v[84:87], v[212:215], v[100:103], v[84:87]
  ds_read_b64_tr_b16 v[98:99], v29 offset:26624
  buffer_load_dwordx4 v[164:167], v2, s[4:7], s92 offen offset:1024 sc1
  buffer_load_dwordx4 v[228:231], v2, s[4:7], s96 offen offset:1024 sc1
  s_waitcnt lgkmcnt(6)
  v_mfma_f32_16x16x32_bf16 v[72:75], v[148:151], v[104:107], v[72:75]
  ds_read_b64_tr_b16 v[100:101], v30 offset:24576
  v_mfma_f32_16x16x32_bf16 v[88:91], v[212:215], v[104:107], v[88:91]
  ds_read_b64_tr_b16 v[102:103], v30 offset:26624
  s_waitcnt lgkmcnt(6)
  v_mfma_f32_16x16x32_bf16 v[76:79], v[148:151], v[108:111], v[76:79]
  ds_read_b64_tr_b16 v[104:105], v31 offset:24576
  v_mfma_f32_16x16x32_bf16 v[92:95], v[212:215], v[108:111], v[92:95]
  ds_read_b64_tr_b16 v[106:107], v31 offset:26624
  s_waitcnt vmcnt(6) lgkmcnt(6)
  v_mfma_f32_16x16x32_bf16 v[64:67], v[152:155], v[112:115], v[64:67]
  ds_read_b64_tr_b16 v[108:109], v28 offset:28672
  v_mfma_f32_16x16x32_bf16 v[80:83], v[216:219], v[112:115], v[80:83]
  ds_read_b64_tr_b16 v[110:111], v28 offset:30720
  s_waitcnt lgkmcnt(6)
  v_mfma_f32_16x16x32_bf16 v[68:71], v[152:155], v[96:99], v[68:71]
  ds_read_b64_tr_b16 v[112:113], v29 offset:28672
  v_mfma_f32_16x16x32_bf16 v[84:87], v[216:219], v[96:99], v[84:87]
  ds_read_b64_tr_b16 v[114:115], v29 offset:30720
  buffer_load_dwordx4 v[168:171], v2, s[4:7], s92 offen offset:2048 sc1
  buffer_load_dwordx4 v[232:235], v2, s[4:7], s96 offen offset:2048 sc1
  s_waitcnt lgkmcnt(6)
  v_mfma_f32_16x16x32_bf16 v[72:75], v[152:155], v[100:103], v[72:75]
  ds_read_b64_tr_b16 v[96:97], v30 offset:28672
  v_mfma_f32_16x16x32_bf16 v[88:91], v[216:219], v[100:103], v[88:91]
  ds_read_b64_tr_b16 v[98:99], v30 offset:30720
  s_waitcnt lgkmcnt(6)
  v_mfma_f32_16x16x32_bf16 v[76:79], v[152:155], v[104:107], v[76:79]
  ds_read_b64_tr_b16 v[100:101], v31 offset:28672
  v_mfma_f32_16x16x32_bf16 v[92:95], v[216:219], v[104:107], v[92:95]
  ds_read_b64_tr_b16 v[102:103], v31 offset:30720
  s_waitcnt vmcnt(6) lgkmcnt(6)
  v_mfma_f32_16x16x32_bf16 v[64:67], v[156:159], v[108:111], v[64:67]
  s_barrier
  ds_read_b64_tr_b16 v[104:105], v28 offset:32768
  v_mfma_f32_16x16x32_bf16 v[80:83], v[220:223], v[108:111], v[80:83]
  ds_read_b64_tr_b16 v[106:107], v28 offset:34816
  s_waitcnt lgkmcnt(6)
  v_mfma_f32_16x16x32_bf16 v[68:71], v[156:159], v[112:115], v[68:71]
  ds_read_b64_tr_b16 v[108:109], v29 offset:32768
  v_mfma_f32_16x16x32_bf16 v[84:87], v[220:223], v[112:115], v[84:87]
  ds_read_b64_tr_b16 v[110:111], v29 offset:34816
  buffer_load_dwordx4 v[172:175], v2, s[4:7], s92 offen offset:3072 sc1
  buffer_load_dwordx4 v[236:239], v2, s[4:7], s96 offen offset:3072 sc1
  s_waitcnt lgkmcnt(6)
  v_mfma_f32_16x16x32_bf16 v[72:75], v[156:159], v[96:99], v[72:75]
  ds_read_b64_tr_b16 v[112:113], v30 offset:32768
  v_mfma_f32_16x16x32_bf16 v[88:91], v[220:223], v[96:99], v[88:91]
  ds_read_b64_tr_b16 v[114:115], v30 offset:34816
  s_waitcnt lgkmcnt(6)
  v_mfma_f32_16x16x32_bf16 v[76:79], v[156:159], v[100:103], v[76:79]
  ds_read_b64_tr_b16 v[96:97], v31 offset:32768
  v_mfma_f32_16x16x32_bf16 v[92:95], v[220:223], v[100:103], v[92:95]
  ds_read_b64_tr_b16 v[98:99], v31 offset:34816
  s_waitcnt vmcnt(6) lgkmcnt(6)
  v_mfma_f32_16x16x32_bf16 v[64:67], v[160:163], v[104:107], v[64:67]
  v_add_u32 v28, 0x10000, v20
  v_xor_b32 v29, 32, v20
  v_add_u32 v29, 0x10000, v29
  v_xor_b32 v30, 64, v20
  v_add_u32 v30, 0x10000, v30
  v_xor_b32 v31, 96, v20
  v_add_u32 v31, 0x10000, v31
  ds_read_b64_tr_b16 v[100:101], v28 offset:0
  v_mfma_f32_16x16x32_bf16 v[80:83], v[224:227], v[104:107], v[80:83]
  ds_read_b64_tr_b16 v[102:103], v28 offset:2048
  s_waitcnt lgkmcnt(6)
  v_mfma_f32_16x16x32_bf16 v[68:71], v[160:163], v[108:111], v[68:71]
  ds_read_b64_tr_b16 v[104:105], v29 offset:0
  v_mfma_f32_16x16x32_bf16 v[84:87], v[224:227], v[108:111], v[84:87]
  ds_read_b64_tr_b16 v[106:107], v29 offset:2048
  buffer_load_dwordx4 v[176:179], v2, s[4:7], s93 offen offset:0 sc1
  buffer_load_dwordx4 v[240:243], v2, s[4:7], s97 offen offset:0 sc1
  s_waitcnt lgkmcnt(6)
  v_mfma_f32_16x16x32_bf16 v[72:75], v[160:163], v[112:115], v[72:75]
  ds_read_b64_tr_b16 v[108:109], v30 offset:0
  v_mfma_f32_16x16x32_bf16 v[88:91], v[224:227], v[112:115], v[88:91]
  ds_read_b64_tr_b16 v[110:111], v30 offset:2048
  s_waitcnt lgkmcnt(6)
  v_mfma_f32_16x16x32_bf16 v[76:79], v[160:163], v[96:99], v[76:79]
  ds_read_b64_tr_b16 v[112:113], v31 offset:0
  v_mfma_f32_16x16x32_bf16 v[92:95], v[224:227], v[96:99], v[92:95]
  ds_read_b64_tr_b16 v[114:115], v31 offset:2048
  s_waitcnt vmcnt(6) lgkmcnt(6)
  v_mfma_f32_16x16x32_bf16 v[64:67], v[164:167], v[100:103], v[64:67]
  ds_read_b64_tr_b16 v[96:97], v28 offset:4096
  v_mfma_f32_16x16x32_bf16 v[80:83], v[228:231], v[100:103], v[80:83]
  ds_read_b64_tr_b16 v[98:99], v28 offset:6144
  s_waitcnt lgkmcnt(6)
  v_mfma_f32_16x16x32_bf16 v[68:71], v[164:167], v[104:107], v[68:71]
  ds_read_b64_tr_b16 v[100:101], v29 offset:4096
  v_mfma_f32_16x16x32_bf16 v[84:87], v[228:231], v[104:107], v[84:87]
  ds_read_b64_tr_b16 v[102:103], v29 offset:6144
  buffer_load_dwordx4 v[180:183], v2, s[4:7], s93 offen offset:1024 sc1
  buffer_load_dwordx4 v[244:247], v2, s[4:7], s97 offen offset:1024 sc1
  s_waitcnt lgkmcnt(6)
  v_mfma_f32_16x16x32_bf16 v[72:75], v[164:167], v[108:111], v[72:75]
  ds_read_b64_tr_b16 v[104:105], v30 offset:4096
  v_mfma_f32_16x16x32_bf16 v[88:91], v[228:231], v[108:111], v[88:91]
  ds_read_b64_tr_b16 v[106:107], v30 offset:6144
  s_waitcnt lgkmcnt(6)
  v_mfma_f32_16x16x32_bf16 v[76:79], v[164:167], v[112:115], v[76:79]
  ds_read_b64_tr_b16 v[108:109], v31 offset:4096
  v_mfma_f32_16x16x32_bf16 v[92:95], v[228:231], v[112:115], v[92:95]
  ds_read_b64_tr_b16 v[110:111], v31 offset:6144
  s_waitcnt vmcnt(6) lgkmcnt(6)
  v_mfma_f32_16x16x32_bf16 v[64:67], v[168:171], v[96:99], v[64:67]
  ds_read_b64_tr_b16 v[112:113], v28 offset:8192
  v_mfma_f32_16x16x32_bf16 v[80:83], v[232:235], v[96:99], v[80:83]
  ds_read_b64_tr_b16 v[114:115], v28 offset:10240
  s_waitcnt lgkmcnt(6)
  v_mfma_f32_16x16x32_bf16 v[68:71], v[168:171], v[100:103], v[68:71]
  ds_read_b64_tr_b16 v[96:97], v29 offset:8192
  v_mfma_f32_16x16x32_bf16 v[84:87], v[232:235], v[100:103], v[84:87]
  ds_read_b64_tr_b16 v[98:99], v29 offset:10240
  buffer_load_dwordx4 v[184:187], v2, s[4:7], s93 offen offset:2048 sc1
  buffer_load_dwordx4 v[248:251], v2, s[4:7], s97 offen offset:2048 sc1
  s_waitcnt lgkmcnt(6)
  v_mfma_f32_16x16x32_bf16 v[72:75], v[168:171], v[104:107], v[72:75]
  ds_read_b64_tr_b16 v[100:101], v30 offset:8192
  v_mfma_f32_16x16x32_bf16 v[88:91], v[232:235], v[104:107], v[88:91]
  ds_read_b64_tr_b16 v[102:103], v30 offset:10240
  s_waitcnt lgkmcnt(6)
  v_mfma_f32_16x16x32_bf16 v[76:79], v[168:171], v[108:111], v[76:79]
  ds_read_b64_tr_b16 v[104:105], v31 offset:8192
  v_mfma_f32_16x16x32_bf16 v[92:95], v[232:235], v[108:111], v[92:95]
  ds_read_b64_tr_b16 v[106:107], v31 offset:10240
  s_waitcnt vmcnt(6) lgkmcnt(6)
  v_mfma_f32_16x16x32_bf16 v[64:67], v[172:175], v[112:115], v[64:67]
  s_barrier
  ds_read_b64_tr_b16 v[108:109], v28 offset:12288
  v_mfma_f32_16x16x32_bf16 v[80:83], v[236:239], v[112:115], v[80:83]
  ds_read_b64_tr_b16 v[110:111], v28 offset:14336
  s_waitcnt lgkmcnt(6)
  v_mfma_f32_16x16x32_bf16 v[68:71], v[172:175], v[96:99], v[68:71]
  ds_read_b64_tr_b16 v[112:113], v29 offset:12288
  v_mfma_f32_16x16x32_bf16 v[84:87], v[236:239], v[96:99], v[84:87]
  ds_read_b64_tr_b16 v[114:115], v29 offset:14336
  buffer_load_dwordx4 v[188:191], v2, s[4:7], s93 offen offset:3072 sc1
  buffer_load_dwordx4 v[252:255], v2, s[4:7], s97 offen offset:3072 sc1
  s_waitcnt lgkmcnt(6)
  v_mfma_f32_16x16x32_bf16 v[72:75], v[172:175], v[100:103], v[72:75]
  ds_read_b64_tr_b16 v[96:97], v30 offset:12288
  v_mfma_f32_16x16x32_bf16 v[88:91], v[236:239], v[100:103], v[88:91]
  ds_read_b64_tr_b16 v[98:99], v30 offset:14336
  s_waitcnt lgkmcnt(6)
  v_mfma_f32_16x16x32_bf16 v[76:79], v[172:175], v[104:107], v[76:79]
  ds_read_b64_tr_b16 v[100:101], v31 offset:12288
  v_mfma_f32_16x16x32_bf16 v[92:95], v[236:239], v[104:107], v[92:95]
  ds_read_b64_tr_b16 v[102:103], v31 offset:14336
  s_waitcnt vmcnt(6) lgkmcnt(6)
  v_mfma_f32_16x16x32_bf16 v[64:67], v[176:179], v[108:111], v[64:67]
  ds_read_b64_tr_b16 v[104:105], v28 offset:16384
  v_mfma_f32_16x16x32_bf16 v[80:83], v[240:243], v[108:111], v[80:83]
  ds_read_b64_tr_b16 v[106:107], v28 offset:18432
  s_waitcnt lgkmcnt(6)
  v_mfma_f32_16x16x32_bf16 v[68:71], v[176:179], v[112:115], v[68:71]
  ds_read_b64_tr_b16 v[108:109], v29 offset:16384
  v_mfma_f32_16x16x32_bf16 v[84:87], v[240:243], v[112:115], v[84:87]
  ds_read_b64_tr_b16 v[110:111], v29 offset:18432
  s_mov_b32 s33, 0xd80000
  buffer_load_dwordx4 v[116:119], v10, s[4:7], s33 offen sc1
  buffer_load_dwordx4 v[120:123], v10, s[4:7], s33 offen offset:512 sc1
  buffer_load_dwordx4 v[56:59], v10, s[4:7], s33 offen offset:256 sc1
  buffer_load_dwordx4 v[60:63], v10, s[4:7], s33 offen offset:768 sc1
  s_waitcnt lgkmcnt(6)
  v_mfma_f32_16x16x32_bf16 v[72:75], v[176:179], v[96:99], v[72:75]
  ds_read_b64_tr_b16 v[112:113], v30 offset:16384
  v_mfma_f32_16x16x32_bf16 v[88:91], v[240:243], v[96:99], v[88:91]
  ds_read_b64_tr_b16 v[114:115], v30 offset:18432
  s_waitcnt lgkmcnt(6)
  v_mfma_f32_16x16x32_bf16 v[76:79], v[176:179], v[100:103], v[76:79]
  ds_read_b64_tr_b16 v[96:97], v31 offset:16384
  v_mfma_f32_16x16x32_bf16 v[92:95], v[240:243], v[100:103], v[92:95]
  ds_read_b64_tr_b16 v[98:99], v31 offset:18432
  s_waitcnt vmcnt(8) lgkmcnt(6)
  v_mfma_f32_16x16x32_bf16 v[64:67], v[180:183], v[104:107], v[64:67]
  ds_read_b64_tr_b16 v[100:101], v28 offset:20480
  v_mfma_f32_16x16x32_bf16 v[80:83], v[244:247], v[104:107], v[80:83]
  ds_read_b64_tr_b16 v[102:103], v28 offset:22528
  s_waitcnt lgkmcnt(6)
  v_mfma_f32_16x16x32_bf16 v[68:71], v[180:183], v[108:111], v[68:71]
  ds_read_b64_tr_b16 v[104:105], v29 offset:20480
  v_mfma_f32_16x16x32_bf16 v[84:87], v[244:247], v[108:111], v[84:87]
  ds_read_b64_tr_b16 v[106:107], v29 offset:22528
  s_waitcnt lgkmcnt(6)
  v_mfma_f32_16x16x32_bf16 v[72:75], v[180:183], v[112:115], v[72:75]
  ds_read_b64_tr_b16 v[108:109], v30 offset:20480
  v_mfma_f32_16x16x32_bf16 v[88:91], v[244:247], v[112:115], v[88:91]
  ds_read_b64_tr_b16 v[110:111], v30 offset:22528
  s_waitcnt lgkmcnt(6)
  v_mfma_f32_16x16x32_bf16 v[76:79], v[180:183], v[96:99], v[76:79]
  ds_read_b64_tr_b16 v[112:113], v31 offset:20480
  v_mfma_f32_16x16x32_bf16 v[92:95], v[244:247], v[96:99], v[92:95]
  ds_read_b64_tr_b16 v[114:115], v31 offset:22528
  s_waitcnt vmcnt(6) lgkmcnt(6)
  v_mfma_f32_16x16x32_bf16 v[64:67], v[184:187], v[100:103], v[64:67]
  ds_read_b64_tr_b16 v[96:97], v28 offset:24576
  v_mfma_f32_16x16x32_bf16 v[80:83], v[248:251], v[100:103], v[80:83]
  ds_read_b64_tr_b16 v[98:99], v28 offset:26624
  s_waitcnt lgkmcnt(6)
  v_mfma_f32_16x16x32_bf16 v[68:71], v[184:187], v[104:107], v[68:71]
  ds_read_b64_tr_b16 v[100:101], v29 offset:24576
  v_mfma_f32_16x16x32_bf16 v[84:87], v[248:251], v[104:107], v[84:87]
  ds_read_b64_tr_b16 v[102:103], v29 offset:26624
  s_waitcnt lgkmcnt(6)
  v_mfma_f32_16x16x32_bf16 v[72:75], v[184:187], v[108:111], v[72:75]
  ds_read_b64_tr_b16 v[104:105], v30 offset:24576
  v_mfma_f32_16x16x32_bf16 v[88:91], v[248:251], v[108:111], v[88:91]
  ds_read_b64_tr_b16 v[106:107], v30 offset:26624
  s_waitcnt lgkmcnt(6)
  v_mfma_f32_16x16x32_bf16 v[76:79], v[184:187], v[112:115], v[76:79]
  ds_read_b64_tr_b16 v[108:109], v31 offset:24576
  v_mfma_f32_16x16x32_bf16 v[92:95], v[248:251], v[112:115], v[92:95]
  ds_read_b64_tr_b16 v[110:111], v31 offset:26624
  s_waitcnt vmcnt(4) lgkmcnt(6)
  v_mfma_f32_16x16x32_bf16 v[64:67], v[188:191], v[96:99], v[64:67]
  v_mfma_f32_16x16x32_bf16 v[80:83], v[252:255], v[96:99], v[80:83]
  s_waitcnt lgkmcnt(4)
  v_mfma_f32_16x16x32_bf16 v[68:71], v[188:191], v[100:103], v[68:71]
  v_mfma_f32_16x16x32_bf16 v[84:87], v[252:255], v[100:103], v[84:87]
  s_waitcnt lgkmcnt(2)
  v_mfma_f32_16x16x32_bf16 v[72:75], v[188:191], v[104:107], v[72:75]
  v_mfma_f32_16x16x32_bf16 v[88:91], v[252:255], v[104:107], v[88:91]
  s_waitcnt lgkmcnt(0)
  v_mfma_f32_16x16x32_bf16 v[76:79], v[188:191], v[108:111], v[76:79]
  v_mfma_f32_16x16x32_bf16 v[92:95], v[252:255], v[108:111], v[92:95]
  s_barrier
  s_nop 7
  s_branch KVJ_2
KVL0_1:
  v_and_b32 v25, 15, v0
  v_lshrrev_b32 v26, 4, v0
  v_xor_b32 v26, v26, v25
  v_lshlrev_b32 v26, 4, v26
  s_lshl_b32 s33, s22, 5
  v_add_u32 v25, s33, v25
  v_lshlrev_b32 v25, 8, v25
  v_xor_b32 v50, 0, v26
  v_add_u32 v50, v50, v25
  v_xor_b32 v51, 64, v26
  v_add_u32 v51, v51, v25
  v_xor_b32 v52, 128, v26
  v_add_u32 v52, v52, v25
  v_xor_b32 v53, 192, v26
  v_add_u32 v53, v53, v25
  s_barrier
  v_add_u32 v28, 0x1d000, v20
  v_xor_b32 v29, 32, v20
  v_add_u32 v29, 0x1d000, v29
  v_xor_b32 v30, 64, v20
  v_add_u32 v30, 0x1d000, v30
  v_xor_b32 v31, 96, v20
  v_add_u32 v31, 0x1d000, v31
  ds_read_b128 v[128:131], v50 offset:0
  ds_read_b128 v[192:195], v50 offset:4096
  ds_read_b64_tr_b16 v[96:97], v28 offset:0
  ds_read_b64_tr_b16 v[98:99], v28 offset:2048
  ds_read_b64_tr_b16 v[100:101], v29 offset:0
  ds_read_b64_tr_b16 v[102:103], v29 offset:2048
  ds_read_b64_tr_b16 v[104:105], v30 offset:0
  ds_read_b64_tr_b16 v[106:107], v30 offset:2048
  ds_read_b64_tr_b16 v[108:109], v31 offset:0
  ds_read_b64_tr_b16 v[110:111], v31 offset:2048
  s_waitcnt lgkmcnt(6)
  v_mfma_f32_16x16x32_bf16 v[64:67], v[128:131], v[96:99], 0
  ds_read_b128 v[132:135], v51 offset:0
  ds_read_b128 v[196:199], v51 offset:4096
  ds_read_b64_tr_b16 v[112:113], v28 offset:4096
  v_mfma_f32_16x16x32_bf16 v[80:83], v[192:195], v[96:99], 0
  ds_read_b64_tr_b16 v[114:115], v28 offset:6144
  s_waitcnt lgkmcnt(8)
  v_mfma_f32_16x16x32_bf16 v[68:71], v[128:131], v[100:103], 0
  ds_read_b64_tr_b16 v[96:97], v29 offset:4096
  v_mfma_f32_16x16x32_bf16 v[84:87], v[192:195], v[100:103], 0
  ds_read_b64_tr_b16 v[98:99], v29 offset:6144
  s_waitcnt lgkmcnt(8)
  v_mfma_f32_16x16x32_bf16 v[72:75], v[128:131], v[104:107], 0
  ds_read_b64_tr_b16 v[100:101], v30 offset:4096
  v_mfma_f32_16x16x32_bf16 v[88:91], v[192:195], v[104:107], 0
  ds_read_b64_tr_b16 v[102:103], v30 offset:6144
  s_waitcnt lgkmcnt(8)
  v_mfma_f32_16x16x32_bf16 v[76:79], v[128:131], v[108:111], 0
  ds_read_b64_tr_b16 v[104:105], v31 offset:4096
  v_mfma_f32_16x16x32_bf16 v[92:95], v[192:195], v[108:111], 0
  ds_read_b64_tr_b16 v[106:107], v31 offset:6144
  v_mfma_f32_16x16x32_bf16 v[116:119], v[124:127], v[128:131], 0
  v_mfma_f32_16x16x32_bf16 v[56:59], v[128:131], v[128:131], 0
  v_mfma_f32_16x16x32_bf16 v[120:123], v[124:127], v[192:195], 0
  v_mfma_f32_16x16x32_bf16 v[60:63], v[192:195], v[192:195], 0
  s_waitcnt lgkmcnt(6)
  v_mfma_f32_16x16x32_bf16 v[64:67], v[132:135], v[112:115], v[64:67]
  ds_read_b128 v[136:139], v52 offset:0
  ds_read_b128 v[200:203], v52 offset:4096
  ds_read_b64_tr_b16 v[108:109], v28 offset:8192
  v_mfma_f32_16x16x32_bf16 v[80:83], v[196:199], v[112:115], v[80:83]
  ds_read_b64_tr_b16 v[110:111], v28 offset:10240
  s_waitcnt lgkmcnt(8)
  v_mfma_f32_16x16x32_bf16 v[68:71], v[132:135], v[96:99], v[68:71]
  ds_read_b64_tr_b16 v[112:113], v29 offset:8192
  v_mfma_f32_16x16x32_bf16 v[84:87], v[196:199], v[96:99], v[84:87]
  ds_read_b64_tr_b16 v[114:115], v29 offset:10240
  s_waitcnt lgkmcnt(8)
  v_mfma_f32_16x16x32_bf16 v[72:75], v[132:135], v[100:103], v[72:75]
  ds_read_b64_tr_b16 v[96:97], v30 offset:8192
  v_mfma_f32_16x16x32_bf16 v[88:91], v[196:199], v[100:103], v[88:91]
  ds_read_b64_tr_b16 v[98:99], v30 offset:10240
  s_waitcnt lgkmcnt(8)
  v_mfma_f32_16x16x32_bf16 v[76:79], v[132:135], v[104:107], v[76:79]
  ds_read_b64_tr_b16 v[100:101], v31 offset:8192
  v_mfma_f32_16x16x32_bf16 v[92:95], v[196:199], v[104:107], v[92:95]
  ds_read_b64_tr_b16 v[102:103], v31 offset:10240
  v_mfma_f32_16x16x32_bf16 v[116:119], v[124:127], v[132:135], v[116:119]
  v_mfma_f32_16x16x32_bf16 v[56:59], v[132:135], v[132:135], v[56:59]
  v_mfma_f32_16x16x32_bf16 v[120:123], v[124:127], v[196:199], v[120:123]
  v_mfma_f32_16x16x32_bf16 v[60:63], v[196:199], v[196:199], v[60:63]
  s_waitcnt lgkmcnt(6)
  v_mfma_f32_16x16x32_bf16 v[64:67], v[136:139], v[108:111], v[64:67]
  ds_read_b128 v[140:143], v53 offset:0
  ds_read_b128 v[204:207], v53 offset:4096
  ds_read_b64_tr_b16 v[104:105], v28 offset:12288
  v_mfma_f32_16x16x32_bf16 v[80:83], v[200:203], v[108:111], v[80:83]
  ds_read_b64_tr_b16 v[106:107], v28 offset:14336
  s_waitcnt lgkmcnt(8)
  v_mfma_f32_16x16x32_bf16 v[68:71], v[136:139], v[112:115], v[68:71]
  ds_read_b64_tr_b16 v[108:109], v29 offset:12288
  v_mfma_f32_16x16x32_bf16 v[84:87], v[200:203], v[112:115], v[84:87]
  ds_read_b64_tr_b16 v[110:111], v29 offset:14336
  s_waitcnt lgkmcnt(8)
  v_mfma_f32_16x16x32_bf16 v[72:75], v[136:139], v[96:99], v[72:75]
  ds_read_b64_tr_b16 v[112:113], v30 offset:12288
  v_mfma_f32_16x16x32_bf16 v[88:91], v[200:203], v[96:99], v[88:91]
  ds_read_b64_tr_b16 v[114:115], v30 offset:14336
  s_waitcnt lgkmcnt(8)
  v_mfma_f32_16x16x32_bf16 v[76:79], v[136:139], v[100:103], v[76:79]
  ds_read_b64_tr_b16 v[96:97], v31 offset:12288
  v_mfma_f32_16x16x32_bf16 v[92:95], v[200:203], v[100:103], v[92:95]
  ds_read_b64_tr_b16 v[98:99], v31 offset:14336
  v_mfma_f32_16x16x32_bf16 v[116:119], v[124:127], v[136:139], v[116:119]
  v_mfma_f32_16x16x32_bf16 v[56:59], v[136:139], v[136:139], v[56:59]
  v_mfma_f32_16x16x32_bf16 v[120:123], v[124:127], v[200:203], v[120:123]
  v_mfma_f32_16x16x32_bf16 v[60:63], v[200:203], v[200:203], v[60:63]
  s_waitcnt lgkmcnt(6)
  v_mfma_f32_16x16x32_bf16 v[64:67], v[140:143], v[104:107], v[64:67]
  s_barrier
  ds_read_b128 v[144:147], v50 offset:32768
  ds_read_b128 v[208:211], v50 offset:36864
  ds_read_b64_tr_b16 v[100:101], v28 offset:16384
  v_mfma_f32_16x16x32_bf16 v[80:83], v[204:207], v[104:107], v[80:83]
  ds_read_b64_tr_b16 v[102:103], v28 offset:18432
  s_waitcnt lgkmcnt(8)
  v_mfma_f32_16x16x32_bf16 v[68:71], v[140:143], v[108:111], v[68:71]
  ds_read_b64_tr_b16 v[104:105], v29 offset:16384
  v_mfma_f32_16x16x32_bf16 v[84:87], v[204:207], v[108:111], v[84:87]
  ds_read_b64_tr_b16 v[106:107], v29 offset:18432
  s_waitcnt lgkmcnt(8)
  v_mfma_f32_16x16x32_bf16 v[72:75], v[140:143], v[112:115], v[72:75]
  ds_read_b64_tr_b16 v[108:109], v30 offset:16384
  v_mfma_f32_16x16x32_bf16 v[88:91], v[204:207], v[112:115], v[88:91]
  ds_read_b64_tr_b16 v[110:111], v30 offset:18432
  s_waitcnt lgkmcnt(8)
  v_mfma_f32_16x16x32_bf16 v[76:79], v[140:143], v[96:99], v[76:79]
  ds_read_b64_tr_b16 v[112:113], v31 offset:16384
  v_mfma_f32_16x16x32_bf16 v[92:95], v[204:207], v[96:99], v[92:95]
  ds_read_b64_tr_b16 v[114:115], v31 offset:18432
  v_mfma_f32_16x16x32_bf16 v[116:119], v[124:127], v[140:143], v[116:119]
  v_mfma_f32_16x16x32_bf16 v[56:59], v[140:143], v[140:143], v[56:59]
  v_mfma_f32_16x16x32_bf16 v[120:123], v[124:127], v[204:207], v[120:123]
  v_mfma_f32_16x16x32_bf16 v[60:63], v[204:207], v[204:207], v[60:63]
  s_waitcnt lgkmcnt(6)
  v_mfma_f32_16x16x32_bf16 v[64:67], v[144:147], v[100:103], v[64:67]
  ds_read_b128 v[148:151], v51 offset:32768
  ds_read_b128 v[212:215], v51 offset:36864
  ds_read_b64_tr_b16 v[96:97], v28 offset:20480
  v_mfma_f32_16x16x32_bf16 v[80:83], v[208:211], v[100:103], v[80:83]
  ds_read_b64_tr_b16 v[98:99], v28 offset:22528
  s_waitcnt lgkmcnt(8)
  v_mfma_f32_16x16x32_bf16 v[68:71], v[144:147], v[104:107], v[68:71]
  ds_read_b64_tr_b16 v[100:101], v29 offset:20480
  v_mfma_f32_16x16x32_bf16 v[84:87], v[208:211], v[104:107], v[84:87]
  ds_read_b64_tr_b16 v[102:103], v29 offset:22528
  s_waitcnt lgkmcnt(8)
  v_mfma_f32_16x16x32_bf16 v[72:75], v[144:147], v[108:111], v[72:75]
  ds_read_b64_tr_b16 v[104:105], v30 offset:20480
  v_mfma_f32_16x16x32_bf16 v[88:91], v[208:211], v[108:111], v[88:91]
  ds_read_b64_tr_b16 v[106:107], v30 offset:22528
  s_waitcnt lgkmcnt(8)
  v_mfma_f32_16x16x32_bf16 v[76:79], v[144:147], v[112:115], v[76:79]
  ds_read_b64_tr_b16 v[108:109], v31 offset:20480
  v_mfma_f32_16x16x32_bf16 v[92:95], v[208:211], v[112:115], v[92:95]
  ds_read_b64_tr_b16 v[110:111], v31 offset:22528
  v_mfma_f32_16x16x32_bf16 v[116:119], v[124:127], v[144:147], v[116:119]
  v_mfma_f32_16x16x32_bf16 v[56:59], v[144:147], v[144:147], v[56:59]
  v_mfma_f32_16x16x32_bf16 v[120:123], v[124:127], v[208:211], v[120:123]
  v_mfma_f32_16x16x32_bf16 v[60:63], v[208:211], v[208:211], v[60:63]
  s_waitcnt lgkmcnt(6)
  v_mfma_f32_16x16x32_bf16 v[64:67], v[148:151], v[96:99], v[64:67]
  ds_read_b128 v[152:155], v52 offset:32768
  ds_read_b128 v[216:219], v52 offset:36864
  ds_read_b64_tr_b16 v[112:113], v28 offset:24576
  v_mfma_f32_16x16x32_bf16 v[80:83], v[212:215], v[96:99], v[80:83]
  ds_read_b64_tr_b16 v[114:115], v28 offset:26624
  s_waitcnt lgkmcnt(8)
  v_mfma_f32_16x16x32_bf16 v[68:71], v[148:151], v[100:103], v[68:71]
  ds_read_b64_tr_b16 v[96:97], v29 offset:24576
  v_mfma_f32_16x16x32_bf16 v[84:87], v[212:215], v[100:103], v[84:87]
  ds_read_b64_tr_b16 v[98:99], v29 offset:26624
  s_waitcnt lgkmcnt(8)
  v_mfma_f32_16x16x32_bf16 v[72:75], v[148:151], v[104:107], v[72:75]
  ds_read_b64_tr_b16 v[100:101], v30 offset:24576
  v_mfma_f32_16x16x32_bf16 v[88:91], v[212:215], v[104:107], v[88:91]
  ds_read_b64_tr_b16 v[102:103], v30 offset:26624
  s_waitcnt lgkmcnt(8)
  v_mfma_f32_16x16x32_bf16 v[76:79], v[148:151], v[108:111], v[76:79]
  ds_read_b64_tr_b16 v[104:105], v31 offset:24576
  v_mfma_f32_16x16x32_bf16 v[92:95], v[212:215], v[108:111], v[92:95]
  ds_read_b64_tr_b16 v[106:107], v31 offset:26624
  v_mfma_f32_16x16x32_bf16 v[116:119], v[124:127], v[148:151], v[116:119]
  v_mfma_f32_16x16x32_bf16 v[56:59], v[148:151], v[148:151], v[56:59]
  v_mfma_f32_16x16x32_bf16 v[120:123], v[124:127], v[212:215], v[120:123]
  v_mfma_f32_16x16x32_bf16 v[60:63], v[212:215], v[212:215], v[60:63]
  s_waitcnt lgkmcnt(6)
  v_mfma_f32_16x16x32_bf16 v[64:67], v[152:155], v[112:115], v[64:67]
  ds_read_b128 v[156:159], v53 offset:32768
  ds_read_b128 v[220:223], v53 offset:36864
  ds_read_b64_tr_b16 v[108:109], v28 offset:28672
  v_mfma_f32_16x16x32_bf16 v[80:83], v[216:219], v[112:115], v[80:83]
  ds_read_b64_tr_b16 v[110:111], v28 offset:30720
  s_waitcnt lgkmcnt(8)
  v_mfma_f32_16x16x32_bf16 v[68:71], v[152:155], v[96:99], v[68:71]
  ds_read_b64_tr_b16 v[112:113], v29 offset:28672
  v_mfma_f32_16x16x32_bf16 v[84:87], v[216:219], v[96:99], v[84:87]
  ds_read_b64_tr_b16 v[114:115], v29 offset:30720
  s_waitcnt lgkmcnt(8)
  v_mfma_f32_16x16x32_bf16 v[72:75], v[152:155], v[100:103], v[72:75]
  ds_read_b64_tr_b16 v[96:97], v30 offset:28672
  v_mfma_f32_16x16x32_bf16 v[88:91], v[216:219], v[100:103], v[88:91]
  ds_read_b64_tr_b16 v[98:99], v30 offset:30720
  s_waitcnt lgkmcnt(8)
  v_mfma_f32_16x16x32_bf16 v[76:79], v[152:155], v[104:107], v[76:79]
  ds_read_b64_tr_b16 v[100:101], v31 offset:28672
  v_mfma_f32_16x16x32_bf16 v[92:95], v[216:219], v[104:107], v[92:95]
  ds_read_b64_tr_b16 v[102:103], v31 offset:30720
  v_mfma_f32_16x16x32_bf16 v[116:119], v[124:127], v[152:155], v[116:119]
  v_mfma_f32_16x16x32_bf16 v[56:59], v[152:155], v[152:155], v[56:59]
  v_mfma_f32_16x16x32_bf16 v[120:123], v[124:127], v[216:219], v[120:123]
  v_mfma_f32_16x16x32_bf16 v[60:63], v[216:219], v[216:219], v[60:63]
  s_waitcnt lgkmcnt(6)
  v_mfma_f32_16x16x32_bf16 v[64:67], v[156:159], v[108:111], v[64:67]
  s_barrier
  ds_read_b128 v[160:163], v50 offset:0
  ds_read_b128 v[224:227], v50 offset:4096
  ds_read_b64_tr_b16 v[104:105], v28 offset:32768
  v_mfma_f32_16x16x32_bf16 v[80:83], v[220:223], v[108:111], v[80:83]
  ds_read_b64_tr_b16 v[106:107], v28 offset:34816
  s_waitcnt lgkmcnt(8)
  v_mfma_f32_16x16x32_bf16 v[68:71], v[156:159], v[112:115], v[68:71]
  ds_read_b64_tr_b16 v[108:109], v29 offset:32768
  v_mfma_f32_16x16x32_bf16 v[84:87], v[220:223], v[112:115], v[84:87]
  ds_read_b64_tr_b16 v[110:111], v29 offset:34816
  s_waitcnt lgkmcnt(8)
  v_mfma_f32_16x16x32_bf16 v[72:75], v[156:159], v[96:99], v[72:75]
  ds_read_b64_tr_b16 v[112:113], v30 offset:32768
  v_mfma_f32_16x16x32_bf16 v[88:91], v[220:223], v[96:99], v[88:91]
  ds_read_b64_tr_b16 v[114:115], v30 offset:34816
  s_waitcnt lgkmcnt(8)
  v_mfma_f32_16x16x32_bf16 v[76:79], v[156:159], v[100:103], v[76:79]
  ds_read_b64_tr_b16 v[96:97], v31 offset:32768
  v_mfma_f32_16x16x32_bf16 v[92:95], v[220:223], v[100:103], v[92:95]
  ds_read_b64_tr_b16 v[98:99], v31 offset:34816
  v_mfma_f32_16x16x32_bf16 v[116:119], v[124:127], v[156:159], v[116:119]
  v_mfma_f32_16x16x32_bf16 v[56:59], v[156:159], v[156:159], v[56:59]
  v_mfma_f32_16x16x32_bf16 v[120:123], v[124:127], v[220:223], v[120:123]
  v_mfma_f32_16x16x32_bf16 v[60:63], v[220:223], v[220:223], v[60:63]
  s_waitcnt lgkmcnt(6)
  v_mfma_f32_16x16x32_bf16 v[64:67], v[160:163], v[104:107], v[64:67]
  v_add_u32 v28, 0x10000, v20
  v_xor_b32 v29, 32, v20
  v_add_u32 v29, 0x10000, v29
  v_xor_b32 v30, 64, v20
  v_add_u32 v30, 0x10000, v30
  v_xor_b32 v31, 96, v20
  v_add_u32 v31, 0x10000, v31
  ds_read_b128 v[164:167], v51 offset:0
  ds_read_b128 v[228:231], v51 offset:4096
  ds_read_b64_tr_b16 v[100:101], v28 offset:0
  v_mfma_f32_16x16x32_bf16 v[80:83], v[224:227], v[104:107], v[80:83]
  ds_read_b64_tr_b16 v[102:103], v28 offset:2048
  s_waitcnt lgkmcnt(8)
  v_mfma_f32_16x16x32_bf16 v[68:71], v[160:163], v[108:111], v[68:71]
  ds_read_b64_tr_b16 v[104:105], v29 offset:0
  v_mfma_f32_16x16x32_bf16 v[84:87], v[224:227], v[108:111], v[84:87]
  ds_read_b64_tr_b16 v[106:107], v29 offset:2048
  s_waitcnt lgkmcnt(8)
  v_mfma_f32_16x16x32_bf16 v[72:75], v[160:163], v[112:115], v[72:75]
  ds_read_b64_tr_b16 v[108:109], v30 offset:0
  v_mfma_f32_16x16x32_bf16 v[88:91], v[224:227], v[112:115], v[88:91]
  ds_read_b64_tr_b16 v[110:111], v30 offset:2048
  s_waitcnt lgkmcnt(8)
  v_mfma_f32_16x16x32_bf16 v[76:79], v[160:163], v[96:99], v[76:79]
  ds_read_b64_tr_b16 v[112:113], v31 offset:0
  v_mfma_f32_16x16x32_bf16 v[92:95], v[224:227], v[96:99], v[92:95]
  ds_read_b64_tr_b16 v[114:115], v31 offset:2048
  v_mfma_f32_16x16x32_bf16 v[116:119], v[124:127], v[160:163], v[116:119]
  v_mfma_f32_16x16x32_bf16 v[56:59], v[160:163], v[160:163], v[56:59]
  v_mfma_f32_16x16x32_bf16 v[120:123], v[124:127], v[224:227], v[120:123]
  v_mfma_f32_16x16x32_bf16 v[60:63], v[224:227], v[224:227], v[60:63]
  s_waitcnt lgkmcnt(6)
  v_mfma_f32_16x16x32_bf16 v[64:67], v[164:167], v[100:103], v[64:67]
  ds_read_b128 v[168:171], v52 offset:0
  ds_read_b128 v[232:235], v52 offset:4096
  ds_read_b64_tr_b16 v[96:97], v28 offset:4096
  v_mfma_f32_16x16x32_bf16 v[80:83], v[228:231], v[100:103], v[80:83]
  ds_read_b64_tr_b16 v[98:99], v28 offset:6144
  s_waitcnt lgkmcnt(8)
  v_mfma_f32_16x16x32_bf16 v[68:71], v[164:167], v[104:107], v[68:71]
  ds_read_b64_tr_b16 v[100:101], v29 offset:4096
  v_mfma_f32_16x16x32_bf16 v[84:87], v[228:231], v[104:107], v[84:87]
  ds_read_b64_tr_b16 v[102:103], v29 offset:6144
  s_waitcnt lgkmcnt(8)
  v_mfma_f32_16x16x32_bf16 v[72:75], v[164:167], v[108:111], v[72:75]
  ds_read_b64_tr_b16 v[104:105], v30 offset:4096
  v_mfma_f32_16x16x32_bf16 v[88:91], v[228:231], v[108:111], v[88:91]
  ds_read_b64_tr_b16 v[106:107], v30 offset:6144
  s_waitcnt lgkmcnt(8)
  v_mfma_f32_16x16x32_bf16 v[76:79], v[164:167], v[112:115], v[76:79]
  ds_read_b64_tr_b16 v[108:109], v31 offset:4096
  v_mfma_f32_16x16x32_bf16 v[92:95], v[228:231], v[112:115], v[92:95]
  ds_read_b64_tr_b16 v[110:111], v31 offset:6144
  v_mfma_f32_16x16x32_bf16 v[116:119], v[124:127], v[164:167], v[116:119]
  v_mfma_f32_16x16x32_bf16 v[56:59], v[164:167], v[164:167], v[56:59]
  v_mfma_f32_16x16x32_bf16 v[120:123], v[124:127], v[228:231], v[120:123]
  v_mfma_f32_16x16x32_bf16 v[60:63], v[228:231], v[228:231], v[60:63]
  s_waitcnt lgkmcnt(6)
  v_mfma_f32_16x16x32_bf16 v[64:67], v[168:171], v[96:99], v[64:67]
  ds_read_b128 v[172:175], v53 offset:0
  ds_read_b128 v[236:239], v53 offset:4096
  ds_read_b64_tr_b16 v[112:113], v28 offset:8192
  v_mfma_f32_16x16x32_bf16 v[80:83], v[232:235], v[96:99], v[80:83]
  ds_read_b64_tr_b16 v[114:115], v28 offset:10240
  s_waitcnt lgkmcnt(8)
  v_mfma_f32_16x16x32_bf16 v[68:71], v[168:171], v[100:103], v[68:71]
  ds_read_b64_tr_b16 v[96:97], v29 offset:8192
  v_mfma_f32_16x16x32_bf16 v[84:87], v[232:235], v[100:103], v[84:87]
  ds_read_b64_tr_b16 v[98:99], v29 offset:10240
  s_waitcnt lgkmcnt(8)
  v_mfma_f32_16x16x32_bf16 v[72:75], v[168:171], v[104:107], v[72:75]
  ds_read_b64_tr_b16 v[100:101], v30 offset:8192
  v_mfma_f32_16x16x32_bf16 v[88:91], v[232:235], v[104:107], v[88:91]
  ds_read_b64_tr_b16 v[102:103], v30 offset:10240
  s_waitcnt lgkmcnt(8)
  v_mfma_f32_16x16x32_bf16 v[76:79], v[168:171], v[108:111], v[76:79]
  ds_read_b64_tr_b16 v[104:105], v31 offset:8192
  v_mfma_f32_16x16x32_bf16 v[92:95], v[232:235], v[108:111], v[92:95]
  ds_read_b64_tr_b16 v[106:107], v31 offset:10240
  v_mfma_f32_16x16x32_bf16 v[116:119], v[124:127], v[168:171], v[116:119]
  v_mfma_f32_16x16x32_bf16 v[56:59], v[168:171], v[168:171], v[56:59]
  v_mfma_f32_16x16x32_bf16 v[120:123], v[124:127], v[232:235], v[120:123]
  v_mfma_f32_16x16x32_bf16 v[60:63], v[232:235], v[232:235], v[60:63]
  s_waitcnt lgkmcnt(6)
  v_mfma_f32_16x16x32_bf16 v[64:67], v[172:175], v[112:115], v[64:67]
  s_barrier
  ds_read_b128 v[176:179], v50 offset:32768
  ds_read_b128 v[240:243], v50 offset:36864
  ds_read_b64_tr_b16 v[108:109], v28 offset:12288
  v_mfma_f32_16x16x32_bf16 v[80:83], v[236:239], v[112:115], v[80:83]
  ds_read_b64_tr_b16 v[110:111], v28 offset:14336
  s_waitcnt lgkmcnt(8)
  v_mfma_f32_16x16x32_bf16 v[68:71], v[172:175], v[96:99], v[68:71]
  ds_read_b64_tr_b16 v[112:113], v29 offset:12288
  v_mfma_f32_16x16x32_bf16 v[84:87], v[236:239], v[96:99], v[84:87]
  ds_read_b64_tr_b16 v[114:115], v29 offset:14336
  s_waitcnt lgkmcnt(8)
  v_mfma_f32_16x16x32_bf16 v[72:75], v[172:175], v[100:103], v[72:75]
  ds_read_b64_tr_b16 v[96:97], v30 offset:12288
  v_mfma_f32_16x16x32_bf16 v[88:91], v[236:239], v[100:103], v[88:91]
  ds_read_b64_tr_b16 v[98:99], v30 offset:14336
  s_waitcnt lgkmcnt(8)
  v_mfma_f32_16x16x32_bf16 v[76:79], v[172:175], v[104:107], v[76:79]
  ds_read_b64_tr_b16 v[100:101], v31 offset:12288
  v_mfma_f32_16x16x32_bf16 v[92:95], v[236:239], v[104:107], v[92:95]
  ds_read_b64_tr_b16 v[102:103], v31 offset:14336
  v_mfma_f32_16x16x32_bf16 v[116:119], v[124:127], v[172:175], v[116:119]
  v_mfma_f32_16x16x32_bf16 v[56:59], v[172:175], v[172:175], v[56:59]
  v_mfma_f32_16x16x32_bf16 v[120:123], v[124:127], v[236:239], v[120:123]
  v_mfma_f32_16x16x32_bf16 v[60:63], v[236:239], v[236:239], v[60:63]
  s_waitcnt lgkmcnt(6)
  v_mfma_f32_16x16x32_bf16 v[64:67], v[176:179], v[108:111], v[64:67]
  ds_read_b128 v[180:183], v51 offset:32768
  ds_read_b128 v[244:247], v51 offset:36864
  ds_read_b64_tr_b16 v[104:105], v28 offset:16384
  v_mfma_f32_16x16x32_bf16 v[80:83], v[240:243], v[108:111], v[80:83]
  ds_read_b64_tr_b16 v[106:107], v28 offset:18432
  s_waitcnt lgkmcnt(8)
  v_mfma_f32_16x16x32_bf16 v[68:71], v[176:179], v[112:115], v[68:71]
  ds_read_b64_tr_b16 v[108:109], v29 offset:16384
  v_mfma_f32_16x16x32_bf16 v[84:87], v[240:243], v[112:115], v[84:87]
  ds_read_b64_tr_b16 v[110:111], v29 offset:18432
  s_waitcnt lgkmcnt(8)
  v_mfma_f32_16x16x32_bf16 v[72:75], v[176:179], v[96:99], v[72:75]
  ds_read_b64_tr_b16 v[112:113], v30 offset:16384
  v_mfma_f32_16x16x32_bf16 v[88:91], v[240:243], v[96:99], v[88:91]
  ds_read_b64_tr_b16 v[114:115], v30 offset:18432
  s_waitcnt lgkmcnt(8)
  v_mfma_f32_16x16x32_bf16 v[76:79], v[176:179], v[100:103], v[76:79]
  ds_read_b64_tr_b16 v[96:97], v31 offset:16384
  v_mfma_f32_16x16x32_bf16 v[92:95], v[240:243], v[100:103], v[92:95]
  ds_read_b64_tr_b16 v[98:99], v31 offset:18432
  v_mfma_f32_16x16x32_bf16 v[116:119], v[124:127], v[176:179], v[116:119]
  v_mfma_f32_16x16x32_bf16 v[56:59], v[176:179], v[176:179], v[56:59]
  v_mfma_f32_16x16x32_bf16 v[120:123], v[124:127], v[240:243], v[120:123]
  v_mfma_f32_16x16x32_bf16 v[60:63], v[240:243], v[240:243], v[60:63]
  s_waitcnt lgkmcnt(6)
  v_mfma_f32_16x16x32_bf16 v[64:67], v[180:183], v[104:107], v[64:67]
  ds_read_b128 v[184:187], v52 offset:32768
  ds_read_b128 v[248:251], v52 offset:36864
  ds_read_b64_tr_b16 v[100:101], v28 offset:20480
  v_mfma_f32_16x16x32_bf16 v[80:83], v[244:247], v[104:107], v[80:83]
  ds_read_b64_tr_b16 v[102:103], v28 offset:22528
  s_waitcnt lgkmcnt(8)
  v_mfma_f32_16x16x32_bf16 v[68:71], v[180:183], v[108:111], v[68:71]
  ds_read_b64_tr_b16 v[104:105], v29 offset:20480
  v_mfma_f32_16x16x32_bf16 v[84:87], v[244:247], v[108:111], v[84:87]
  ds_read_b64_tr_b16 v[106:107], v29 offset:22528
  s_waitcnt lgkmcnt(8)
  v_mfma_f32_16x16x32_bf16 v[72:75], v[180:183], v[112:115], v[72:75]
  ds_read_b64_tr_b16 v[108:109], v30 offset:20480
  v_mfma_f32_16x16x32_bf16 v[88:91], v[244:247], v[112:115], v[88:91]
  ds_read_b64_tr_b16 v[110:111], v30 offset:22528
  s_waitcnt lgkmcnt(8)
  v_mfma_f32_16x16x32_bf16 v[76:79], v[180:183], v[96:99], v[76:79]
  ds_read_b64_tr_b16 v[112:113], v31 offset:20480
  v_mfma_f32_16x16x32_bf16 v[92:95], v[244:247], v[96:99], v[92:95]
  ds_read_b64_tr_b16 v[114:115], v31 offset:22528
  v_mfma_f32_16x16x32_bf16 v[116:119], v[124:127], v[180:183], v[116:119]
  v_mfma_f32_16x16x32_bf16 v[56:59], v[180:183], v[180:183], v[56:59]
  v_mfma_f32_16x16x32_bf16 v[120:123], v[124:127], v[244:247], v[120:123]
  v_mfma_f32_16x16x32_bf16 v[60:63], v[244:247], v[244:247], v[60:63]
  s_waitcnt lgkmcnt(6)
  v_mfma_f32_16x16x32_bf16 v[64:67], v[184:187], v[100:103], v[64:67]
  ds_read_b128 v[188:191], v53 offset:32768
  ds_read_b128 v[252:255], v53 offset:36864
  ds_read_b64_tr_b16 v[96:97], v28 offset:24576
  v_mfma_f32_16x16x32_bf16 v[80:83], v[248:251], v[100:103], v[80:83]
  ds_read_b64_tr_b16 v[98:99], v28 offset:26624
  s_waitcnt lgkmcnt(8)
  v_mfma_f32_16x16x32_bf16 v[68:71], v[184:187], v[104:107], v[68:71]
  ds_read_b64_tr_b16 v[100:101], v29 offset:24576
  v_mfma_f32_16x16x32_bf16 v[84:87], v[248:251], v[104:107], v[84:87]
  ds_read_b64_tr_b16 v[102:103], v29 offset:26624
  s_waitcnt lgkmcnt(8)
  v_mfma_f32_16x16x32_bf16 v[72:75], v[184:187], v[108:111], v[72:75]
  ds_read_b64_tr_b16 v[104:105], v30 offset:24576
  v_mfma_f32_16x16x32_bf16 v[88:91], v[248:251], v[108:111], v[88:91]
  ds_read_b64_tr_b16 v[106:107], v30 offset:26624
  s_waitcnt lgkmcnt(8)
  v_mfma_f32_16x16x32_bf16 v[76:79], v[184:187], v[112:115], v[76:79]
  ds_read_b64_tr_b16 v[108:109], v31 offset:24576
  v_mfma_f32_16x16x32_bf16 v[92:95], v[248:251], v[112:115], v[92:95]
  ds_read_b64_tr_b16 v[110:111], v31 offset:26624
  v_mfma_f32_16x16x32_bf16 v[116:119], v[124:127], v[184:187], v[116:119]
  v_mfma_f32_16x16x32_bf16 v[56:59], v[184:187], v[184:187], v[56:59]
  v_mfma_f32_16x16x32_bf16 v[120:123], v[124:127], v[248:251], v[120:123]
  v_mfma_f32_16x16x32_bf16 v[60:63], v[248:251], v[248:251], v[60:63]
  s_waitcnt lgkmcnt(6)
  v_mfma_f32_16x16x32_bf16 v[64:67], v[188:191], v[96:99], v[64:67]
  v_mfma_f32_16x16x32_bf16 v[80:83], v[252:255], v[96:99], v[80:83]
  s_waitcnt lgkmcnt(4)
  v_mfma_f32_16x16x32_bf16 v[68:71], v[188:191], v[100:103], v[68:71]
  v_mfma_f32_16x16x32_bf16 v[84:87], v[252:255], v[100:103], v[84:87]
  s_waitcnt lgkmcnt(2)
  v_mfma_f32_16x16x32_bf16 v[72:75], v[188:191], v[104:107], v[72:75]
  v_mfma_f32_16x16x32_bf16 v[88:91], v[252:255], v[104:107], v[88:91]
  s_waitcnt lgkmcnt(0)
  v_mfma_f32_16x16x32_bf16 v[76:79], v[188:191], v[108:111], v[76:79]
  v_mfma_f32_16x16x32_bf16 v[92:95], v[252:255], v[108:111], v[92:95]
  v_mfma_f32_16x16x32_bf16 v[116:119], v[124:127], v[188:191], v[116:119]
  v_mfma_f32_16x16x32_bf16 v[56:59], v[188:191], v[188:191], v[56:59]
  v_mfma_f32_16x16x32_bf16 v[120:123], v[124:127], v[252:255], v[120:123]
  v_mfma_f32_16x16x32_bf16 v[60:63], v[252:255], v[252:255], v[60:63]
  s_barrier
  s_nop 7
KVJ_2:
  s_waitcnt vmcnt(0)
  s_cmp_eq_u32 s28, 0
  s_cbranch_scc0 S1_5
  v_and_b32 v25, 31, v0
  v_lshlrev_b32 v25, 7, v25
  v_lshrrev_b32 v26, 5, v0
  v_lshl_add_u32 v25, v26, 3, v25
  s_lshl_b32 s33, s53, 12
  s_lshl_b32 s34, s54, 6
  s_add_u32 s33, s33, s34
  v_add_u32 v25, s33, v25
  ds_read_b64 v[32:33], v25 offset:0
  ds_read_b64 v[36:37], v25 offset:16
  ds_read_b64 v[40:41], v25 offset:32
  ds_read_b64 v[44:45], v25 offset:48
  s_waitcnt lgkmcnt(0)
  v_and_b32 v35, 0xffff0000, v33
  v_lshlrev_b32 v34, 16, v33
  v_and_b32 v33, 0xffff0000, v32
  v_lshlrev_b32 v32, 16, v32
  v_and_b32 v39, 0xffff0000, v37
  v_lshlrev_b32 v38, 16, v37
  v_and_b32 v37, 0xffff0000, v36
  v_lshlrev_b32 v36, 16, v36
  v_and_b32 v43, 0xffff0000, v41
  v_lshlrev_b32 v42, 16, v41
  v_and_b32 v41, 0xffff0000, v40
  v_lshlrev_b32 v40, 16, v40
  v_and_b32 v47, 0xffff0000, v45
  v_lshlrev_b32 v46, 16, v45
  v_and_b32 v45, 0xffff0000, v44
  v_lshlrev_b32 v44, 16, v44
  v_and_b32 v25, 3, v0
  v_bfe_u32 v26, v0, 2, 2
  v_lshrrev_b32 v27, 4, v0
  v_mov_b32 v50, v116
  v_mov_b32 v51, v56
  v_cmp_eq_u32 vcc, 1, v25
  s_nop 1
  v_cndmask_b32 v51, v51, v57, vcc
  v_cmp_eq_u32 vcc, 2, v25
  s_nop 1
  v_cndmask_b32 v51, v51, v58, vcc
  v_cmp_eq_u32 vcc, 3, v25
  s_nop 1
  v_cndmask_b32 v51, v51, v59, vcc
  v_cmp_eq_u32 vcc, v26, v27
  s_nop 1
  v_cndmask_b32 v51, 0, v51, vcc
  v_mov_b32 v52, v120
  v_mov_b32 v53, v60
  v_cmp_eq_u32 vcc, 1, v25
  s_nop 1
  v_cndmask_b32 v53, v53, v61, vcc
  v_cmp_eq_u32 vcc, 2, v25
  s_nop 1
  v_cndmask_b32 v53, v53, v62, vcc
  v_cmp_eq_u32 vcc, 3, v25
  s_nop 1
  v_cndmask_b32 v53, v53, v63, vcc
  v_cmp_eq_u32 vcc, v26, v27
  s_nop 1
  v_cndmask_b32 v53, 0, v53, vcc
  v_mov_b32 v25, v51
  v_mov_b32 v26, v53
  s_nop 1
  v_permlane32_swap_b32 v51, v25
  v_permlane32_swap_b32 v53, v26
  s_nop 0
  v_add_f32 v51, v51, v25
  v_add_f32 v53, v53, v26
  v_mov_b32 v25, v51
  v_mov_b32 v26, v53
  s_nop 1
  v_permlane16_swap_b32 v51, v25
  v_permlane16_swap_b32 v53, v26
  s_nop 0
  v_add_f32 v51, v51, v25
  v_add_f32 v53, v53, v26
  s_branch SE_6
S1_5:
  v_pk_add_f32 v[116:117], v[116:117], v[118:119]
  v_pk_add_f32 v[120:121], v[120:121], v[122:123]
  v_pk_add_f32 v[116:117], v[116:117], v[120:121]
  v_mov_b32 v50, v116
  v_mov_b32 v51, v117
  v_pk_add_f32 v[56:57], v[56:57], v[58:59]
  v_pk_add_f32 v[60:61], v[60:61], v[62:63]
  v_pk_add_f32 v[56:57], v[56:57], v[60:61]
  v_mov_b32 v52, v56
  v_mov_b32 v53, v57
  v_mov_b32 v96, v50
  v_mov_b32 v97, v51
  v_mov_b32 v98, v52
  v_mov_b32 v99, v53
  s_nop 1
  v_permlane32_swap_b32 v50, v96
  v_permlane32_swap_b32 v51, v97
  v_permlane32_swap_b32 v52, v98
  v_permlane32_swap_b32 v53, v99
  s_nop 0
  v_add_f32 v50, v50, v96
  v_add_f32 v51, v51, v97
  v_add_f32 v52, v52, v98
  v_add_f32 v53, v53, v99
  v_mov_b32 v96, v50
  v_mov_b32 v97, v51
  v_mov_b32 v98, v52
  v_mov_b32 v99, v53
  s_nop 1
  v_permlane16_swap_b32 v50, v96
  v_permlane16_swap_b32 v51, v97
  v_permlane16_swap_b32 v52, v98
  v_permlane16_swap_b32 v53, v99
  s_nop 0
  v_add_f32 v50, v50, v96
  v_add_f32 v51, v51, v97
  v_add_f32 v52, v52, v98
  v_add_f32 v53, v53, v99
SE_6:
  v_and_b32 v25, 15, v0
  v_lshlrev_b32 v25, 2, v25
  v_add_u32 v25, 0x26f00, v25
  v_and_b32 v26, 0x30, v0
  ds_read_b32 v120, v25 offset:0
  ds_read_b32 v121, v25 offset:64
  ds_read_b32 v122, v25 offset:128
  ds_read_b32 v123, v25 offset:192
  v_mul_f32 v50, 0x3b000000, v50
  v_mul_f32 v51, 0x3b000000, v51
  v_fma_f32 v51, -v50, v50, v51
  v_max_f32 v51, 0, v51
  v_add_f32 v96, 0x3727c5ac, v51
  v_rsq_f32 v96, v96
  s_nop 0
  v_mov_b32 v56, v96
  v_mul_f32 v58, v56, v50
  v_sub_f32 v58, 0, v58
  v_mul_f32 v52, 0x3b000000, v52
  v_mul_f32 v53, 0x3b000000, v53
  v_fma_f32 v53, -v52, v52, v53
  v_max_f32 v53, 0, v53
  v_add_f32 v96, 0x3727c5ac, v53
  v_rsq_f32 v96, v96
  s_nop 0
  v_mov_b32 v60, v96
  v_mul_f32 v62, v60, v52
  v_sub_f32 v62, 0, v62
  ds_bpermute_b32 v96, v26, v56 offset:0
  ds_bpermute_b32 v100, v26, v58 offset:0
  ds_bpermute_b32 v97, v26, v56 offset:4
  ds_bpermute_b32 v101, v26, v58 offset:4
  ds_bpermute_b32 v98, v26, v56 offset:8
  ds_bpermute_b32 v102, v26, v58 offset:8
  ds_bpermute_b32 v99, v26, v56 offset:12
  ds_bpermute_b32 v103, v26, v58 offset:12
  ds_bpermute_b32 v104, v26, v60 offset:0
  ds_bpermute_b32 v108, v26, v62 offset:0
  ds_bpermute_b32 v105, v26, v60 offset:4
  ds_bpermute_b32 v109, v26, v62 offset:4
  ds_bpermute_b32 v106, v26, v60 offset:8
  ds_bpermute_b32 v110, v26, v62 offset:8
  ds_bpermute_b32 v107, v26, v60 offset:12
  ds_bpermute_b32 v111, v26, v62 offset:12
  s_waitcnt vmcnt(0) lgkmcnt(0)
  v_mov_b32 v112, v120
  v_mov_b32 v114, v121
  v_mov_b32 v116, v122
  v_mov_b32 v118, v123
  v_pk_mul_f32 v[64:65], v[64:65], v[96:97]
  v_pk_mul_f32 v[66:67], v[66:67], v[98:99]
  v_pk_mul_f32 v[68:69], v[68:69], v[96:97]
  v_pk_mul_f32 v[70:71], v[70:71], v[98:99]
  v_pk_mul_f32 v[72:73], v[72:73], v[96:97]
  v_pk_mul_f32 v[74:75], v[74:75], v[98:99]
  v_pk_mul_f32 v[76:77], v[76:77], v[96:97]
  v_pk_mul_f32 v[78:79], v[78:79], v[98:99]
  v_pk_fma_f32 v[64:65], v[100:101], v[112:113], v[64:65] op_sel_hi:[1,0,1]
  v_pk_fma_f32 v[66:67], v[102:103], v[112:113], v[66:67] op_sel_hi:[1,0,1]
  v_pk_fma_f32 v[68:69], v[100:101], v[114:115], v[68:69] op_sel_hi:[1,0,1]
  v_pk_fma_f32 v[70:71], v[102:103], v[114:115], v[70:71] op_sel_hi:[1,0,1]
  v_pk_fma_f32 v[72:73], v[100:101], v[116:117], v[72:73] op_sel_hi:[1,0,1]
  v_pk_fma_f32 v[74:75], v[102:103], v[116:117], v[74:75] op_sel_hi:[1,0,1]
  v_pk_fma_f32 v[76:77], v[100:101], v[118:119], v[76:77] op_sel_hi:[1,0,1]
  v_pk_fma_f32 v[78:79], v[102:103], v[118:119], v[78:79] op_sel_hi:[1,0,1]
  v_pk_mul_f32 v[80:81], v[80:81], v[104:105]
  v_pk_mul_f32 v[82:83], v[82:83], v[106:107]
  v_pk_mul_f32 v[84:85], v[84:85], v[104:105]
  v_pk_mul_f32 v[86:87], v[86:87], v[106:107]
  v_pk_mul_f32 v[88:89], v[88:89], v[104:105]
  v_pk_mul_f32 v[90:91], v[90:91], v[106:107]
  v_pk_mul_f32 v[92:93], v[92:93], v[104:105]
  v_pk_mul_f32 v[94:95], v[94:95], v[106:107]
  v_pk_fma_f32 v[80:81], v[108:109], v[112:113], v[80:81] op_sel_hi:[1,0,1]
  v_pk_fma_f32 v[82:83], v[110:111], v[112:113], v[82:83] op_sel_hi:[1,0,1]
  v_pk_fma_f32 v[84:85], v[108:109], v[114:115], v[84:85] op_sel_hi:[1,0,1]
  v_pk_fma_f32 v[86:87], v[110:111], v[114:115], v[86:87] op_sel_hi:[1,0,1]
  v_pk_fma_f32 v[88:89], v[108:109], v[116:117], v[88:89] op_sel_hi:[1,0,1]
  v_pk_fma_f32 v[90:91], v[110:111], v[116:117], v[90:91] op_sel_hi:[1,0,1]
  v_pk_fma_f32 v[92:93], v[108:109], v[118:119], v[92:93] op_sel_hi:[1,0,1]
  v_pk_fma_f32 v[94:95], v[110:111], v[118:119], v[94:95] op_sel_hi:[1,0,1]
  v_pk_mul_f32 v[96:97], v[64:65], s[88:89]
  v_pk_mul_f32 v[98:99], v[66:67], s[88:89]
  v_pk_mul_f32 v[100:101], v[68:69], s[88:89]
  v_pk_mul_f32 v[102:103], v[70:71], s[88:89]
  v_pk_mul_f32 v[104:105], v[80:81], s[88:89]
  v_pk_mul_f32 v[106:107], v[82:83], s[88:89]
  v_pk_mul_f32 v[108:109], v[84:85], s[88:89]
  v_pk_mul_f32 v[110:111], v[86:87], s[88:89]
  v_exp_f32_e64 v96, v96 clamp
  v_exp_f32_e64 v97, v97 clamp
  v_exp_f32_e64 v98, v98 clamp
  v_exp_f32_e64 v99, v99 clamp
  v_exp_f32_e64 v100, v100 clamp
  v_exp_f32_e64 v101, v101 clamp
  v_exp_f32_e64 v102, v102 clamp
  v_exp_f32_e64 v103, v103 clamp
  v_exp_f32_e64 v104, v104 clamp
  v_exp_f32_e64 v105, v105 clamp
  v_exp_f32_e64 v106, v106 clamp
  v_exp_f32_e64 v107, v107 clamp
  v_exp_f32_e64 v108, v108 clamp
  v_exp_f32_e64 v109, v109 clamp
  v_exp_f32_e64 v110, v110 clamp
  v_exp_f32_e64 v111, v111 clamp
  v_max_f32 v64, 0, v64
  v_max_f32 v65, 0, v65
  v_max_f32 v66, 0, v66
  v_max_f32 v67, 0, v67
  v_max_f32 v68, 0, v68
  v_max_f32 v69, 0, v69
  v_max_f32 v70, 0, v70
  v_max_f32 v71, 0, v71
  v_max_f32 v80, 0, v80
  v_max_f32 v81, 0, v81
  v_max_f32 v82, 0, v82
  v_max_f32 v83, 0, v83
  v_max_f32 v84, 0, v84
  v_max_f32 v85, 0, v85
  v_max_f32 v86, 0, v86
  v_max_f32 v87, 0, v87
  v_pk_add_f32 v[96:97], v[96:97], s[86:87]
  v_pk_add_f32 v[98:99], v[98:99], s[86:87]
  v_pk_add_f32 v[100:101], v[100:101], s[86:87]
  v_pk_add_f32 v[102:103], v[102:103], s[86:87]
  v_pk_add_f32 v[104:105], v[104:105], s[86:87]
  v_pk_add_f32 v[106:107], v[106:107], s[86:87]
  v_pk_add_f32 v[108:109], v[108:109], s[86:87]
  v_pk_add_f32 v[110:111], v[110:111], s[86:87]
  v_pk_add_f32 v[64:65], v[64:65], v[96:97]
  v_pk_add_f32 v[66:67], v[66:67], v[98:99]
  v_pk_add_f32 v[68:69], v[68:69], v[100:101]
  v_pk_add_f32 v[70:71], v[70:71], v[102:103]
  v_pk_add_f32 v[80:81], v[80:81], v[104:105]
  v_pk_add_f32 v[82:83], v[82:83], v[106:107]
  v_pk_add_f32 v[84:85], v[84:85], v[108:109]
  v_pk_add_f32 v[86:87], v[86:87], v[110:111]
  v_cvt_pk_bf16_f32 v64, v64, v65
  v_cvt_pk_bf16_f32 v65, v66, v67
  v_cvt_pk_bf16_f32 v66, v80, v81
  v_cvt_pk_bf16_f32 v67, v82, v83
  v_cvt_pk_bf16_f32 v68, v68, v69
  v_cvt_pk_bf16_f32 v69, v70, v71
  v_cvt_pk_bf16_f32 v70, v84, v85
  v_cvt_pk_bf16_f32 v71, v86, v87
  v_cvt_pk_bf16_f32 v72, v72, v73
  v_cvt_pk_bf16_f32 v73, v74, v75
  v_cvt_pk_bf16_f32 v74, v88, v89
  v_cvt_pk_bf16_f32 v75, v90, v91
  v_cvt_pk_bf16_f32 v76, v76, v77
  v_cvt_pk_bf16_f32 v77, v78, v79
  v_cvt_pk_bf16_f32 v78, v92, v93
  v_cvt_pk_bf16_f32 v79, v94, v95
  s_nop 1
  v_mfma_f32_16x16x32_bf16 v[80:83], v[64:67], v[72:75], 0
  v_mfma_f32_16x16x32_bf16 v[88:91], v[64:67], v[124:127], 0
  v_mfma_f32_16x16x32_bf16 v[84:87], v[68:71], v[76:79], 0
  v_mfma_f32_16x16x32_bf16 v[92:95], v[68:71], v[124:127], 0
  s_lshl_b32 s33, s22, 11
  s_add_u32 s33, s33, 0xc000
  v_lshlrev_b32 v25, 4, v0
  v_add_u32 v25, s33, v25
  s_lshl_b32 s33, s22, 7
  s_add_u32 s33, s33, 0xe000
  v_add_u32 v27, s33, v26
  s_nop 4
  ds_write_b128 v25, v[80:83]
  ds_write_b128 v25, v[84:87] offset:1024
  s_mov_b32 exec_lo, 0x10001
  s_mov_b32 exec_hi, 0x10001
  ds_write_b128 v27, v[88:91]
  ds_write_b128 v27, v[92:95] offset:64
  s_mov_b64 exec, -1
  s_waitcnt lgkmcnt(0)
  s_barrier
  s_branch KVST_7
  s_cmp_lt_u32 s22, 2
  s_cbranch_scc0 KVST_7
  s_lshl_b32 s33, s22, 10
  s_add_u32 s33, s33, 0xc000
  v_lshlrev_b32 v25, 2, v0
  v_add_u32 v27, s33, v25
  s_lshl_b32 s33, s22, 6
  s_add_u32 s33, s33, 0xe000
  v_add_u32 v50, s33, v25
  ds_read_b32 v64, v27 offset:0
  ds_read_b32 v65, v27 offset:256
  ds_read_b32 v66, v27 offset:512
  ds_read_b32 v67, v27 offset:768
  ds_read_b32 v68, v27 offset:2048
  ds_read_b32 v69, v27 offset:2304
  ds_read_b32 v70, v27 offset:2560
  ds_read_b32 v71, v27 offset:2816
  ds_read_b32 v72, v27 offset:4096
  ds_read_b32 v73, v27 offset:4352
  ds_read_b32 v74, v27 offset:4608
  ds_read_b32 v75, v27 offset:4864
  s_waitcnt lgkmcnt(4)
  ds_read_b32 v76, v27 offset:6144
  ds_read_b32 v77, v27 offset:6400
  ds_read_b32 v78, v27 offset:6656
  ds_read_b32 v79, v27 offset:6912
  ds_read_b32 v80, v50 offset:0
  ds_read_b32 v81, v50 offset:128
  ds_read_b32 v82, v50 offset:256
  ds_read_b32 v83, v50 offset:384
  s_mul_i32 s33, s26, 2176
  s_mul_i32 s34, s28, 34816
  s_add_u32 s33, s33, s34
  s_add_u32 s33, s33, 0xed0000
  s_lshl_b32 s34, s22, 10
  s_add_u32 s34, s34, s33
  s_lshl_b32 s35, s22, 6
  s_add_u32 s35, s35, s33
  s_add_u32 s35, s35, 2048
  s_waitcnt lgkmcnt(0)
  v_pk_add_f32 v[64:65], v[64:65], v[68:69]
  v_pk_add_f32 v[72:73], v[72:73], v[76:77]
  v_pk_add_f32 v[64:65], v[64:65], v[72:73]
  v_pk_add_f32 v[66:67], v[66:67], v[70:71]
  v_pk_add_f32 v[74:75], v[74:75], v[78:79]
  v_pk_add_f32 v[66:67], v[66:67], v[74:75]
  v_pk_add_f32 v[80:81], v[80:81], v[82:83]
  v_add_f32 v80, v80, v81
  buffer_atomic_add_f32 v64, v25, s[4:7], s34 offen offset:0
  buffer_atomic_add_f32 v65, v25, s[4:7], s34 offen offset:256
  buffer_atomic_add_f32 v66, v25, s[4:7], s34 offen offset:512
  buffer_atomic_add_f32 v67, v25, s[4:7], s34 offen offset:768
  s_mov_b64 exec, 0xffff
  buffer_atomic_add_f32 v80, v25, s[4:7], s35 offen
  s_mov_b64 exec, -1
  s_lshl_b32 s33, s28, 11
  s_lshl_b32 s34, s26, 7
  s_add_u32 s33, s33, s34
  s_lshl_b32 s34, s22, 6
  s_add_u32 s33, s33, s34
  s_lshl_b32 s34, s20, 3
  s_add_u32 s33, s33, s34
  s_lshl_b32 s34, s25, 2
  s_add_u32 s33, s33, s34
  s_add_u32 s33, s33, 0xf01000
  v_mov_b32 v54, s33
KVST_7:
  v_and_b32 v26, 0x30, v0
  v_add_u32 v26, 0x27000, v26
  ds_read_b128 v[80:83], v26
  ds_read_b128 v[84:87], v26 offset:64
  s_waitcnt lgkmcnt(0)
  v_mov_b32 v88, v56
  v_mov_b32 v90, v58
  v_mov_b32 v92, v60
  v_mov_b32 v94, v62
  s_barrier
  v_add_u32 v28, 0x17000, v21
  v_xor_b32 v29, 32, v21
  v_add_u32 v29, 0x17000, v29
  ds_read_b64_tr_b16 v[96:97], v28 offset:0
  ds_read_b64_tr_b16 v[98:99], v28 offset:1024
  ds_read_b64_tr_b16 v[100:101], v29 offset:0
  ds_read_b64_tr_b16 v[102:103], v29 offset:1024
  ds_read_b64_tr_b16 v[104:105], v28 offset:2048
  ds_read_b64_tr_b16 v[106:107], v28 offset:3072
  ds_read_b64_tr_b16 v[108:109], v29 offset:2048
  ds_read_b64_tr_b16 v[110:111], v29 offset:3072
  s_waitcnt lgkmcnt(6)
  v_mfma_f32_16x16x32_bf16 v[64:67], v[96:99], v[128:131], 0
  ds_read_b64_tr_b16 v[112:113], v28 offset:4096
  v_mfma_f32_16x16x32_bf16 v[72:75], v[96:99], v[192:195], 0
  ds_read_b64_tr_b16 v[114:115], v28 offset:5120
  s_waitcnt lgkmcnt(6)
  v_mfma_f32_16x16x32_bf16 v[68:71], v[100:103], v[128:131], 0
  ds_read_b64_tr_b16 v[116:117], v29 offset:4096
  v_mfma_f32_16x16x32_bf16 v[76:79], v[100:103], v[192:195], 0
  ds_read_b64_tr_b16 v[118:119], v29 offset:5120
  s_waitcnt lgkmcnt(6)
  v_mfma_f32_16x16x32_bf16 v[64:67], v[104:107], v[132:135], v[64:67]
  ds_read_b64_tr_b16 v[120:121], v28 offset:6144
  v_mfma_f32_16x16x32_bf16 v[72:75], v[104:107], v[196:199], v[72:75]
  ds_read_b64_tr_b16 v[122:123], v28 offset:7168
  s_waitcnt lgkmcnt(6)
  v_mfma_f32_16x16x32_bf16 v[68:71], v[108:111], v[132:135], v[68:71]
  ds_read_b64_tr_b16 v[124:125], v29 offset:6144
  v_mfma_f32_16x16x32_bf16 v[76:79], v[108:111], v[196:199], v[76:79]
  ds_read_b64_tr_b16 v[126:127], v29 offset:7168
  s_waitcnt lgkmcnt(6)
  v_mfma_f32_16x16x32_bf16 v[64:67], v[112:115], v[136:139], v[64:67]
  ds_read_b64_tr_b16 v[96:97], v28 offset:8192
  v_mfma_f32_16x16x32_bf16 v[72:75], v[112:115], v[200:203], v[72:75]
  ds_read_b64_tr_b16 v[98:99], v28 offset:9216
  s_waitcnt lgkmcnt(6)
  v_mfma_f32_16x16x32_bf16 v[68:71], v[116:119], v[136:139], v[68:71]
  ds_read_b64_tr_b16 v[100:101], v29 offset:8192
  v_mfma_f32_16x16x32_bf16 v[76:79], v[116:119], v[200:203], v[76:79]
  ds_read_b64_tr_b16 v[102:103], v29 offset:9216
  s_waitcnt lgkmcnt(6)
  v_mfma_f32_16x16x32_bf16 v[64:67], v[120:123], v[140:143], v[64:67]
  ds_read_b64_tr_b16 v[104:105], v28 offset:10240
  v_mfma_f32_16x16x32_bf16 v[72:75], v[120:123], v[204:207], v[72:75]
  ds_read_b64_tr_b16 v[106:107], v28 offset:11264
  s_waitcnt lgkmcnt(6)
  v_mfma_f32_16x16x32_bf16 v[68:71], v[124:127], v[140:143], v[68:71]
  ds_read_b64_tr_b16 v[108:109], v29 offset:10240
  v_mfma_f32_16x16x32_bf16 v[76:79], v[124:127], v[204:207], v[76:79]
  ds_read_b64_tr_b16 v[110:111], v29 offset:11264
  s_waitcnt lgkmcnt(6)
  v_mfma_f32_16x16x32_bf16 v[64:67], v[96:99], v[144:147], v[64:67]
  ds_read_b64_tr_b16 v[112:113], v28 offset:12288
  v_mfma_f32_16x16x32_bf16 v[72:75], v[96:99], v[208:211], v[72:75]
  ds_read_b64_tr_b16 v[114:115], v28 offset:13312
  s_waitcnt lgkmcnt(6)
  v_mfma_f32_16x16x32_bf16 v[68:71], v[100:103], v[144:147], v[68:71]
  ds_read_b64_tr_b16 v[116:117], v29 offset:12288
  v_mfma_f32_16x16x32_bf16 v[76:79], v[100:103], v[208:211], v[76:79]
  ds_read_b64_tr_b16 v[118:119], v29 offset:13312
  s_waitcnt lgkmcnt(6)
  v_mfma_f32_16x16x32_bf16 v[64:67], v[104:107], v[148:151], v[64:67]
  ds_read_b64_tr_b16 v[120:121], v28 offset:14336
  v_mfma_f32_16x16x32_bf16 v[72:75], v[104:107], v[212:215], v[72:75]
  ds_read_b64_tr_b16 v[122:123], v28 offset:15360
  s_waitcnt lgkmcnt(6)
  v_mfma_f32_16x16x32_bf16 v[68:71], v[108:111], v[148:151], v[68:71]
  ds_read_b64_tr_b16 v[124:125], v29 offset:14336
  v_mfma_f32_16x16x32_bf16 v[76:79], v[108:111], v[212:215], v[76:79]
  ds_read_b64_tr_b16 v[126:127], v29 offset:15360
  s_waitcnt lgkmcnt(6)
  v_mfma_f32_16x16x32_bf16 v[64:67], v[112:115], v[152:155], v[64:67]
  s_barrier
  ds_read_b64_tr_b16 v[96:97], v28 offset:16384
  v_mfma_f32_16x16x32_bf16 v[72:75], v[112:115], v[216:219], v[72:75]
  ds_read_b64_tr_b16 v[98:99], v28 offset:17408
  s_waitcnt lgkmcnt(6)
  v_mfma_f32_16x16x32_bf16 v[68:71], v[116:119], v[152:155], v[68:71]
  ds_read_b64_tr_b16 v[100:101], v29 offset:16384
  v_mfma_f32_16x16x32_bf16 v[76:79], v[116:119], v[216:219], v[76:79]
  ds_read_b64_tr_b16 v[102:103], v29 offset:17408
  s_waitcnt lgkmcnt(6)
  v_mfma_f32_16x16x32_bf16 v[64:67], v[120:123], v[156:159], v[64:67]
  ds_read_b64_tr_b16 v[104:105], v28 offset:18432
  v_mfma_f32_16x16x32_bf16 v[72:75], v[120:123], v[220:223], v[72:75]
  ds_read_b64_tr_b16 v[106:107], v28 offset:19456
  s_waitcnt lgkmcnt(6)
  v_mfma_f32_16x16x32_bf16 v[68:71], v[124:127], v[156:159], v[68:71]
  ds_read_b64_tr_b16 v[108:109], v29 offset:18432
  v_mfma_f32_16x16x32_bf16 v[76:79], v[124:127], v[220:223], v[76:79]
  ds_read_b64_tr_b16 v[110:111], v29 offset:19456
  s_waitcnt lgkmcnt(6)
  v_mfma_f32_16x16x32_bf16 v[64:67], v[96:99], v[160:163], v[64:67]
  ds_read_b64_tr_b16 v[112:113], v28 offset:20480
  v_mfma_f32_16x16x32_bf16 v[72:75], v[96:99], v[224:227], v[72:75]
  ds_read_b64_tr_b16 v[114:115], v28 offset:21504
  s_waitcnt lgkmcnt(6)
  v_mfma_f32_16x16x32_bf16 v[68:71], v[100:103], v[160:163], v[68:71]
  ds_read_b64_tr_b16 v[116:117], v29 offset:20480
  v_mfma_f32_16x16x32_bf16 v[76:79], v[100:103], v[224:227], v[76:79]
  ds_read_b64_tr_b16 v[118:119], v29 offset:21504
  s_waitcnt lgkmcnt(6)
  v_mfma_f32_16x16x32_bf16 v[64:67], v[104:107], v[164:167], v[64:67]
  ds_read_b64_tr_b16 v[120:121], v28 offset:22528
  v_mfma_f32_16x16x32_bf16 v[72:75], v[104:107], v[228:231], v[72:75]
  ds_read_b64_tr_b16 v[122:123], v28 offset:23552
  s_waitcnt lgkmcnt(6)
  v_mfma_f32_16x16x32_bf16 v[68:71], v[108:111], v[164:167], v[68:71]
  ds_read_b64_tr_b16 v[124:125], v29 offset:22528
  v_mfma_f32_16x16x32_bf16 v[76:79], v[108:111], v[228:231], v[76:79]
  ds_read_b64_tr_b16 v[126:127], v29 offset:23552
  s_waitcnt lgkmcnt(6)
  v_mfma_f32_16x16x32_bf16 v[64:67], v[112:115], v[168:171], v[64:67]
  ds_read_b64_tr_b16 v[96:97], v28 offset:24576
  v_mfma_f32_16x16x32_bf16 v[72:75], v[112:115], v[232:235], v[72:75]
  ds_read_b64_tr_b16 v[98:99], v28 offset:25600
  s_waitcnt lgkmcnt(6)
  v_mfma_f32_16x16x32_bf16 v[68:71], v[116:119], v[168:171], v[68:71]
  ds_read_b64_tr_b16 v[100:101], v29 offset:24576
  v_mfma_f32_16x16x32_bf16 v[76:79], v[116:119], v[232:235], v[76:79]
  ds_read_b64_tr_b16 v[102:103], v29 offset:25600
  s_waitcnt lgkmcnt(6)
  v_mfma_f32_16x16x32_bf16 v[64:67], v[120:123], v[172:175], v[64:67]
  ds_read_b64_tr_b16 v[104:105], v28 offset:26624
  v_mfma_f32_16x16x32_bf16 v[72:75], v[120:123], v[236:239], v[72:75]
  ds_read_b64_tr_b16 v[106:107], v28 offset:27648
  s_waitcnt lgkmcnt(6)
  v_mfma_f32_16x16x32_bf16 v[68:71], v[124:127], v[172:175], v[68:71]
  ds_read_b64_tr_b16 v[108:109], v29 offset:26624
  v_mfma_f32_16x16x32_bf16 v[76:79], v[124:127], v[236:239], v[76:79]
  ds_read_b64_tr_b16 v[110:111], v29 offset:27648
  s_waitcnt lgkmcnt(6)
  v_mfma_f32_16x16x32_bf16 v[64:67], v[96:99], v[176:179], v[64:67]
  ds_read_b64_tr_b16 v[112:113], v28 offset:28672
  v_mfma_f32_16x16x32_bf16 v[72:75], v[96:99], v[240:243], v[72:75]
  ds_read_b64_tr_b16 v[114:115], v28 offset:29696
  s_waitcnt lgkmcnt(6)
  v_mfma_f32_16x16x32_bf16 v[68:71], v[100:103], v[176:179], v[68:71]
  ds_read_b64_tr_b16 v[116:117], v29 offset:28672
  v_mfma_f32_16x16x32_bf16 v[76:79], v[100:103], v[240:243], v[76:79]
  ds_read_b64_tr_b16 v[118:119], v29 offset:29696
  s_waitcnt lgkmcnt(6)
  v_mfma_f32_16x16x32_bf16 v[64:67], v[104:107], v[180:183], v[64:67]
  ds_read_b64_tr_b16 v[120:121], v28 offset:30720
  v_mfma_f32_16x16x32_bf16 v[72:75], v[104:107], v[244:247], v[72:75]
  ds_read_b64_tr_b16 v[122:123], v28 offset:31744
  s_waitcnt lgkmcnt(6)
  v_mfma_f32_16x16x32_bf16 v[68:71], v[108:111], v[180:183], v[68:71]
  ds_read_b64_tr_b16 v[124:125], v29 offset:30720
  v_mfma_f32_16x16x32_bf16 v[76:79], v[108:111], v[244:247], v[76:79]
  ds_read_b64_tr_b16 v[126:127], v29 offset:31744
  s_waitcnt lgkmcnt(6)
  v_mfma_f32_16x16x32_bf16 v[64:67], v[112:115], v[184:187], v[64:67]
  v_mfma_f32_16x16x32_bf16 v[72:75], v[112:115], v[248:251], v[72:75]
  s_waitcnt lgkmcnt(4)
  v_mfma_f32_16x16x32_bf16 v[68:71], v[116:119], v[184:187], v[68:71]
  v_mfma_f32_16x16x32_bf16 v[76:79], v[116:119], v[248:251], v[76:79]
  s_waitcnt lgkmcnt(2)
  v_mfma_f32_16x16x32_bf16 v[64:67], v[120:123], v[188:191], v[64:67]
  v_mfma_f32_16x16x32_bf16 v[72:75], v[120:123], v[252:255], v[72:75]
  s_waitcnt lgkmcnt(0)
  v_mfma_f32_16x16x32_bf16 v[68:71], v[124:127], v[188:191], v[68:71]
  v_mfma_f32_16x16x32_bf16 v[76:79], v[124:127], v[252:255], v[76:79]
  s_barrier
  s_nop 7
  v_pk_mul_f32 v[64:65], v[64:65], v[88:89] op_sel_hi:[1,0]
  v_pk_mul_f32 v[66:67], v[66:67], v[88:89] op_sel_hi:[1,0]
  v_pk_fma_f32 v[64:65], v[80:81], v[90:91], v[64:65] op_sel_hi:[1,0,1]
  v_pk_fma_f32 v[66:67], v[82:83], v[90:91], v[66:67] op_sel_hi:[1,0,1]
  v_pk_mul_f32 v[68:69], v[68:69], v[88:89] op_sel_hi:[1,0]
  v_pk_mul_f32 v[70:71], v[70:71], v[88:89] op_sel_hi:[1,0]
  v_pk_fma_f32 v[68:69], v[84:85], v[90:91], v[68:69] op_sel_hi:[1,0,1]
  v_pk_fma_f32 v[70:71], v[86:87], v[90:91], v[70:71] op_sel_hi:[1,0,1]
  v_pk_mul_f32 v[72:73], v[72:73], v[92:93] op_sel_hi:[1,0]
  v_pk_mul_f32 v[74:75], v[74:75], v[92:93] op_sel_hi:[1,0]
  v_pk_fma_f32 v[72:73], v[80:81], v[94:95], v[72:73] op_sel_hi:[1,0,1]
  v_pk_fma_f32 v[74:75], v[82:83], v[94:95], v[74:75] op_sel_hi:[1,0,1]
  v_pk_mul_f32 v[76:77], v[76:77], v[92:93] op_sel_hi:[1,0]
  v_pk_mul_f32 v[78:79], v[78:79], v[92:93] op_sel_hi:[1,0]
  v_pk_fma_f32 v[76:77], v[84:85], v[94:95], v[76:77] op_sel_hi:[1,0,1]
  v_pk_fma_f32 v[78:79], v[86:87], v[94:95], v[78:79] op_sel_hi:[1,0,1]
  v_pk_mul_f32 v[96:97], v[64:65], s[88:89]
  v_pk_mul_f32 v[98:99], v[66:67], s[88:89]
  v_pk_mul_f32 v[100:101], v[68:69], s[88:89]
  v_pk_mul_f32 v[102:103], v[70:71], s[88:89]
  v_pk_mul_f32 v[104:105], v[72:73], s[88:89]
  v_pk_mul_f32 v[106:107], v[74:75], s[88:89]
  v_pk_mul_f32 v[108:109], v[76:77], s[88:89]
  v_pk_mul_f32 v[110:111], v[78:79], s[88:89]
  v_exp_f32_e64 v96, v96 clamp
  v_exp_f32_e64 v97, v97 clamp
  v_exp_f32_e64 v98, v98 clamp
  v_exp_f32_e64 v99, v99 clamp
  v_exp_f32_e64 v100, v100 clamp
  v_exp_f32_e64 v101, v101 clamp
  v_exp_f32_e64 v102, v102 clamp
  v_exp_f32_e64 v103, v103 clamp
  v_exp_f32_e64 v104, v104 clamp
  v_exp_f32_e64 v105, v105 clamp
  v_exp_f32_e64 v106, v106 clamp
  v_exp_f32_e64 v107, v107 clamp
  v_exp_f32_e64 v108, v108 clamp
  v_exp_f32_e64 v109, v109 clamp
  v_exp_f32_e64 v110, v110 clamp
  v_exp_f32_e64 v111, v111 clamp
  v_max_f32 v64, 0, v64
  v_max_f32 v65, 0, v65
  v_max_f32 v66, 0, v66
  v_max_f32 v67, 0, v67
  v_max_f32 v68, 0, v68
  v_max_f32 v69, 0, v69
  v_max_f32 v70, 0, v70
  v_max_f32 v71, 0, v71
  v_max_f32 v72, 0, v72
  v_max_f32 v73, 0, v73
  v_max_f32 v74, 0, v74
  v_max_f32 v75, 0, v75
  v_max_f32 v76, 0, v76
  v_max_f32 v77, 0, v77
  v_max_f32 v78, 0, v78
  v_max_f32 v79, 0, v79
  v_pk_add_f32 v[96:97], v[96:97], s[86:87]
  v_pk_add_f32 v[98:99], v[98:99], s[86:87]
  v_pk_add_f32 v[100:101], v[100:101], s[86:87]
  v_pk_add_f32 v[102:103], v[102:103], s[86:87]
  v_pk_add_f32 v[104:105], v[104:105], s[86:87]
  v_pk_add_f32 v[106:107], v[106:107], s[86:87]
  v_pk_add_f32 v[108:109], v[108:109], s[86:87]
  v_pk_add_f32 v[110:111], v[110:111], s[86:87]
  v_pk_add_f32 v[64:65], v[64:65], v[96:97]
  v_pk_add_f32 v[66:67], v[66:67], v[98:99]
  v_pk_add_f32 v[68:69], v[68:69], v[100:101]
  v_pk_add_f32 v[70:71], v[70:71], v[102:103]
  v_pk_add_f32 v[72:73], v[72:73], v[104:105]
  v_pk_add_f32 v[74:75], v[74:75], v[106:107]
  v_pk_add_f32 v[76:77], v[76:77], v[108:109]
  v_pk_add_f32 v[78:79], v[78:79], v[110:111]
  v_cvt_pk_bf16_f32 v56, v64, v65
  v_cvt_pk_bf16_f32 v57, v66, v67
  v_cvt_pk_bf16_f32 v58, v68, v69
  v_cvt_pk_bf16_f32 v59, v70, v71
  v_cvt_pk_bf16_f32 v60, v72, v73
  v_cvt_pk_bf16_f32 v61, v74, v75
  v_cvt_pk_bf16_f32 v62, v76, v77
  v_cvt_pk_bf16_f32 v63, v78, v79
  s_cmp_eq_u32 s28, 0
  s_cbranch_scc0 MODE_8
  v_and_b32 v26, 31, v0
  v_lshlrev_b32 v26, 2, v26
  s_lshl_b32 s33, s20, 7
  s_add_u32 s33, s33, 0xf07400
  s_add_u32 s40, s31, 0
  s_mov_b32 s39, 131072
POLL_9:
  buffer_load_dword v27, v26, s[4:7], s33 offen sc1
  s_waitcnt vmcnt(0)
  v_subrev_u32 v25, s40, v27
  v_cmp_gt_u32 vcc, 0x80, v25
  s_sub_u32 s39, s39, 1
  s_cbranch_scc1 POLLD_10
  s_cmp_eq_u64 vcc, -1
  s_cbranch_scc0 POLL_9
POLLD_10:
  v_and_b32 v27, 7, v27
  v_cmp_eq_u32 vcc, s32, v27
  s_nop 1
  s_cmp_eq_u64 vcc, -1
  s_cselect_b32 s27, 0, 1
MODE_8:
  s_lshl_b32 s33, s28, 11
  s_add_u32 s40, s31, 8
  s_mov_b32 s39, 131072
POLL_11:
  buffer_load_dword v27, v19, s[4:7], s33 offen sc1
  s_waitcnt vmcnt(0)
  v_subrev_u32 v25, s40, v27
  v_cmp_gt_u32 vcc, 0x80, v25
  s_sub_u32 s39, s39, 1
  s_cbranch_scc1 POLLD_12
  s_cmp_eq_u64 vcc, -1
  s_cbranch_scc0 POLL_11
POLLD_12:
  s_mul_i32 s33, s26, 2176
  s_mul_i32 s34, s28, 34816
  s_add_u32 s33, s33, s34
  s_add_u32 s33, s33, 0xed0000
  v_lshlrev_b32 v25, 4, v0
  v_and_b32 v26, 0x30, v0
  buffer_load_dwordx4 v[192:195], v25, s[4:7], s33 offen sc1
  buffer_load_dwordx4 v[196:199], v25, s[4:7], s33 offen offset:1024 sc1
  buffer_load_dwordx4 v[200:203], v26, s[4:7], s33 offen offset:2048 sc1
  buffer_load_dwordx4 v[204:207], v26, s[4:7], s33 offen offset:2112 sc1
  s_waitcnt vmcnt(0)
  v_cvt_pk_bf16_f32 v80, v192, v193
  v_cvt_pk_bf16_f32 v81, v194, v195
  v_cvt_pk_bf16_f32 v82, v196, v197
  v_cvt_pk_bf16_f32 v83, v198, v199
  v_cvt_pk_bf16_f32 v84, v200, v201
  v_cvt_pk_bf16_f32 v85, v202, v203
  v_cvt_pk_bf16_f32 v86, v204, v205
  v_cvt_pk_bf16_f32 v87, v206, v207
  s_nop 1
  v_mfma_f32_16x16x16_bf16 v[128:131], v[80:81], v[56:57], 0
  v_mfma_f32_16x16x16_bf16 v[144:147], v[84:85], v[56:57], 0
  v_mfma_f32_16x16x16_bf16 v[132:135], v[82:83], v[58:59], 0
  v_mfma_f32_16x16x16_bf16 v[148:151], v[86:87], v[58:59], 0
  v_mfma_f32_16x16x16_bf16 v[136:139], v[80:81], v[60:61], 0
  v_mfma_f32_16x16x16_bf16 v[152:155], v[84:85], v[60:61], 0
  v_mfma_f32_16x16x16_bf16 v[140:143], v[82:83], v[62:63], 0
  v_mfma_f32_16x16x16_bf16 v[156:159], v[86:87], v[62:63], 0
  s_lshl_b32 s33, s26, 10
  s_add_u32 s33, s33, s63
  s_add_u32 s34, s33, 0x4000
  s_nop 4
  v_add_f32 v144, s51, v144
  v_add_f32 v148, s51, v148
  v_add_f32 v152, s51, v152
  v_add_f32 v156, s51, v156
  v_rcp_f32 v144, v144
  v_rcp_f32 v148, v148
  v_rcp_f32 v152, v152
  v_rcp_f32 v156, v156
  s_nop 0
  v_mul_f32 v128, v128, v144
  v_mul_f32 v129, v129, v144
  v_mul_f32 v130, v130, v144
  v_mul_f32 v131, v131, v144
  v_mul_f32 v132, v132, v148
  v_mul_f32 v133, v133, v148
  v_mul_f32 v134, v134, v148
  v_mul_f32 v135, v135, v148
  v_mul_f32 v136, v136, v152
  v_mul_f32 v137, v137, v152
  v_mul_f32 v138, v138, v152
  v_mul_f32 v139, v139, v152
  v_mul_f32 v140, v140, v156
  v_mul_f32 v141, v141, v156
  v_mul_f32 v142, v142, v156
  v_mul_f32 v143, v143, v156
  v_cvt_pk_bf16_f32 v160, v128, v129
  v_cvt_pk_bf16_f32 v161, v130, v131
  v_cvt_pk_bf16_f32 v162, v132, v133
  v_cvt_pk_bf16_f32 v163, v134, v135
  v_cvt_pk_bf16_f32 v164, v136, v137
  v_cvt_pk_bf16_f32 v165, v138, v139
  v_cvt_pk_bf16_f32 v166, v140, v141
  v_cvt_pk_bf16_f32 v167, v142, v143
  s_cmp_eq_u32 s27, 0
  s_cbranch_scc1 STF_13
  buffer_store_dwordx4 v[160:163], v2, s[4:7], s33 offen sc1
  buffer_store_dwordx4 v[164:167], v2, s[4:7], s34 offen sc1
  s_branch STD_14
STF_13:
  buffer_store_dwordx4 v[160:163], v2, s[4:7], s33 offen
  buffer_store_dwordx4 v[164:167], v2, s[4:7], s34 offen
STD_14:
  s_add_u32 s38, s30, 1
  s_lshl_b32 s40, s38, 3
  s_add_u32 s40, s40, s31
  s_add_u32 s40, s40, s32
  v_mov_b32 v25, s40
  s_waitcnt vmcnt(0)
  s_mov_b64 exec, 1
  s_cmp_eq_u32 s27, 0
  s_cbranch_scc1 STF_15
  buffer_store_dword v25, v18, s[4:7], 0 offen sc1
  s_branch STD_16
STF_15:
  buffer_store_dword v25, v18, s[4:7], 0 offen
STD_16:
  s_mov_b64 exec, -1
  s_barrier
  v_add_u32 v28, 0x1f000, v23
  ds_read_b128 v[80:83], v24 offset:0
  ds_read_b64_tr_b16 v[84:85], v28 offset:0
  ds_read_b64_tr_b16 v[86:87], v28 offset:2048
  ds_read_b128 v[88:91], v24 offset:512
  ds_read_b64_tr_b16 v[92:93], v28 offset:1024
  ds_read_b64_tr_b16 v[94:95], v28 offset:3072
  ds_read_b128 v[96:99], v24 offset:1024
  ds_read_b64_tr_b16 v[100:101], v28 offset:4096
  ds_read_b64_tr_b16 v[102:103], v28 offset:6144
  ds_read_b128 v[104:107], v24 offset:1536
  ds_read_b64_tr_b16 v[108:109], v28 offset:5120
  ds_read_b64_tr_b16 v[110:111], v28 offset:7168
  s_waitcnt lgkmcnt(9)
  v_mfma_f32_32x32x16_bf16 v[64:79], v[84:87], v[80:83], 0
  ds_read_b128 v[112:115], v24 offset:2048
  ds_read_b64_tr_b16 v[116:117], v28 offset:8192
  ds_read_b64_tr_b16 v[118:119], v28 offset:10240
  s_waitcnt lgkmcnt(9)
  v_mfma_f32_32x32x16_bf16 v[64:79], v[92:95], v[88:91], v[64:79]
  ds_read_b128 v[80:83], v24 offset:2560
  ds_read_b64_tr_b16 v[84:85], v28 offset:9216
  ds_read_b64_tr_b16 v[86:87], v28 offset:11264
  s_waitcnt lgkmcnt(9)
  v_mfma_f32_32x32x16_bf16 v[64:79], v[100:103], v[96:99], v[64:79]
  ds_read_b128 v[88:91], v24 offset:3072
  ds_read_b64_tr_b16 v[92:93], v28 offset:12288
  ds_read_b64_tr_b16 v[94:95], v28 offset:14336
  s_waitcnt lgkmcnt(9)
  v_mfma_f32_32x32x16_bf16 v[64:79], v[108:111], v[104:107], v[64:79]
  ds_read_b128 v[96:99], v24 offset:3584
  ds_read_b64_tr_b16 v[100:101], v28 offset:13312
  ds_read_b64_tr_b16 v[102:103], v28 offset:15360
  s_waitcnt lgkmcnt(9)
  v_mfma_f32_32x32x16_bf16 v[64:79], v[116:119], v[112:115], v[64:79]
  s_barrier
  ds_read_b128 v[104:107], v24 offset:16384
  ds_read_b64_tr_b16 v[108:109], v28 offset:16384
  ds_read_b64_tr_b16 v[110:111], v28 offset:18432
  s_waitcnt lgkmcnt(9)
  v_mfma_f32_32x32x16_bf16 v[64:79], v[84:87], v[80:83], v[64:79]
  ds_read_b128 v[112:115], v24 offset:16896
  ds_read_b64_tr_b16 v[116:117], v28 offset:17408
  ds_read_b64_tr_b16 v[118:119], v28 offset:19456
  s_waitcnt lgkmcnt(9)
  v_mfma_f32_32x32x16_bf16 v[64:79], v[92:95], v[88:91], v[64:79]
  ds_read_b128 v[80:83], v24 offset:17408
  ds_read_b64_tr_b16 v[84:85], v28 offset:20480
  ds_read_b64_tr_b16 v[86:87], v28 offset:22528
  s_waitcnt lgkmcnt(9)
  v_mfma_f32_32x32x16_bf16 v[64:79], v[100:103], v[96:99], v[64:79]
  ds_read_b128 v[88:91], v24 offset:17920
  ds_read_b64_tr_b16 v[92:93], v28 offset:21504
  ds_read_b64_tr_b16 v[94:95], v28 offset:23552
  s_waitcnt lgkmcnt(9)
  v_mfma_f32_32x32x16_bf16 v[64:79], v[108:111], v[104:107], v[64:79]
  ds_read_b128 v[96:99], v24 offset:18432
  ds_read_b64_tr_b16 v[100:101], v28 offset:24576
  ds_read_b64_tr_b16 v[102:103], v28 offset:26624
  s_waitcnt lgkmcnt(9)
  v_mfma_f32_32x32x16_bf16 v[64:79], v[116:119], v[112:115], v[64:79]
  ds_read_b128 v[104:107], v24 offset:18944
  ds_read_b64_tr_b16 v[108:109], v28 offset:25600
  ds_read_b64_tr_b16 v[110:111], v28 offset:27648
  s_waitcnt lgkmcnt(9)
  v_mfma_f32_32x32x16_bf16 v[64:79], v[84:87], v[80:83], v[64:79]
  v_add_u32 v28, 0x10000, v23
  ds_read_b128 v[112:115], v24 offset:19456
  ds_read_b64_tr_b16 v[116:117], v28 offset:0
  ds_read_b64_tr_b16 v[118:119], v28 offset:2048
  s_waitcnt lgkmcnt(9)
  v_mfma_f32_32x32x16_bf16 v[64:79], v[92:95], v[88:91], v[64:79]
  ds_read_b128 v[80:83], v24 offset:19968
  ds_read_b64_tr_b16 v[84:85], v28 offset:1024
  ds_read_b64_tr_b16 v[86:87], v28 offset:3072
  s_waitcnt lgkmcnt(9)
  v_mfma_f32_32x32x16_bf16 v[64:79], v[100:103], v[96:99], v[64:79]
  s_barrier
  ds_read_b128 v[88:91], v24 offset:32768
  ds_read_b64_tr_b16 v[92:93], v28 offset:4096
  ds_read_b64_tr_b16 v[94:95], v28 offset:6144
  s_waitcnt lgkmcnt(9)
  v_mfma_f32_32x32x16_bf16 v[64:79], v[108:111], v[104:107], v[64:79]
  ds_read_b128 v[96:99], v24 offset:33280
  ds_read_b64_tr_b16 v[100:101], v28 offset:5120
  ds_read_b64_tr_b16 v[102:103], v28 offset:7168
  s_waitcnt lgkmcnt(9)
  v_mfma_f32_32x32x16_bf16 v[64:79], v[116:119], v[112:115], v[64:79]
  ds_read_b128 v[104:107], v24 offset:33792
  ds_read_b64_tr_b16 v[108:109], v28 offset:8192
  ds_read_b64_tr_b16 v[110:111], v28 offset:10240
  s_waitcnt lgkmcnt(9)
  v_mfma_f32_32x32x16_bf16 v[64:79], v[84:87], v[80:83], v[64:79]
  ds_read_b128 v[112:115], v24 offset:34304
  ds_read_b64_tr_b16 v[116:117], v28 offset:9216
  ds_read_b64_tr_b16 v[118:119], v28 offset:11264
  s_waitcnt lgkmcnt(9)
  v_mfma_f32_32x32x16_bf16 v[64:79], v[92:95], v[88:91], v[64:79]
  ds_read_b128 v[80:83], v24 offset:34816
  ds_read_b64_tr_b16 v[84:85], v28 offset:12288
  ds_read_b64_tr_b16 v[86:87], v28 offset:14336
  s_waitcnt lgkmcnt(9)
  v_mfma_f32_32x32x16_bf16 v[64:79], v[100:103], v[96:99], v[64:79]
  ds_read_b128 v[88:91], v24 offset:35328
  ds_read_b64_tr_b16 v[92:93], v28 offset:13312
  ds_read_b64_tr_b16 v[94:95], v28 offset:15360
  s_waitcnt lgkmcnt(9)
  v_mfma_f32_32x32x16_bf16 v[64:79], v[108:111], v[104:107], v[64:79]
  ds_read_b128 v[96:99], v24 offset:35840
  ds_read_b64_tr_b16 v[100:101], v28 offset:16384
  ds_read_b64_tr_b16 v[102:103], v28 offset:18432
  s_waitcnt lgkmcnt(9)
  v_mfma_f32_32x32x16_bf16 v[64:79], v[116:119], v[112:115], v[64:79]
  ds_read_b128 v[104:107], v24 offset:36352
  ds_read_b64_tr_b16 v[108:109], v28 offset:17408
  ds_read_b64_tr_b16 v[110:111], v28 offset:19456
  s_waitcnt lgkmcnt(9)
  v_mfma_f32_32x32x16_bf16 v[64:79], v[84:87], v[80:83], v[64:79]
  s_barrier
  ds_read_b128 v[112:115], v24 offset:49152
  ds_read_b64_tr_b16 v[116:117], v28 offset:20480
  ds_read_b64_tr_b16 v[118:119], v28 offset:22528
  s_waitcnt lgkmcnt(9)
  v_mfma_f32_32x32x16_bf16 v[64:79], v[92:95], v[88:91], v[64:79]
  ds_read_b128 v[80:83], v24 offset:49664
  ds_read_b64_tr_b16 v[84:85], v28 offset:21504
  ds_read_b64_tr_b16 v[86:87], v28 offset:23552
  s_waitcnt lgkmcnt(9)
  v_mfma_f32_32x32x16_bf16 v[64:79], v[100:103], v[96:99], v[64:79]
  ds_read_b128 v[88:91], v24 offset:50176
  ds_read_b64_tr_b16 v[92:93], v28 offset:24576
  ds_read_b64_tr_b16 v[94:95], v28 offset:26624
  s_waitcnt lgkmcnt(9)
  v_mfma_f32_32x32x16_bf16 v[64:79], v[108:111], v[104:107], v[64:79]
  ds_read_b128 v[96:99], v24 offset:50688
  ds_read_b64_tr_b16 v[100:101], v28 offset:25600
  ds_read_b64_tr_b16 v[102:103], v28 offset:27648
  s_waitcnt lgkmcnt(9)
  v_mfma_f32_32x32x16_bf16 v[64:79], v[116:119], v[112:115], v[64:79]
  ds_read_b128 v[104:107], v24 offset:51200
  ds_read_b64_tr_b16 v[108:109], v28 offset:28672
  ds_read_b64_tr_b16 v[110:111], v28 offset:30720
  s_waitcnt lgkmcnt(9)
  v_mfma_f32_32x32x16_bf16 v[64:79], v[84:87], v[80:83], v[64:79]
  ds_read_b128 v[112:115], v24 offset:51712
  ds_read_b64_tr_b16 v[116:117], v28 offset:29696
  ds_read_b64_tr_b16 v[118:119], v28 offset:31744
  s_waitcnt lgkmcnt(9)
  v_mfma_f32_32x32x16_bf16 v[64:79], v[92:95], v[88:91], v[64:79]
  ds_read_b128 v[80:83], v24 offset:52224
  ds_read_b64_tr_b16 v[84:85], v28 offset:32768
  ds_read_b64_tr_b16 v[86:87], v28 offset:34816
  s_waitcnt lgkmcnt(9)
  v_mfma_f32_32x32x16_bf16 v[64:79], v[100:103], v[96:99], v[64:79]
  ds_read_b128 v[88:91], v24 offset:52736
  ds_read_b64_tr_b16 v[92:93], v28 offset:33792
  ds_read_b64_tr_b16 v[94:95], v28 offset:35840
  s_waitcnt lgkmcnt(9)
  v_mfma_f32_32x32x16_bf16 v[64:79], v[108:111], v[104:107], v[64:79]
  s_waitcnt lgkmcnt(6)
  v_mfma_f32_32x32x16_bf16 v[64:79], v[116:119], v[112:115], v[64:79]
  s_waitcnt lgkmcnt(3)
  v_mfma_f32_32x32x16_bf16 v[64:79], v[84:87], v[80:83], v[64:79]
  s_waitcnt lgkmcnt(0)
  v_mfma_f32_32x32x16_bf16 v[64:79], v[92:95], v[88:91], v[64:79]
  s_nop 7
  s_nop 3
  v_pk_add_f32 v[32:33], v[32:33], v[64:65]
  v_pk_add_f32 v[34:35], v[34:35], v[66:67]
  v_pk_add_f32 v[36:37], v[36:37], v[68:69]
  v_pk_add_f32 v[38:39], v[38:39], v[70:71]
  v_pk_add_f32 v[40:41], v[40:41], v[72:73]
  v_pk_add_f32 v[42:43], v[42:43], v[74:75]
  v_pk_add_f32 v[44:45], v[44:45], v[76:77]
  v_pk_add_f32 v[46:47], v[46:47], v[78:79]
  v_cvt_pk_bf16_f32 v128, v32, v33
  v_cvt_pk_bf16_f32 v129, v34, v35
  v_cvt_pk_bf16_f32 v130, v40, v41
  v_cvt_pk_bf16_f32 v131, v42, v43
  v_cvt_pk_bf16_f32 v132, v36, v37
  v_cvt_pk_bf16_f32 v133, v38, v39
  v_cvt_pk_bf16_f32 v134, v44, v45
  v_cvt_pk_bf16_f32 v135, v46, v47
  s_mov_b32 s33, 0x280000
  s_cmp_eq_u32 s27, 0
  s_cbranch_scc1 STF_17
  buffer_store_dwordx4 v[128:131], v13, s[4:7], s33 offen sc1
  buffer_store_dwordx4 v[132:135], v13, s[4:7], s33 offen offset:512 sc1
  s_branch STD_18
STF_17:
  buffer_store_dwordx4 v[128:131], v13, s[4:7], s33 offen
  buffer_store_dwordx4 v[132:135], v13, s[4:7], s33 offen offset:512
STD_18:
  s_mov_b32 s34, 0xd80000
  v_pk_add_f32 v[136:137], v[32:33], v[34:35]
  v_pk_mul_f32 v[138:139], v[32:33], v[32:33]
  v_pk_fma_f32 v[138:139], v[34:35], v[34:35], v[138:139]
  v_pk_add_f32 v[136:137], v[136:137], v[36:37]
  v_pk_fma_f32 v[138:139], v[36:37], v[36:37], v[138:139]
  v_pk_add_f32 v[136:137], v[136:137], v[38:39]
  v_pk_fma_f32 v[138:139], v[38:39], v[38:39], v[138:139]
  v_pk_add_f32 v[136:137], v[136:137], v[40:41]
  v_pk_fma_f32 v[138:139], v[40:41], v[40:41], v[138:139]
  v_pk_add_f32 v[136:137], v[136:137], v[42:43]
  v_pk_fma_f32 v[138:139], v[42:43], v[42:43], v[138:139]
  v_pk_add_f32 v[136:137], v[136:137], v[44:45]
  v_pk_fma_f32 v[138:139], v[44:45], v[44:45], v[138:139]
  v_pk_add_f32 v[136:137], v[136:137], v[46:47]
  v_pk_fma_f32 v[138:139], v[46:47], v[46:47], v[138:139]
  v_add_f32 v136, v136, v137
  v_add_f32 v137, v138, v139
  v_mov_b32 v140, v136
  v_mov_b32 v141, v137
  s_nop 1
  v_permlane32_swap_b32 v136, v140
  v_permlane32_swap_b32 v137, v141
  s_nop 0
  v_add_f32 v136, v136, v140
  v_add_f32 v137, v137, v141
  s_mov_b32 exec_lo, 0xffffffff
  s_mov_b32 exec_hi, 0x0
  s_cmp_eq_u32 s27, 0
  s_cbranch_scc1 STF_19
  buffer_store_dwordx2 v[136:137], v11, s[4:7], s34 offen sc1
  s_branch STD_20
STF_19:
  buffer_store_dwordx2 v[136:137], v11, s[4:7], s34 offen
STD_20:
  s_mov_b64 exec, -1
  s_add_u32 s38, s30, 2
  s_lshl_b32 s40, s38, 3
  s_add_u32 s40, s40, s31
  s_add_u32 s40, s40, s32
  v_mov_b32 v25, s40
  s_waitcnt vmcnt(0)
  s_mov_b64 exec, 1
  s_cmp_eq_u32 s27, 0
  s_cbranch_scc1 STF_21
  buffer_store_dword v25, v18, s[4:7], 0 offen sc1
  s_branch STD_22
STF_21:
  buffer_store_dword v25, v18, s[4:7], 0 offen
STD_22:
  s_mov_b64 exec, -1
  v_lshrrev_b32 v26, 5, v0
  v_lshlrev_b32 v26, 4, v26
  s_lshl_b32 s34, s54, 7
  s_add_u32 s34, s34, 0x27080
  v_add_u32 v26, s34, v26
  ds_read_b128 v[144:147], v26 offset:0
  ds_read_b128 v[148:151], v26 offset:32
  ds_read_b128 v[152:155], v26 offset:64
  ds_read_b128 v[156:159], v26 offset:96
  s_waitcnt lgkmcnt(0)
  s_barrier
  v_add_u32 v28, 0x19000, v23
  ds_read_b128 v[80:83], v24 offset:0
  ds_read_b64_tr_b16 v[84:85], v28 offset:0
  ds_read_b64_tr_b16 v[86:87], v28 offset:2048
  ds_read_b128 v[88:91], v24 offset:512
  ds_read_b64_tr_b16 v[92:93], v28 offset:1024
  ds_read_b64_tr_b16 v[94:95], v28 offset:3072
  ds_read_b128 v[96:99], v24 offset:1024
  ds_read_b64_tr_b16 v[100:101], v28 offset:4096
  ds_read_b64_tr_b16 v[102:103], v28 offset:6144
  ds_read_b128 v[104:107], v24 offset:1536
  ds_read_b64_tr_b16 v[108:109], v28 offset:5120
  ds_read_b64_tr_b16 v[110:111], v28 offset:7168
  s_waitcnt lgkmcnt(9)
  v_mfma_f32_32x32x16_bf16 v[64:79], v[84:87], v[80:83], 0
  ds_read_b128 v[112:115], v24 offset:2048
  ds_read_b64_tr_b16 v[116:117], v28 offset:8192
  ds_read_b64_tr_b16 v[118:119], v28 offset:10240
  s_waitcnt lgkmcnt(9)
  v_mfma_f32_32x32x16_bf16 v[64:79], v[92:95], v[88:91], v[64:79]
  ds_read_b128 v[80:83], v24 offset:2560
  ds_read_b64_tr_b16 v[84:85], v28 offset:9216
  ds_read_b64_tr_b16 v[86:87], v28 offset:11264
  s_waitcnt lgkmcnt(9)
  v_mfma_f32_32x32x16_bf16 v[64:79], v[100:103], v[96:99], v[64:79]
  ds_read_b128 v[88:91], v24 offset:3072
  ds_read_b64_tr_b16 v[92:93], v28 offset:12288
  ds_read_b64_tr_b16 v[94:95], v28 offset:14336
  s_waitcnt lgkmcnt(9)
  v_mfma_f32_32x32x16_bf16 v[64:79], v[108:111], v[104:107], v[64:79]
  ds_read_b128 v[96:99], v24 offset:3584
  ds_read_b64_tr_b16 v[100:101], v28 offset:13312
  ds_read_b64_tr_b16 v[102:103], v28 offset:15360
  s_waitcnt lgkmcnt(9)
  v_mfma_f32_32x32x16_bf16 v[64:79], v[116:119], v[112:115], v[64:79]
  s_barrier
  ds_read_b128 v[104:107], v24 offset:16384
  ds_read_b64_tr_b16 v[108:109], v28 offset:16384
  ds_read_b64_tr_b16 v[110:111], v28 offset:18432
  s_waitcnt lgkmcnt(9)
  v_mfma_f32_32x32x16_bf16 v[64:79], v[84:87], v[80:83], v[64:79]
  ds_read_b128 v[112:115], v24 offset:16896
  ds_read_b64_tr_b16 v[116:117], v28 offset:17408
  ds_read_b64_tr_b16 v[118:119], v28 offset:19456
  s_waitcnt lgkmcnt(9)
  v_mfma_f32_32x32x16_bf16 v[64:79], v[92:95], v[88:91], v[64:79]
  ds_read_b128 v[80:83], v24 offset:17408
  ds_read_b64_tr_b16 v[84:85], v28 offset:20480
  ds_read_b64_tr_b16 v[86:87], v28 offset:22528
  s_waitcnt lgkmcnt(9)
  v_mfma_f32_32x32x16_bf16 v[64:79], v[100:103], v[96:99], v[64:79]
  ds_read_b128 v[88:91], v24 offset:17920
  ds_read_b64_tr_b16 v[92:93], v28 offset:21504
  ds_read_b64_tr_b16 v[94:95], v28 offset:23552
  s_waitcnt lgkmcnt(9)
  v_mfma_f32_32x32x16_bf16 v[64:79], v[108:111], v[104:107], v[64:79]
  ds_read_b128 v[96:99], v24 offset:18432
  ds_read_b64_tr_b16 v[100:101], v28 offset:24576
  ds_read_b64_tr_b16 v[102:103], v28 offset:26624
  s_mov_b32 s33, 0xd80000
  buffer_load_dwordx4 v[160:163], v9, s[4:7], s33 offen offset:0 sc1
  buffer_load_dwordx4 v[164:167], v9, s[4:7], s33 offen offset:512 sc1
  buffer_load_dwordx4 v[168:171], v9, s[4:7], s33 offen offset:1024 sc1
  buffer_load_dwordx4 v[172:175], v9, s[4:7], s33 offen offset:1536 sc1
  s_waitcnt lgkmcnt(9)
  v_mfma_f32_32x32x16_bf16 v[64:79], v[116:119], v[112:115], v[64:79]
  ds_read_b128 v[104:107], v24 offset:18944
  ds_read_b64_tr_b16 v[108:109], v28 offset:25600
  ds_read_b64_tr_b16 v[110:111], v28 offset:27648
  s_waitcnt lgkmcnt(9)
  v_mfma_f32_32x32x16_bf16 v[64:79], v[84:87], v[80:83], v[64:79]
  ds_read_b128 v[112:115], v24 offset:19456
  ds_read_b64_tr_b16 v[116:117], v28 offset:28672
  ds_read_b64_tr_b16 v[118:119], v28 offset:30720
  s_waitcnt lgkmcnt(9)
  v_mfma_f32_32x32x16_bf16 v[64:79], v[92:95], v[88:91], v[64:79]
  ds_read_b128 v[80:83], v24 offset:19968
  ds_read_b64_tr_b16 v[84:85], v28 offset:29696
  ds_read_b64_tr_b16 v[86:87], v28 offset:31744
  s_waitcnt lgkmcnt(9)
  v_mfma_f32_32x32x16_bf16 v[64:79], v[100:103], v[96:99], v[64:79]
  s_barrier
  ds_read_b128 v[88:91], v24 offset:32768
  ds_read_b64_tr_b16 v[92:93], v28 offset:32768
  ds_read_b64_tr_b16 v[94:95], v28 offset:34816
  s_waitcnt lgkmcnt(9)
  v_mfma_f32_32x32x16_bf16 v[64:79], v[108:111], v[104:107], v[64:79]
  ds_read_b128 v[96:99], v24 offset:33280
  ds_read_b64_tr_b16 v[100:101], v28 offset:33792
  ds_read_b64_tr_b16 v[102:103], v28 offset:35840
  s_waitcnt lgkmcnt(9)
  v_mfma_f32_32x32x16_bf16 v[64:79], v[116:119], v[112:115], v[64:79]
  ds_read_b128 v[104:107], v24 offset:33792
  ds_read_b64_tr_b16 v[108:109], v28 offset:36864
  ds_read_b64_tr_b16 v[110:111], v28 offset:38912
  s_waitcnt lgkmcnt(9)
  v_mfma_f32_32x32x16_bf16 v[64:79], v[84:87], v[80:83], v[64:79]
  ds_read_b128 v[112:115], v24 offset:34304
  ds_read_b64_tr_b16 v[116:117], v28 offset:37888
  ds_read_b64_tr_b16 v[118:119], v28 offset:39936
  s_waitcnt lgkmcnt(9)
  v_mfma_f32_32x32x16_bf16 v[64:79], v[92:95], v[88:91], v[64:79]
  ds_read_b128 v[80:83], v24 offset:34816
  ds_read_b64_tr_b16 v[84:85], v28 offset:40960
  ds_read_b64_tr_b16 v[86:87], v28 offset:43008
  s_waitcnt lgkmcnt(9)
  v_mfma_f32_32x32x16_bf16 v[64:79], v[100:103], v[96:99], v[64:79]
  ds_read_b128 v[88:91], v24 offset:35328
  ds_read_b64_tr_b16 v[92:93], v28 offset:41984
  ds_read_b64_tr_b16 v[94:95], v28 offset:44032
  s_waitcnt lgkmcnt(9)
  v_mfma_f32_32x32x16_bf16 v[64:79], v[108:111], v[104:107], v[64:79]
  ds_read_b128 v[96:99], v24 offset:35840
  ds_read_b64_tr_b16 v[100:101], v28 offset:45056
  ds_read_b64_tr_b16 v[102:103], v28 offset:47104
  s_waitcnt lgkmcnt(9)
  v_mfma_f32_32x32x16_bf16 v[64:79], v[116:119], v[112:115], v[64:79]
  ds_read_b128 v[104:107], v24 offset:36352
  ds_read_b64_tr_b16 v[108:109], v28 offset:46080
  ds_read_b64_tr_b16 v[110:111], v28 offset:48128
  s_waitcnt lgkmcnt(9)
  v_mfma_f32_32x32x16_bf16 v[64:79], v[84:87], v[80:83], v[64:79]
  s_barrier
  ds_read_b128 v[112:115], v24 offset:49152
  ds_read_b64_tr_b16 v[116:117], v28 offset:49152
  ds_read_b64_tr_b16 v[118:119], v28 offset:51200
  s_waitcnt lgkmcnt(9)
  v_mfma_f32_32x32x16_bf16 v[64:79], v[92:95], v[88:91], v[64:79]
  ds_read_b128 v[80:83], v24 offset:49664
  ds_read_b64_tr_b16 v[84:85], v28 offset:50176
  ds_read_b64_tr_b16 v[86:87], v28 offset:52224
  s_waitcnt lgkmcnt(9)
  v_mfma_f32_32x32x16_bf16 v[64:79], v[100:103], v[96:99], v[64:79]
  v_add_u32 v28, 0x10000, v23
  ds_read_b128 v[88:91], v24 offset:50176
  ds_read_b64_tr_b16 v[92:93], v28 offset:0
  ds_read_b64_tr_b16 v[94:95], v28 offset:2048
  s_waitcnt lgkmcnt(9)
  v_mfma_f32_32x32x16_bf16 v[64:79], v[108:111], v[104:107], v[64:79]
  ds_read_b128 v[96:99], v24 offset:50688
  ds_read_b64_tr_b16 v[100:101], v28 offset:1024
  ds_read_b64_tr_b16 v[102:103], v28 offset:3072
  s_waitcnt lgkmcnt(9)
  v_mfma_f32_32x32x16_bf16 v[64:79], v[116:119], v[112:115], v[64:79]
  ds_read_b128 v[104:107], v24 offset:51200
  ds_read_b64_tr_b16 v[108:109], v28 offset:4096
  ds_read_b64_tr_b16 v[110:111], v28 offset:6144
  s_waitcnt lgkmcnt(9)
  v_mfma_f32_32x32x16_bf16 v[64:79], v[84:87], v[80:83], v[64:79]
  ds_read_b128 v[112:115], v24 offset:51712
  ds_read_b64_tr_b16 v[116:117], v28 offset:5120
  ds_read_b64_tr_b16 v[118:119], v28 offset:7168
  s_waitcnt lgkmcnt(9)
  v_mfma_f32_32x32x16_bf16 v[64:79], v[92:95], v[88:91], v[64:79]
  ds_read_b128 v[80:83], v24 offset:52224
  ds_read_b64_tr_b16 v[84:85], v28 offset:8192
  ds_read_b64_tr_b16 v[86:87], v28 offset:10240
  s_waitcnt lgkmcnt(9)
  v_mfma_f32_32x32x16_bf16 v[64:79], v[100:103], v[96:99], v[64:79]
  ds_read_b128 v[88:91], v24 offset:52736
  ds_read_b64_tr_b16 v[92:93], v28 offset:9216
  ds_read_b64_tr_b16 v[94:95], v28 offset:11264
  s_waitcnt lgkmcnt(9)
  v_mfma_f32_32x32x16_bf16 v[64:79], v[108:111], v[104:107], v[64:79]
  s_waitcnt lgkmcnt(6)
  v_mfma_f32_32x32x16_bf16 v[64:79], v[116:119], v[112:115], v[64:79]
  s_waitcnt lgkmcnt(3)
  v_mfma_f32_32x32x16_bf16 v[64:79], v[84:87], v[80:83], v[64:79]
  s_waitcnt lgkmcnt(0)
  v_mfma_f32_32x32x16_bf16 v[64:79], v[92:95], v[88:91], v[64:79]
  s_nop 7
  s_nop 3
  s_waitcnt vmcnt(0)
  v_pk_add_f32 v[160:161], v[160:161], v[162:163]
  v_pk_add_f32 v[164:165], v[164:165], v[166:167]
  v_pk_add_f32 v[168:169], v[168:169], v[170:171]
  v_pk_add_f32 v[172:173], v[172:173], v[174:175]
  v_pk_add_f32 v[160:161], v[160:161], v[164:165]
  v_pk_add_f32 v[168:169], v[168:169], v[172:173]
  v_pk_add_f32 v[160:161], v[160:161], v[168:169]
  v_mov_b32 v162, v160
  v_mov_b32 v163, v161
  s_nop 1
  v_permlane32_swap_b32 v160, v162
  v_permlane32_swap_b32 v161, v163
  s_nop 0
  v_add_f32 v160, v160, v162
  v_add_f32 v161, v161, v163
  v_mul_f32 v160, 0x3b000000, v160
  v_mul_f32 v161, 0x3b000000, v161
  v_fma_f32 v161, -v160, v160, v161
  v_max_f32 v161, 0, v161
  v_add_f32 v168, 0x3727c5ac, v161
  v_rsq_f32 v168, v168
  s_nop 0
  v_mul_f32 v169, v168, v168
  v_mul_f32 v169, v169, v161
  v_add_f32 v169, 0x3727c5ac, v169
  v_rsq_f32 v169, v169
  s_nop 0
  v_mul_f32 v164, v168, v169
  v_mov_b32 v48, v160
  v_mov_b32 v49, v168
  v_mul_f32 v166, v164, v160
  v_sub_f32 v166, 0, v166
  v_pk_mul_f32 v[64:65], v[64:65], v[164:165] op_sel_hi:[1,0]
  v_pk_mul_f32 v[66:67], v[66:67], v[164:165] op_sel_hi:[1,0]
  v_pk_mul_f32 v[68:69], v[68:69], v[164:165] op_sel_hi:[1,0]
  v_pk_mul_f32 v[70:71], v[70:71], v[164:165] op_sel_hi:[1,0]
  v_pk_mul_f32 v[72:73], v[72:73], v[164:165] op_sel_hi:[1,0]
  v_pk_mul_f32 v[74:75], v[74:75], v[164:165] op_sel_hi:[1,0]
  v_pk_mul_f32 v[76:77], v[76:77], v[164:165] op_sel_hi:[1,0]
  v_pk_mul_f32 v[78:79], v[78:79], v[164:165] op_sel_hi:[1,0]
  v_pk_fma_f32 v[64:65], v[144:145], v[166:167], v[64:65] op_sel_hi:[1,0,1]
  v_pk_fma_f32 v[66:67], v[146:147], v[166:167], v[66:67] op_sel_hi:[1,0,1]
  v_pk_fma_f32 v[68:69], v[148:149], v[166:167], v[68:69] op_sel_hi:[1,0,1]
  v_pk_fma_f32 v[70:71], v[150:151], v[166:167], v[70:71] op_sel_hi:[1,0,1]
  v_pk_fma_f32 v[72:73], v[152:153], v[166:167], v[72:73] op_sel_hi:[1,0,1]
  v_pk_fma_f32 v[74:75], v[154:155], v[166:167], v[74:75] op_sel_hi:[1,0,1]
  v_pk_fma_f32 v[76:77], v[156:157], v[166:167], v[76:77] op_sel_hi:[1,0,1]
  v_pk_fma_f32 v[78:79], v[158:159], v[166:167], v[78:79] op_sel_hi:[1,0,1]
  v_mov_b32 v56, s44
  v_pk_mul_f32 v[176:177], v[64:65], v[64:65]
  v_pk_mul_f32 v[178:179], v[66:67], v[66:67]
  v_pk_mul_f32 v[180:181], v[68:69], v[68:69]
  v_pk_mul_f32 v[182:183], v[70:71], v[70:71]
  v_pk_mul_f32 v[184:185], v[72:73], v[72:73]
  v_pk_mul_f32 v[186:187], v[74:75], v[74:75]
  v_pk_mul_f32 v[188:189], v[76:77], v[76:77]
  v_pk_mul_f32 v[190:191], v[78:79], v[78:79]
  v_pk_fma_f32 v[176:177], v[176:177], s[46:47], v[56:57] op_sel_hi:[1,1,0]
  v_pk_fma_f32 v[178:179], v[178:179], s[46:47], v[56:57] op_sel_hi:[1,1,0]
  v_pk_fma_f32 v[180:181], v[180:181], s[46:47], v[56:57] op_sel_hi:[1,1,0]
  v_pk_fma_f32 v[182:183], v[182:183], s[46:47], v[56:57] op_sel_hi:[1,1,0]
  v_pk_fma_f32 v[184:185], v[184:185], s[46:47], v[56:57] op_sel_hi:[1,1,0]
  v_pk_fma_f32 v[186:187], v[186:187], s[46:47], v[56:57] op_sel_hi:[1,1,0]
  v_pk_fma_f32 v[188:189], v[188:189], s[46:47], v[56:57] op_sel_hi:[1,1,0]
  v_pk_fma_f32 v[190:191], v[190:191], s[46:47], v[56:57] op_sel_hi:[1,1,0]
  v_pk_mul_f32 v[176:177], v[176:177], v[64:65]
  v_pk_mul_f32 v[178:179], v[178:179], v[66:67]
  v_pk_mul_f32 v[180:181], v[180:181], v[68:69]
  v_pk_mul_f32 v[182:183], v[182:183], v[70:71]
  v_pk_mul_f32 v[184:185], v[184:185], v[72:73]
  v_pk_mul_f32 v[186:187], v[186:187], v[74:75]
  v_pk_mul_f32 v[188:189], v[188:189], v[76:77]
  v_pk_mul_f32 v[190:191], v[190:191], v[78:79]
  v_exp_f32 v176, v176
  v_exp_f32 v177, v177
  v_exp_f32 v178, v178
  v_exp_f32 v179, v179
  v_exp_f32 v180, v180
  v_exp_f32 v181, v181
  v_exp_f32 v182, v182
  v_exp_f32 v183, v183
  v_exp_f32 v184, v184
  v_exp_f32 v185, v185
  v_exp_f32 v186, v186
  v_exp_f32 v187, v187
  v_exp_f32 v188, v188
  v_exp_f32 v189, v189
  v_exp_f32 v190, v190
  v_exp_f32 v191, v191
  v_pk_add_f32 v[176:177], v[176:177], s[48:49]
  v_pk_add_f32 v[178:179], v[178:179], s[48:49]
  v_pk_add_f32 v[180:181], v[180:181], s[48:49]
  v_pk_add_f32 v[182:183], v[182:183], s[48:49]
  v_pk_add_f32 v[184:185], v[184:185], s[48:49]
  v_pk_add_f32 v[186:187], v[186:187], s[48:49]
  v_pk_add_f32 v[188:189], v[188:189], s[48:49]
  v_pk_add_f32 v[190:191], v[190:191], s[48:49]
  v_rcp_f32 v176, v176
  v_rcp_f32 v177, v177
  v_rcp_f32 v178, v178
  v_rcp_f32 v179, v179
  v_rcp_f32 v180, v180
  v_rcp_f32 v181, v181
  v_rcp_f32 v182, v182
  v_rcp_f32 v183, v183
  v_rcp_f32 v184, v184
  v_rcp_f32 v185, v185
  v_rcp_f32 v186, v186
  v_rcp_f32 v187, v187
  v_rcp_f32 v188, v188
  v_rcp_f32 v189, v189
  v_rcp_f32 v190, v190
  v_rcp_f32 v191, v191
  v_pk_mul_f32 v[64:65], v[64:65], v[176:177]
  v_pk_mul_f32 v[66:67], v[66:67], v[178:179]
  v_pk_mul_f32 v[68:69], v[68:69], v[180:181]
  v_pk_mul_f32 v[70:71], v[70:71], v[182:183]
  v_pk_mul_f32 v[72:73], v[72:73], v[184:185]
  v_pk_mul_f32 v[74:75], v[74:75], v[186:187]
  v_pk_mul_f32 v[76:77], v[76:77], v[188:189]
  v_pk_mul_f32 v[78:79], v[78:79], v[190:191]
  v_cvt_pk_bf16_f32 v128, v64, v65
  v_cvt_pk_bf16_f32 v129, v66, v67
  v_cvt_pk_bf16_f32 v130, v72, v73
  v_cvt_pk_bf16_f32 v131, v74, v75
  v_cvt_pk_bf16_f32 v132, v68, v69
  v_cvt_pk_bf16_f32 v133, v70, v71
  v_cvt_pk_bf16_f32 v134, v76, v77
  v_cvt_pk_bf16_f32 v135, v78, v79
  s_add_u32 s33, s63, 0x0
  s_cmp_eq_u32 s27, 0
  s_cbranch_scc1 STF_23
  buffer_store_dwordx4 v[128:131], v13, s[4:7], s33 offen sc1
  buffer_store_dwordx4 v[132:135], v13, s[4:7], s33 offen offset:512 sc1
  s_branch STD_24
STF_23:
  buffer_store_dwordx4 v[128:131], v13, s[4:7], s33 offen
  buffer_store_dwordx4 v[132:135], v13, s[4:7], s33 offen offset:512
STD_24:
  s_cmp_eq_u32 s23, 3
  s_cbranch_scc0 GH_26
  s_cmp_eq_u32 s53, 1
  s_cbranch_scc0 GH_27
  s_bitcmp1_b32 s24, 1
  s_cbranch_scc1 GH_27
  s_cmp_eq_u32 s20, 7
  s_cbranch_scc1 GH_27
  s_add_u32 s34, s20, 1
  s_mul_i32 s35, s34, 294912
  s_lshl_b32 s36, s34, 8
  s_mov_b32 exec_lo, 0xc0000000
  s_mov_b32 exec_hi, 0xc0000000
  s_branch GH_25
GH_26:
  s_cmp_eq_u32 s23, 0
  s_cbranch_scc0 GH_27
  s_cmp_eq_u32 s53, 0
  s_cbranch_scc0 GH_27
  s_bitcmp1_b32 s24, 1
  s_cbranch_scc0 GH_27
  s_cmp_eq_u32 s20, 0
  s_cbranch_scc1 GH_27
  s_sub_u32 s34, s20, 1
  s_mul_i32 s35, s34, 294912
  s_add_u32 s35, s35, 278528
  s_lshl_b32 s36, s34, 8
  s_add_u32 s36, s36, 128
  s_mov_b32 exec_lo, 0x3
  s_mov_b32 exec_hi, 0x3
GH_25:
  s_lshl_b32 s33, s24, 1
  s_add_u32 s33, s33, s54
  s_lshl_b32 s33, s33, 10
  s_add_u32 s35, s35, s33
  v_and_b32 v25, 0x3fff, v13
  v_and_b32 v25, 0x3ff, v25
  buffer_store_dwordx4 v[128:131], v25, s[4:7], s35 offen sc1
  buffer_store_dwordx4 v[132:135], v25, s[4:7], s35 offen offset:512 sc1
  s_mov_b64 exec, -1
  s_and_b32 s33, s24, 1
  s_lshr_b32 s34, s24, 2
  s_lshl_b32 s34, s34, 1
  s_add_u32 s33, s33, s34
  s_lshl_b32 s33, s33, 1
  s_add_u32 s33, s33, s54
  s_lshl_b32 s33, s33, 2
  s_add_u32 s36, s36, s33
  s_lshl_b32 s33, s28, 11
  s_add_u32 s36, s36, s33
  s_add_u32 s36, s36, 0xf02000
  s_add_u32 s38, s30, 3
  s_lshl_b32 s40, s38, 3
  s_add_u32 s40, s40, s31
  s_add_u32 s40, s40, s32
  v_mov_b32 v25, s36
  v_mov_b32 v26, s40
  s_waitcnt vmcnt(0)
  s_mov_b64 exec, 1
  buffer_store_dword v26, v25, s[4:7], 0 offen sc1
  s_mov_b64 exec, -1
GH_27:
  s_add_u32 s38, s30, 3
  s_lshl_b32 s40, s38, 3
  s_add_u32 s40, s40, s31
  s_add_u32 s40, s40, s32
  v_mov_b32 v25, s40
  s_waitcnt vmcnt(0)
  s_mov_b64 exec, 1
  s_cmp_eq_u32 s27, 0
  s_cbranch_scc1 STF_28
  buffer_store_dword v25, v18, s[4:7], 0 offen sc1
  s_branch STD_29
STF_28:
  buffer_store_dword v25, v18, s[4:7], 0 offen
STD_29:
  s_mov_b64 exec, -1
  s_barrier
  v_add_u32 v28, 0x13000, v23
  ds_read_b128 v[80:83], v24 offset:0
  ds_read_b64_tr_b16 v[84:85], v28 offset:0
  ds_read_b64_tr_b16 v[86:87], v28 offset:2048
  ds_read_b128 v[88:91], v24 offset:512
  ds_read_b64_tr_b16 v[92:93], v28 offset:1024
  ds_read_b64_tr_b16 v[94:95], v28 offset:3072
  ds_read_b128 v[96:99], v24 offset:1024
  ds_read_b64_tr_b16 v[100:101], v28 offset:4096
  ds_read_b64_tr_b16 v[102:103], v28 offset:6144
  ds_read_b128 v[104:107], v24 offset:1536
  ds_read_b64_tr_b16 v[108:109], v28 offset:5120
  ds_read_b64_tr_b16 v[110:111], v28 offset:7168
  s_waitcnt lgkmcnt(9)
  v_mfma_f32_32x32x16_bf16 v[64:79], v[84:87], v[80:83], 0
  ds_read_b128 v[112:115], v24 offset:2048
  ds_read_b64_tr_b16 v[116:117], v28 offset:8192
  ds_read_b64_tr_b16 v[118:119], v28 offset:10240
  s_waitcnt lgkmcnt(9)
  v_mfma_f32_32x32x16_bf16 v[64:79], v[92:95], v[88:91], v[64:79]
  ds_read_b128 v[80:83], v24 offset:2560
  ds_read_b64_tr_b16 v[84:85], v28 offset:9216
  ds_read_b64_tr_b16 v[86:87], v28 offset:11264
  s_waitcnt lgkmcnt(9)
  v_mfma_f32_32x32x16_bf16 v[64:79], v[100:103], v[96:99], v[64:79]
  ds_read_b128 v[88:91], v24 offset:3072
  ds_read_b64_tr_b16 v[92:93], v28 offset:12288
  ds_read_b64_tr_b16 v[94:95], v28 offset:14336
  s_waitcnt lgkmcnt(9)
  v_mfma_f32_32x32x16_bf16 v[64:79], v[108:111], v[104:107], v[64:79]
  ds_read_b128 v[96:99], v24 offset:3584
  ds_read_b64_tr_b16 v[100:101], v28 offset:13312
  ds_read_b64_tr_b16 v[102:103], v28 offset:15360
  s_waitcnt lgkmcnt(9)
  v_mfma_f32_32x32x16_bf16 v[64:79], v[116:119], v[112:115], v[64:79]
  s_barrier
  ds_read_b128 v[104:107], v24 offset:16384
  ds_read_b64_tr_b16 v[108:109], v28 offset:16384
  ds_read_b64_tr_b16 v[110:111], v28 offset:18432
  s_waitcnt lgkmcnt(9)
  v_mfma_f32_32x32x16_bf16 v[64:79], v[84:87], v[80:83], v[64:79]
  ds_read_b128 v[112:115], v24 offset:16896
  ds_read_b64_tr_b16 v[116:117], v28 offset:17408
  ds_read_b64_tr_b16 v[118:119], v28 offset:19456
  s_waitcnt lgkmcnt(9)
  v_mfma_f32_32x32x16_bf16 v[64:79], v[92:95], v[88:91], v[64:79]
  ds_read_b128 v[80:83], v24 offset:17408
  ds_read_b64_tr_b16 v[84:85], v28 offset:20480
  ds_read_b64_tr_b16 v[86:87], v28 offset:22528
  s_waitcnt lgkmcnt(9)
  v_mfma_f32_32x32x16_bf16 v[64:79], v[100:103], v[96:99], v[64:79]
  ds_read_b128 v[88:91], v24 offset:17920
  ds_read_b64_tr_b16 v[92:93], v28 offset:21504
  ds_read_b64_tr_b16 v[94:95], v28 offset:23552
  s_waitcnt lgkmcnt(9)
  v_mfma_f32_32x32x16_bf16 v[64:79], v[108:111], v[104:107], v[64:79]
  ds_read_b128 v[96:99], v24 offset:18432
  ds_read_b64_tr_b16 v[100:101], v28 offset:24576
  ds_read_b64_tr_b16 v[102:103], v28 offset:26624
  s_waitcnt lgkmcnt(9)
  v_mfma_f32_32x32x16_bf16 v[64:79], v[116:119], v[112:115], v[64:79]
  ds_read_b128 v[104:107], v24 offset:18944
  ds_read_b64_tr_b16 v[108:109], v28 offset:25600
  ds_read_b64_tr_b16 v[110:111], v28 offset:27648
  s_waitcnt lgkmcnt(9)
  v_mfma_f32_32x32x16_bf16 v[64:79], v[84:87], v[80:83], v[64:79]
  ds_read_b128 v[112:115], v24 offset:19456
  ds_read_b64_tr_b16 v[116:117], v28 offset:28672
  ds_read_b64_tr_b16 v[118:119], v28 offset:30720
  s_waitcnt lgkmcnt(9)
  v_mfma_f32_32x32x16_bf16 v[64:79], v[92:95], v[88:91], v[64:79]
  ds_read_b128 v[80:83], v24 offset:19968
  ds_read_b64_tr_b16 v[84:85], v28 offset:29696
  ds_read_b64_tr_b16 v[86:87], v28 offset:31744
  s_waitcnt lgkmcnt(9)
  v_mfma_f32_32x32x16_bf16 v[64:79], v[100:103], v[96:99], v[64:79]
  s_barrier
  ds_read_b128 v[88:91], v24 offset:32768
  ds_read_b64_tr_b16 v[92:93], v28 offset:32768
  ds_read_b64_tr_b16 v[94:95], v28 offset:34816
  s_waitcnt lgkmcnt(9)
  v_mfma_f32_32x32x16_bf16 v[64:79], v[108:111], v[104:107], v[64:79]
  ds_read_b128 v[96:99], v24 offset:33280
  ds_read_b64_tr_b16 v[100:101], v28 offset:33792
  ds_read_b64_tr_b16 v[102:103], v28 offset:35840
  s_waitcnt lgkmcnt(9)
  v_mfma_f32_32x32x16_bf16 v[64:79], v[116:119], v[112:115], v[64:79]
  ds_read_b128 v[104:107], v24 offset:33792
  ds_read_b64_tr_b16 v[108:109], v28 offset:36864
  ds_read_b64_tr_b16 v[110:111], v28 offset:38912
  s_waitcnt lgkmcnt(9)
  v_mfma_f32_32x32x16_bf16 v[64:79], v[84:87], v[80:83], v[64:79]
  ds_read_b128 v[112:115], v24 offset:34304
  ds_read_b64_tr_b16 v[116:117], v28 offset:37888
  ds_read_b64_tr_b16 v[118:119], v28 offset:39936
  s_waitcnt lgkmcnt(9)
  v_mfma_f32_32x32x16_bf16 v[64:79], v[92:95], v[88:91], v[64:79]
  ds_read_b128 v[80:83], v24 offset:34816
  ds_read_b64_tr_b16 v[84:85], v28 offset:40960
  ds_read_b64_tr_b16 v[86:87], v28 offset:43008
  s_waitcnt lgkmcnt(9)
  v_mfma_f32_32x32x16_bf16 v[64:79], v[100:103], v[96:99], v[64:79]
  ds_read_b128 v[88:91], v24 offset:35328
  ds_read_b64_tr_b16 v[92:93], v28 offset:41984
  ds_read_b64_tr_b16 v[94:95], v28 offset:44032
  s_waitcnt lgkmcnt(9)
  v_mfma_f32_32x32x16_bf16 v[64:79], v[108:111], v[104:107], v[64:79]
  ds_read_b128 v[96:99], v24 offset:35840
  ds_read_b64_tr_b16 v[100:101], v28 offset:45056
  ds_read_b64_tr_b16 v[102:103], v28 offset:47104
  s_waitcnt lgkmcnt(9)
  v_mfma_f32_32x32x16_bf16 v[64:79], v[116:119], v[112:115], v[64:79]
  ds_read_b128 v[104:107], v24 offset:36352
  ds_read_b64_tr_b16 v[108:109], v28 offset:46080
  ds_read_b64_tr_b16 v[110:111], v28 offset:48128
  s_waitcnt lgkmcnt(9)
  v_mfma_f32_32x32x16_bf16 v[64:79], v[84:87], v[80:83], v[64:79]
  s_barrier
  ds_read_b128 v[112:115], v24 offset:49152
  ds_read_b64_tr_b16 v[116:117], v28 offset:49152
  ds_read_b64_tr_b16 v[118:119], v28 offset:51200
  s_waitcnt lgkmcnt(9)
  v_mfma_f32_32x32x16_bf16 v[64:79], v[92:95], v[88:91], v[64:79]
  ds_read_b128 v[80:83], v24 offset:49664
  ds_read_b64_tr_b16 v[84:85], v28 offset:50176
  ds_read_b64_tr_b16 v[86:87], v28 offset:52224
  s_waitcnt lgkmcnt(9)
  v_mfma_f32_32x32x16_bf16 v[64:79], v[100:103], v[96:99], v[64:79]
  ds_read_b128 v[88:91], v24 offset:50176
  ds_read_b64_tr_b16 v[92:93], v28 offset:53248
  ds_read_b64_tr_b16 v[94:95], v28 offset:55296
  s_waitcnt lgkmcnt(9)
  v_mfma_f32_32x32x16_bf16 v[64:79], v[108:111], v[104:107], v[64:79]
  ds_read_b128 v[96:99], v24 offset:50688
  ds_read_b64_tr_b16 v[100:101], v28 offset:54272
  ds_read_b64_tr_b16 v[102:103], v28 offset:56320
  s_waitcnt lgkmcnt(9)
  v_mfma_f32_32x32x16_bf16 v[64:79], v[116:119], v[112:115], v[64:79]
  ds_read_b128 v[104:107], v24 offset:51200
  ds_read_b64_tr_b16 v[108:109], v28 offset:57344
  ds_read_b64_tr_b16 v[110:111], v28 offset:59392
  s_waitcnt lgkmcnt(9)
  v_mfma_f32_32x32x16_bf16 v[64:79], v[84:87], v[80:83], v[64:79]
  ds_read_b128 v[112:115], v24 offset:51712
  ds_read_b64_tr_b16 v[116:117], v28 offset:58368
  ds_read_b64_tr_b16 v[118:119], v28 offset:60416
  s_waitcnt lgkmcnt(9)
  v_mfma_f32_32x32x16_bf16 v[64:79], v[92:95], v[88:91], v[64:79]
  v_add_u32 v28, 0x22000, v23
  ds_read_b128 v[80:83], v24 offset:52224
  ds_read_b64_tr_b16 v[84:85], v28 offset:0
  ds_read_b64_tr_b16 v[86:87], v28 offset:2048
  s_waitcnt lgkmcnt(9)
  v_mfma_f32_32x32x16_bf16 v[64:79], v[100:103], v[96:99], v[64:79]
  ds_read_b128 v[88:91], v24 offset:52736
  ds_read_b64_tr_b16 v[92:93], v28 offset:1024
  ds_read_b64_tr_b16 v[94:95], v28 offset:3072
  s_waitcnt lgkmcnt(9)
  v_mfma_f32_32x32x16_bf16 v[64:79], v[108:111], v[104:107], v[64:79]
  s_waitcnt lgkmcnt(6)
  v_mfma_f32_32x32x16_bf16 v[64:79], v[116:119], v[112:115], v[64:79]
  s_waitcnt lgkmcnt(3)
  v_mfma_f32_32x32x16_bf16 v[64:79], v[84:87], v[80:83], v[64:79]
  s_waitcnt lgkmcnt(0)
  v_mfma_f32_32x32x16_bf16 v[64:79], v[92:95], v[88:91], v[64:79]
  s_nop 7
  s_nop 3
  v_mul_f32 v138, v48, v49
  v_sub_f32 v138, 0, v138
  v_mov_b32 v136, v49
  v_pk_fma_f32 v[64:65], v[32:33], v[136:137], v[64:65] op_sel_hi:[1,0,1]
  v_pk_fma_f32 v[66:67], v[34:35], v[136:137], v[66:67] op_sel_hi:[1,0,1]
  v_pk_fma_f32 v[68:69], v[36:37], v[136:137], v[68:69] op_sel_hi:[1,0,1]
  v_pk_fma_f32 v[70:71], v[38:39], v[136:137], v[70:71] op_sel_hi:[1,0,1]
  v_pk_fma_f32 v[72:73], v[40:41], v[136:137], v[72:73] op_sel_hi:[1,0,1]
  v_pk_fma_f32 v[74:75], v[42:43], v[136:137], v[74:75] op_sel_hi:[1,0,1]
  v_pk_fma_f32 v[76:77], v[44:45], v[136:137], v[76:77] op_sel_hi:[1,0,1]
  v_pk_fma_f32 v[78:79], v[46:47], v[136:137], v[78:79] op_sel_hi:[1,0,1]
  v_pk_add_f32 v[64:65], v[64:65], v[138:139] op_sel_hi:[1,0]
  v_pk_add_f32 v[66:67], v[66:67], v[138:139] op_sel_hi:[1,0]
  v_pk_add_f32 v[68:69], v[68:69], v[138:139] op_sel_hi:[1,0]
  v_pk_add_f32 v[70:71], v[70:71], v[138:139] op_sel_hi:[1,0]
  v_pk_add_f32 v[72:73], v[72:73], v[138:139] op_sel_hi:[1,0]
  v_pk_add_f32 v[74:75], v[74:75], v[138:139] op_sel_hi:[1,0]
  v_pk_add_f32 v[76:77], v[76:77], v[138:139] op_sel_hi:[1,0]
  v_pk_add_f32 v[78:79], v[78:79], v[138:139] op_sel_hi:[1,0]
  v_cvt_pk_bf16_f32 v128, v64, v65
  v_cvt_pk_bf16_f32 v129, v66, v67
  v_cvt_pk_bf16_f32 v130, v72, v73
  v_cvt_pk_bf16_f32 v131, v74, v75
  v_cvt_pk_bf16_f32 v132, v68, v69
  v_cvt_pk_bf16_f32 v133, v70, v71
  v_cvt_pk_bf16_f32 v134, v76, v77
  v_cvt_pk_bf16_f32 v135, v78, v79
  s_mov_b32 s33, 0x280000
  s_cmp_eq_u32 s27, 0
  s_cbranch_scc1 STF_30
  buffer_store_dwordx4 v[128:131], v13, s[4:7], s33 offen sc1
  buffer_store_dwordx4 v[132:135], v13, s[4:7], s33 offen offset:512 sc1
  s_branch STD_31
STF_30:
  buffer_store_dwordx4 v[128:131], v13, s[4:7], s33 offen
  buffer_store_dwordx4 v[132:135], v13, s[4:7], s33 offen offset:512
STD_31:
  s_mov_b32 s34, 0xd80000
  v_pk_add_f32 v[140:141], v[64:65], v[66:67]
  v_pk_mul_f32 v[142:143], v[64:65], v[64:65]
  v_pk_fma_f32 v[142:143], v[66:67], v[66:67], v[142:143]
  v_pk_add_f32 v[140:141], v[140:141], v[68:69]
  v_pk_fma_f32 v[142:143], v[68:69], v[68:69], v[142:143]
  v_pk_add_f32 v[140:141], v[140:141], v[70:71]
  v_pk_fma_f32 v[142:143], v[70:71], v[70:71], v[142:143]
  v_pk_add_f32 v[140:141], v[140:141], v[72:73]
  v_pk_fma_f32 v[142:143], v[72:73], v[72:73], v[142:143]
  v_pk_add_f32 v[140:141], v[140:141], v[74:75]
  v_pk_fma_f32 v[142:143], v[74:75], v[74:75], v[142:143]
  v_pk_add_f32 v[140:141], v[140:141], v[76:77]
  v_pk_fma_f32 v[142:143], v[76:77], v[76:77], v[142:143]
  v_pk_add_f32 v[140:141], v[140:141], v[78:79]
  v_pk_fma_f32 v[142:143], v[78:79], v[78:79], v[142:143]
  v_add_f32 v140, v140, v141
  v_add_f32 v141, v142, v143
  v_mov_b32 v144, v140
  v_mov_b32 v145, v141
  s_nop 1
  v_permlane32_swap_b32 v140, v144
  v_permlane32_swap_b32 v141, v145
  s_nop 0
  v_add_f32 v140, v140, v144
  v_add_f32 v141, v141, v145
  s_mov_b32 exec_lo, 0xffffffff
  s_mov_b32 exec_hi, 0x0
  s_cmp_eq_u32 s27, 0
  s_cbranch_scc1 STF_32
  buffer_store_dwordx2 v[140:141], v11, s[4:7], s34 offen sc1
  s_branch STD_33
STF_32:
  buffer_store_dwordx2 v[140:141], v11, s[4:7], s34 offen
STD_33:
  s_mov_b64 exec, -1
  v_pk_add_f32 v[32:33], v[32:33], v[64:65]
  v_pk_add_f32 v[34:35], v[34:35], v[66:67]
  v_pk_add_f32 v[36:37], v[36:37], v[68:69]
  v_pk_add_f32 v[38:39], v[38:39], v[70:71]
  v_pk_add_f32 v[40:41], v[40:41], v[72:73]
  v_pk_add_f32 v[42:43], v[42:43], v[74:75]
  v_pk_add_f32 v[44:45], v[44:45], v[76:77]
  v_pk_add_f32 v[46:47], v[46:47], v[78:79]
  s_add_u32 s38, s30, 4
  s_lshl_b32 s40, s38, 3
  s_add_u32 s40, s40, s31
  s_add_u32 s40, s40, s32
  v_mov_b32 v25, s40
  s_waitcnt vmcnt(0)
  s_mov_b64 exec, 1
  s_cmp_eq_u32 s27, 0
  s_cbranch_scc1 STF_34
  buffer_store_dword v25, v18, s[4:7], 0 offen sc1
  s_branch STD_35
STF_34:
  buffer_store_dword v25, v18, s[4:7], 0 offen
STD_35:
  s_mov_b64 exec, -1
  v_and_b32 v26, 0x30, v0
  v_add_u32 v26, 0x27180, v26
  ds_read_b128 v[64:67], v26 offset:0
  ds_read_b128 v[68:71], v26 offset:64
  ds_read_b128 v[72:75], v26 offset:128
  ds_read_b128 v[76:79], v26 offset:192
  ds_read_b128 v[80:83], v26 offset:256
  ds_read_b128 v[84:87], v26 offset:320
  ds_read_b128 v[88:91], v26 offset:384
  s_waitcnt lgkmcnt(0)
  s_lshl_b32 s94, s25, 13
  s_xor_b32 s94, s94, 0x0
  s_add_u32 s94, s94, 0x280000
  s_add_u32 s98, s94, 0x4000
  s_lshl_b32 s95, s25, 13
  s_xor_b32 s95, s95, 0x1000
  s_add_u32 s95, s95, 0x280000
  s_add_u32 s99, s95, 0x4000
  s_lshl_b32 s96, s25, 13
  s_xor_b32 s96, s96, 0x2000
  s_add_u32 s96, s96, 0x280000
  s_add_u32 s100, s96, 0x4000
  s_lshl_b32 s97, s25, 13
  s_xor_b32 s97, s97, 0x3000
  s_add_u32 s97, s97, 0x280000
  s_add_u32 s101, s97, 0x4000
  s_add_u32 s38, s30, 4
  s_lshl_b32 s40, s38, 3
  s_add_u32 s40, s40, s31
  s_mov_b32 s39, 131072
POLL_36:
  buffer_load_dword v27, v14, s[4:7], 0 offen sc1
  s_waitcnt vmcnt(0)
  v_subrev_u32 v25, s40, v27
  v_cmp_gt_u32 vcc, 0x80, v25
  s_sub_u32 s39, s39, 1
  s_cbranch_scc1 POLLD_37
  s_cmp_eq_u64 vcc, -1
  s_cbranch_scc0 POLL_36
POLLD_37:
  buffer_load_dwordx4 v[128:131], v2, s[4:7], s94 offen offset:0 sc1
  buffer_load_dwordx4 v[132:135], v2, s[4:7], s98 offen offset:0 sc1
  buffer_load_dwordx4 v[136:139], v2, s[4:7], s94 offen offset:1024 sc1
  buffer_load_dwordx4 v[140:143], v2, s[4:7], s98 offen offset:1024 sc1
  buffer_load_dwordx4 v[144:147], v2, s[4:7], s94 offen offset:2048 sc1
  buffer_load_dwordx4 v[148:151], v2, s[4:7], s98 offen offset:2048 sc1
  buffer_load_dwordx4 v[152:155], v2, s[4:7], s94 offen offset:3072 sc1
  buffer_load_dwordx4 v[156:159], v2, s[4:7], s98 offen offset:3072 sc1
  s_barrier
  v_add_u32 v28, 0x23000, v22
  ds_read_b64_tr_b16 v[96:97], v28 offset:0
  ds_read_b64_tr_b16 v[98:99], v28 offset:3584
  ds_read_b64_tr_b16 v[100:101], v28 offset:32
  ds_read_b64_tr_b16 v[102:103], v28 offset:3616
  ds_read_b64_tr_b16 v[104:105], v28 offset:64
  ds_read_b64_tr_b16 v[106:107], v28 offset:3648
  ds_read_b64_tr_b16 v[108:109], v28 offset:96
  ds_read_b64_tr_b16 v[110:111], v28 offset:3680
  s_waitcnt vmcnt(6) lgkmcnt(6)
  v_mfma_f32_16x16x32_bf16 v[192:195], v[96:99], v[128:131], 0
  ds_read_b64_tr_b16 v[112:113], v28 offset:128
  v_mfma_f32_16x16x32_bf16 v[220:223], v[96:99], v[132:135], 0
  ds_read_b64_tr_b16 v[114:115], v28 offset:3712
  s_waitcnt lgkmcnt(6)
  v_mfma_f32_16x16x32_bf16 v[196:199], v[100:103], v[128:131], 0
  ds_read_b64_tr_b16 v[116:117], v28 offset:160
  v_mfma_f32_16x16x32_bf16 v[224:227], v[100:103], v[132:135], 0
  ds_read_b64_tr_b16 v[118:119], v28 offset:3744
  buffer_load_dwordx4 v[160:163], v2, s[4:7], s95 offen offset:0 sc1
  buffer_load_dwordx4 v[164:167], v2, s[4:7], s99 offen offset:0 sc1
  s_waitcnt lgkmcnt(6)
  v_mfma_f32_16x16x32_bf16 v[200:203], v[104:107], v[128:131], 0
  ds_read_b64_tr_b16 v[120:121], v28 offset:192
  v_mfma_f32_16x16x32_bf16 v[228:231], v[104:107], v[132:135], 0
  ds_read_b64_tr_b16 v[122:123], v28 offset:3776
  s_waitcnt lgkmcnt(6)
  v_mfma_f32_16x16x32_bf16 v[204:207], v[108:111], v[128:131], 0
  ds_read_b64_tr_b16 v[124:125], v28 offset:7168
  v_mfma_f32_16x16x32_bf16 v[232:235], v[108:111], v[132:135], 0
  ds_read_b64_tr_b16 v[126:127], v28 offset:10752
  s_waitcnt lgkmcnt(6)
  v_mfma_f32_16x16x32_bf16 v[208:211], v[112:115], v[128:131], 0
  ds_read_b64_tr_b16 v[96:97], v28 offset:7200
  v_mfma_f32_16x16x32_bf16 v[236:239], v[112:115], v[132:135], 0
  ds_read_b64_tr_b16 v[98:99], v28 offset:10784
  s_waitcnt lgkmcnt(6)
  v_mfma_f32_16x16x32_bf16 v[212:215], v[116:119], v[128:131], 0
  ds_read_b64_tr_b16 v[100:101], v28 offset:7232
  v_mfma_f32_16x16x32_bf16 v[240:243], v[116:119], v[132:135], 0
  ds_read_b64_tr_b16 v[102:103], v28 offset:10816
  s_waitcnt lgkmcnt(6)
  v_mfma_f32_16x16x32_bf16 v[216:219], v[120:123], v[128:131], 0
  ds_read_b64_tr_b16 v[104:105], v28 offset:7264
  v_mfma_f32_16x16x32_bf16 v[244:247], v[120:123], v[132:135], 0
  ds_read_b64_tr_b16 v[106:107], v28 offset:10848
  s_waitcnt vmcnt(6) lgkmcnt(6)
  v_mfma_f32_16x16x32_bf16 v[192:195], v[124:127], v[136:139], v[192:195]
  ds_read_b64_tr_b16 v[108:109], v28 offset:7296
  v_mfma_f32_16x16x32_bf16 v[220:223], v[124:127], v[140:143], v[220:223]
  ds_read_b64_tr_b16 v[110:111], v28 offset:10880
  s_waitcnt lgkmcnt(6)
  v_mfma_f32_16x16x32_bf16 v[196:199], v[96:99], v[136:139], v[196:199]
  ds_read_b64_tr_b16 v[112:113], v28 offset:7328
  v_mfma_f32_16x16x32_bf16 v[224:227], v[96:99], v[140:143], v[224:227]
  ds_read_b64_tr_b16 v[114:115], v28 offset:10912
  buffer_load_dwordx4 v[168:171], v2, s[4:7], s95 offen offset:1024 sc1
  buffer_load_dwordx4 v[172:175], v2, s[4:7], s99 offen offset:1024 sc1
  s_waitcnt lgkmcnt(6)
  v_mfma_f32_16x16x32_bf16 v[200:203], v[100:103], v[136:139], v[200:203]
  ds_read_b64_tr_b16 v[116:117], v28 offset:7360
  v_mfma_f32_16x16x32_bf16 v[228:231], v[100:103], v[140:143], v[228:231]
  ds_read_b64_tr_b16 v[118:119], v28 offset:10944
  s_waitcnt lgkmcnt(6)
  v_mfma_f32_16x16x32_bf16 v[204:207], v[104:107], v[136:139], v[204:207]
  v_add_u32 v28, 0x10000, v22
  ds_read_b64_tr_b16 v[120:121], v28 offset:0
  v_mfma_f32_16x16x32_bf16 v[232:235], v[104:107], v[140:143], v[232:235]
  ds_read_b64_tr_b16 v[122:123], v28 offset:3584
  s_waitcnt lgkmcnt(6)
  v_mfma_f32_16x16x32_bf16 v[208:211], v[108:111], v[136:139], v[208:211]
  ds_read_b64_tr_b16 v[124:125], v28 offset:32
  v_mfma_f32_16x16x32_bf16 v[236:239], v[108:111], v[140:143], v[236:239]
  ds_read_b64_tr_b16 v[126:127], v28 offset:3616
  s_waitcnt lgkmcnt(6)
  v_mfma_f32_16x16x32_bf16 v[212:215], v[112:115], v[136:139], v[212:215]
  ds_read_b64_tr_b16 v[96:97], v28 offset:64
  v_mfma_f32_16x16x32_bf16 v[240:243], v[112:115], v[140:143], v[240:243]
  ds_read_b64_tr_b16 v[98:99], v28 offset:3648
  s_waitcnt lgkmcnt(6)
  v_mfma_f32_16x16x32_bf16 v[216:219], v[116:119], v[136:139], v[216:219]
  ds_read_b64_tr_b16 v[100:101], v28 offset:96
  v_mfma_f32_16x16x32_bf16 v[244:247], v[116:119], v[140:143], v[244:247]
  ds_read_b64_tr_b16 v[102:103], v28 offset:3680
  s_waitcnt vmcnt(6) lgkmcnt(6)
  v_mfma_f32_16x16x32_bf16 v[192:195], v[120:123], v[144:147], v[192:195]
  ds_read_b64_tr_b16 v[104:105], v28 offset:128
  v_mfma_f32_16x16x32_bf16 v[220:223], v[120:123], v[148:151], v[220:223]
  ds_read_b64_tr_b16 v[106:107], v28 offset:3712
  s_waitcnt lgkmcnt(6)
  v_mfma_f32_16x16x32_bf16 v[196:199], v[124:127], v[144:147], v[196:199]
  ds_read_b64_tr_b16 v[108:109], v28 offset:160
  v_mfma_f32_16x16x32_bf16 v[224:227], v[124:127], v[148:151], v[224:227]
  ds_read_b64_tr_b16 v[110:111], v28 offset:3744
  buffer_load_dwordx4 v[176:179], v2, s[4:7], s95 offen offset:2048 sc1
  buffer_load_dwordx4 v[180:183], v2, s[4:7], s99 offen offset:2048 sc1
  s_waitcnt lgkmcnt(6)
  v_mfma_f32_16x16x32_bf16 v[200:203], v[96:99], v[144:147], v[200:203]
  ds_read_b64_tr_b16 v[112:113], v28 offset:192
  v_mfma_f32_16x16x32_bf16 v[228:231], v[96:99], v[148:151], v[228:231]
  ds_read_b64_tr_b16 v[114:115], v28 offset:3776
  s_waitcnt lgkmcnt(6)
  v_mfma_f32_16x16x32_bf16 v[204:207], v[100:103], v[144:147], v[204:207]
  ds_read_b64_tr_b16 v[116:117], v28 offset:7168
  v_mfma_f32_16x16x32_bf16 v[232:235], v[100:103], v[148:151], v[232:235]
  ds_read_b64_tr_b16 v[118:119], v28 offset:10752
  s_waitcnt lgkmcnt(6)
  v_mfma_f32_16x16x32_bf16 v[208:211], v[104:107], v[144:147], v[208:211]
  ds_read_b64_tr_b16 v[120:121], v28 offset:7200
  v_mfma_f32_16x16x32_bf16 v[236:239], v[104:107], v[148:151], v[236:239]
  ds_read_b64_tr_b16 v[122:123], v28 offset:10784
  s_waitcnt lgkmcnt(6)
  v_mfma_f32_16x16x32_bf16 v[212:215], v[108:111], v[144:147], v[212:215]
  ds_read_b64_tr_b16 v[124:125], v28 offset:7232
  v_mfma_f32_16x16x32_bf16 v[240:243], v[108:111], v[148:151], v[240:243]
  ds_read_b64_tr_b16 v[126:127], v28 offset:10816
  s_waitcnt lgkmcnt(6)
  v_mfma_f32_16x16x32_bf16 v[216:219], v[112:115], v[144:147], v[216:219]
  ds_read_b64_tr_b16 v[96:97], v28 offset:7264
  v_mfma_f32_16x16x32_bf16 v[244:247], v[112:115], v[148:151], v[244:247]
  ds_read_b64_tr_b16 v[98:99], v28 offset:10848
  s_waitcnt vmcnt(6) lgkmcnt(6)
  v_mfma_f32_16x16x32_bf16 v[192:195], v[116:119], v[152:155], v[192:195]
  ds_read_b64_tr_b16 v[100:101], v28 offset:7296
  v_mfma_f32_16x16x32_bf16 v[220:223], v[116:119], v[156:159], v[220:223]
  ds_read_b64_tr_b16 v[102:103], v28 offset:10880
  s_waitcnt lgkmcnt(6)
  v_mfma_f32_16x16x32_bf16 v[196:199], v[120:123], v[152:155], v[196:199]
  ds_read_b64_tr_b16 v[104:105], v28 offset:7328
  v_mfma_f32_16x16x32_bf16 v[224:227], v[120:123], v[156:159], v[224:227]
  ds_read_b64_tr_b16 v[106:107], v28 offset:10912
  buffer_load_dwordx4 v[184:187], v2, s[4:7], s95 offen offset:3072 sc1
  buffer_load_dwordx4 v[188:191], v2, s[4:7], s99 offen offset:3072 sc1
  s_waitcnt lgkmcnt(6)
  v_mfma_f32_16x16x32_bf16 v[200:203], v[124:127], v[152:155], v[200:203]
  ds_read_b64_tr_b16 v[108:109], v28 offset:7360
  v_mfma_f32_16x16x32_bf16 v[228:231], v[124:127], v[156:159], v[228:231]
  ds_read_b64_tr_b16 v[110:111], v28 offset:10944
  s_waitcnt lgkmcnt(6)
  v_mfma_f32_16x16x32_bf16 v[204:207], v[96:99], v[152:155], v[204:207]
  s_barrier
  ds_read_b64_tr_b16 v[112:113], v28 offset:14336
  v_mfma_f32_16x16x32_bf16 v[232:235], v[96:99], v[156:159], v[232:235]
  ds_read_b64_tr_b16 v[114:115], v28 offset:17920
  s_waitcnt lgkmcnt(6)
  v_mfma_f32_16x16x32_bf16 v[208:211], v[100:103], v[152:155], v[208:211]
  ds_read_b64_tr_b16 v[116:117], v28 offset:14368
  v_mfma_f32_16x16x32_bf16 v[236:239], v[100:103], v[156:159], v[236:239]
  ds_read_b64_tr_b16 v[118:119], v28 offset:17952
  s_waitcnt lgkmcnt(6)
  v_mfma_f32_16x16x32_bf16 v[212:215], v[104:107], v[152:155], v[212:215]
  ds_read_b64_tr_b16 v[120:121], v28 offset:14400
  v_mfma_f32_16x16x32_bf16 v[240:243], v[104:107], v[156:159], v[240:243]
  ds_read_b64_tr_b16 v[122:123], v28 offset:17984
  s_waitcnt lgkmcnt(6)
  v_mfma_f32_16x16x32_bf16 v[216:219], v[108:111], v[152:155], v[216:219]
  ds_read_b64_tr_b16 v[124:125], v28 offset:14432
  v_mfma_f32_16x16x32_bf16 v[244:247], v[108:111], v[156:159], v[244:247]
  ds_read_b64_tr_b16 v[126:127], v28 offset:18016
  s_waitcnt vmcnt(6) lgkmcnt(6)
  v_mfma_f32_16x16x32_bf16 v[192:195], v[112:115], v[160:163], v[192:195]
  ds_read_b64_tr_b16 v[96:97], v28 offset:14464
  v_mfma_f32_16x16x32_bf16 v[220:223], v[112:115], v[164:167], v[220:223]
  ds_read_b64_tr_b16 v[98:99], v28 offset:18048
  s_waitcnt lgkmcnt(6)
  v_mfma_f32_16x16x32_bf16 v[196:199], v[116:119], v[160:163], v[196:199]
  ds_read_b64_tr_b16 v[100:101], v28 offset:14496
  v_mfma_f32_16x16x32_bf16 v[224:227], v[116:119], v[164:167], v[224:227]
  ds_read_b64_tr_b16 v[102:103], v28 offset:18080
  buffer_load_dwordx4 v[128:131], v2, s[4:7], s96 offen offset:0 sc1
  buffer_load_dwordx4 v[132:135], v2, s[4:7], s100 offen offset:0 sc1
  s_waitcnt lgkmcnt(6)
  v_mfma_f32_16x16x32_bf16 v[200:203], v[120:123], v[160:163], v[200:203]
  ds_read_b64_tr_b16 v[104:105], v28 offset:14528
  v_mfma_f32_16x16x32_bf16 v[228:231], v[120:123], v[164:167], v[228:231]
  ds_read_b64_tr_b16 v[106:107], v28 offset:18112
  s_waitcnt lgkmcnt(6)
  v_mfma_f32_16x16x32_bf16 v[204:207], v[124:127], v[160:163], v[204:207]
  ds_read_b64_tr_b16 v[108:109], v28 offset:21504
  v_mfma_f32_16x16x32_bf16 v[232:235], v[124:127], v[164:167], v[232:235]
  ds_read_b64_tr_b16 v[110:111], v28 offset:25088
  s_waitcnt lgkmcnt(6)
  v_mfma_f32_16x16x32_bf16 v[208:211], v[96:99], v[160:163], v[208:211]
  ds_read_b64_tr_b16 v[112:113], v28 offset:21536
  v_mfma_f32_16x16x32_bf16 v[236:239], v[96:99], v[164:167], v[236:239]
  ds_read_b64_tr_b16 v[114:115], v28 offset:25120
  s_waitcnt lgkmcnt(6)
  v_mfma_f32_16x16x32_bf16 v[212:215], v[100:103], v[160:163], v[212:215]
  ds_read_b64_tr_b16 v[116:117], v28 offset:21568
  v_mfma_f32_16x16x32_bf16 v[240:243], v[100:103], v[164:167], v[240:243]
  ds_read_b64_tr_b16 v[118:119], v28 offset:25152
  s_waitcnt lgkmcnt(6)
  v_mfma_f32_16x16x32_bf16 v[216:219], v[104:107], v[160:163], v[216:219]
  ds_read_b64_tr_b16 v[120:121], v28 offset:21600
  v_mfma_f32_16x16x32_bf16 v[244:247], v[104:107], v[164:167], v[244:247]
  ds_read_b64_tr_b16 v[122:123], v28 offset:25184
  s_waitcnt vmcnt(6) lgkmcnt(6)
  v_mfma_f32_16x16x32_bf16 v[192:195], v[108:111], v[168:171], v[192:195]
  ds_read_b64_tr_b16 v[124:125], v28 offset:21632
  v_mfma_f32_16x16x32_bf16 v[220:223], v[108:111], v[172:175], v[220:223]
  ds_read_b64_tr_b16 v[126:127], v28 offset:25216
  s_waitcnt lgkmcnt(6)
  v_mfma_f32_16x16x32_bf16 v[196:199], v[112:115], v[168:171], v[196:199]
  ds_read_b64_tr_b16 v[96:97], v28 offset:21664
  v_mfma_f32_16x16x32_bf16 v[224:227], v[112:115], v[172:175], v[224:227]
  ds_read_b64_tr_b16 v[98:99], v28 offset:25248
  buffer_load_dwordx4 v[136:139], v2, s[4:7], s96 offen offset:1024 sc1
  buffer_load_dwordx4 v[140:143], v2, s[4:7], s100 offen offset:1024 sc1
  s_waitcnt lgkmcnt(6)
  v_mfma_f32_16x16x32_bf16 v[200:203], v[116:119], v[168:171], v[200:203]
  ds_read_b64_tr_b16 v[100:101], v28 offset:21696
  v_mfma_f32_16x16x32_bf16 v[228:231], v[116:119], v[172:175], v[228:231]
  ds_read_b64_tr_b16 v[102:103], v28 offset:25280
  s_waitcnt lgkmcnt(6)
  v_mfma_f32_16x16x32_bf16 v[204:207], v[120:123], v[168:171], v[204:207]
  ds_read_b64_tr_b16 v[104:105], v28 offset:28672
  v_mfma_f32_16x16x32_bf16 v[232:235], v[120:123], v[172:175], v[232:235]
  ds_read_b64_tr_b16 v[106:107], v28 offset:32256
  s_waitcnt lgkmcnt(6)
  v_mfma_f32_16x16x32_bf16 v[208:211], v[124:127], v[168:171], v[208:211]
  ds_read_b64_tr_b16 v[108:109], v28 offset:28704
  v_mfma_f32_16x16x32_bf16 v[236:239], v[124:127], v[172:175], v[236:239]
  ds_read_b64_tr_b16 v[110:111], v28 offset:32288
  s_waitcnt lgkmcnt(6)
  v_mfma_f32_16x16x32_bf16 v[212:215], v[96:99], v[168:171], v[212:215]
  ds_read_b64_tr_b16 v[112:113], v28 offset:28736
  v_mfma_f32_16x16x32_bf16 v[240:243], v[96:99], v[172:175], v[240:243]
  ds_read_b64_tr_b16 v[114:115], v28 offset:32320
  s_waitcnt lgkmcnt(6)
  v_mfma_f32_16x16x32_bf16 v[216:219], v[100:103], v[168:171], v[216:219]
  ds_read_b64_tr_b16 v[116:117], v28 offset:28768
  v_mfma_f32_16x16x32_bf16 v[244:247], v[100:103], v[172:175], v[244:247]
  ds_read_b64_tr_b16 v[118:119], v28 offset:32352
  s_waitcnt vmcnt(6) lgkmcnt(6)
  v_mfma_f32_16x16x32_bf16 v[192:195], v[104:107], v[176:179], v[192:195]
  ds_read_b64_tr_b16 v[120:121], v28 offset:28800
  v_mfma_f32_16x16x32_bf16 v[220:223], v[104:107], v[180:183], v[220:223]
  ds_read_b64_tr_b16 v[122:123], v28 offset:32384
  s_waitcnt lgkmcnt(6)
  v_mfma_f32_16x16x32_bf16 v[196:199], v[108:111], v[176:179], v[196:199]
  ds_read_b64_tr_b16 v[124:125], v28 offset:28832
  v_mfma_f32_16x16x32_bf16 v[224:227], v[108:111], v[180:183], v[224:227]
  ds_read_b64_tr_b16 v[126:127], v28 offset:32416
  buffer_load_dwordx4 v[144:147], v2, s[4:7], s96 offen offset:2048 sc1
  buffer_load_dwordx4 v[148:151], v2, s[4:7], s100 offen offset:2048 sc1
  s_waitcnt lgkmcnt(6)
  v_mfma_f32_16x16x32_bf16 v[200:203], v[112:115], v[176:179], v[200:203]
  ds_read_b64_tr_b16 v[96:97], v28 offset:28864
  v_mfma_f32_16x16x32_bf16 v[228:231], v[112:115], v[180:183], v[228:231]
  ds_read_b64_tr_b16 v[98:99], v28 offset:32448
  s_waitcnt lgkmcnt(6)
  v_mfma_f32_16x16x32_bf16 v[204:207], v[116:119], v[176:179], v[204:207]
  ds_read_b64_tr_b16 v[100:101], v28 offset:35840
  v_mfma_f32_16x16x32_bf16 v[232:235], v[116:119], v[180:183], v[232:235]
  ds_read_b64_tr_b16 v[102:103], v28 offset:39424
  s_waitcnt lgkmcnt(6)
  v_mfma_f32_16x16x32_bf16 v[208:211], v[120:123], v[176:179], v[208:211]
  ds_read_b64_tr_b16 v[104:105], v28 offset:35872
  v_mfma_f32_16x16x32_bf16 v[236:239], v[120:123], v[180:183], v[236:239]
  ds_read_b64_tr_b16 v[106:107], v28 offset:39456
  s_waitcnt lgkmcnt(6)
  v_mfma_f32_16x16x32_bf16 v[212:215], v[124:127], v[176:179], v[212:215]
  ds_read_b64_tr_b16 v[108:109], v28 offset:35904
  v_mfma_f32_16x16x32_bf16 v[240:243], v[124:127], v[180:183], v[240:243]
  ds_read_b64_tr_b16 v[110:111], v28 offset:39488
  s_waitcnt lgkmcnt(6)
  v_mfma_f32_16x16x32_bf16 v[216:219], v[96:99], v[176:179], v[216:219]
  ds_read_b64_tr_b16 v[112:113], v28 offset:35936
  v_mfma_f32_16x16x32_bf16 v[244:247], v[96:99], v[180:183], v[244:247]
  ds_read_b64_tr_b16 v[114:115], v28 offset:39520
  s_waitcnt vmcnt(6) lgkmcnt(6)
  v_mfma_f32_16x16x32_bf16 v[192:195], v[100:103], v[184:187], v[192:195]
  ds_read_b64_tr_b16 v[116:117], v28 offset:35968
  v_mfma_f32_16x16x32_bf16 v[220:223], v[100:103], v[188:191], v[220:223]
  ds_read_b64_tr_b16 v[118:119], v28 offset:39552
  s_waitcnt lgkmcnt(6)
  v_mfma_f32_16x16x32_bf16 v[196:199], v[104:107], v[184:187], v[196:199]
  ds_read_b64_tr_b16 v[120:121], v28 offset:36000
  v_mfma_f32_16x16x32_bf16 v[224:227], v[104:107], v[188:191], v[224:227]
  ds_read_b64_tr_b16 v[122:123], v28 offset:39584
  buffer_load_dwordx4 v[152:155], v2, s[4:7], s96 offen offset:3072 sc1
  buffer_load_dwordx4 v[156:159], v2, s[4:7], s100 offen offset:3072 sc1
  s_waitcnt lgkmcnt(6)
  v_mfma_f32_16x16x32_bf16 v[200:203], v[108:111], v[184:187], v[200:203]
  ds_read_b64_tr_b16 v[124:125], v28 offset:36032
  v_mfma_f32_16x16x32_bf16 v[228:231], v[108:111], v[188:191], v[228:231]
  ds_read_b64_tr_b16 v[126:127], v28 offset:39616
  s_waitcnt lgkmcnt(6)
  v_mfma_f32_16x16x32_bf16 v[204:207], v[112:115], v[184:187], v[204:207]
  s_barrier
  ds_read_b64_tr_b16 v[96:97], v28 offset:43008
  v_mfma_f32_16x16x32_bf16 v[232:235], v[112:115], v[188:191], v[232:235]
  ds_read_b64_tr_b16 v[98:99], v28 offset:46592
  s_waitcnt lgkmcnt(6)
  v_mfma_f32_16x16x32_bf16 v[208:211], v[116:119], v[184:187], v[208:211]
  ds_read_b64_tr_b16 v[100:101], v28 offset:43040
  v_mfma_f32_16x16x32_bf16 v[236:239], v[116:119], v[188:191], v[236:239]
  ds_read_b64_tr_b16 v[102:103], v28 offset:46624
  s_waitcnt lgkmcnt(6)
  v_mfma_f32_16x16x32_bf16 v[212:215], v[120:123], v[184:187], v[212:215]
  ds_read_b64_tr_b16 v[104:105], v28 offset:43072
  v_mfma_f32_16x16x32_bf16 v[240:243], v[120:123], v[188:191], v[240:243]
  ds_read_b64_tr_b16 v[106:107], v28 offset:46656
  s_waitcnt lgkmcnt(6)
  v_mfma_f32_16x16x32_bf16 v[216:219], v[124:127], v[184:187], v[216:219]
  ds_read_b64_tr_b16 v[108:109], v28 offset:43104
  v_mfma_f32_16x16x32_bf16 v[244:247], v[124:127], v[188:191], v[244:247]
  ds_read_b64_tr_b16 v[110:111], v28 offset:46688
  s_waitcnt vmcnt(6) lgkmcnt(6)
  v_mfma_f32_16x16x32_bf16 v[192:195], v[96:99], v[128:131], v[192:195]
  ds_read_b64_tr_b16 v[112:113], v28 offset:43136
  v_mfma_f32_16x16x32_bf16 v[220:223], v[96:99], v[132:135], v[220:223]
  ds_read_b64_tr_b16 v[114:115], v28 offset:46720
  s_waitcnt lgkmcnt(6)
  v_mfma_f32_16x16x32_bf16 v[196:199], v[100:103], v[128:131], v[196:199]
  ds_read_b64_tr_b16 v[116:117], v28 offset:43168
  v_mfma_f32_16x16x32_bf16 v[224:227], v[100:103], v[132:135], v[224:227]
  ds_read_b64_tr_b16 v[118:119], v28 offset:46752
  buffer_load_dwordx4 v[160:163], v2, s[4:7], s97 offen offset:0 sc1
  buffer_load_dwordx4 v[164:167], v2, s[4:7], s101 offen offset:0 sc1
  s_waitcnt lgkmcnt(6)
  v_mfma_f32_16x16x32_bf16 v[200:203], v[104:107], v[128:131], v[200:203]
  ds_read_b64_tr_b16 v[120:121], v28 offset:43200
  v_mfma_f32_16x16x32_bf16 v[228:231], v[104:107], v[132:135], v[228:231]
  ds_read_b64_tr_b16 v[122:123], v28 offset:46784
  s_waitcnt lgkmcnt(6)
  v_mfma_f32_16x16x32_bf16 v[204:207], v[108:111], v[128:131], v[204:207]
  ds_read_b64_tr_b16 v[124:125], v28 offset:50176
  v_mfma_f32_16x16x32_bf16 v[232:235], v[108:111], v[132:135], v[232:235]
  ds_read_b64_tr_b16 v[126:127], v28 offset:53760
  s_waitcnt lgkmcnt(6)
  v_mfma_f32_16x16x32_bf16 v[208:211], v[112:115], v[128:131], v[208:211]
  ds_read_b64_tr_b16 v[96:97], v28 offset:50208
  v_mfma_f32_16x16x32_bf16 v[236:239], v[112:115], v[132:135], v[236:239]
  ds_read_b64_tr_b16 v[98:99], v28 offset:53792
  s_waitcnt lgkmcnt(6)
  v_mfma_f32_16x16x32_bf16 v[212:215], v[116:119], v[128:131], v[212:215]
  ds_read_b64_tr_b16 v[100:101], v28 offset:50240
  v_mfma_f32_16x16x32_bf16 v[240:243], v[116:119], v[132:135], v[240:243]
  ds_read_b64_tr_b16 v[102:103], v28 offset:53824
  s_waitcnt lgkmcnt(6)
  v_mfma_f32_16x16x32_bf16 v[216:219], v[120:123], v[128:131], v[216:219]
  ds_read_b64_tr_b16 v[104:105], v28 offset:50272
  v_mfma_f32_16x16x32_bf16 v[244:247], v[120:123], v[132:135], v[244:247]
  ds_read_b64_tr_b16 v[106:107], v28 offset:53856
  s_waitcnt vmcnt(6) lgkmcnt(6)
  v_mfma_f32_16x16x32_bf16 v[192:195], v[124:127], v[136:139], v[192:195]
  ds_read_b64_tr_b16 v[108:109], v28 offset:50304
  v_mfma_f32_16x16x32_bf16 v[220:223], v[124:127], v[140:143], v[220:223]
  ds_read_b64_tr_b16 v[110:111], v28 offset:53888
  s_waitcnt lgkmcnt(6)
  v_mfma_f32_16x16x32_bf16 v[196:199], v[96:99], v[136:139], v[196:199]
  ds_read_b64_tr_b16 v[112:113], v28 offset:50336
  v_mfma_f32_16x16x32_bf16 v[224:227], v[96:99], v[140:143], v[224:227]
  ds_read_b64_tr_b16 v[114:115], v28 offset:53920
  buffer_load_dwordx4 v[168:171], v2, s[4:7], s97 offen offset:1024 sc1
  buffer_load_dwordx4 v[172:175], v2, s[4:7], s101 offen offset:1024 sc1
  s_waitcnt lgkmcnt(6)
  v_mfma_f32_16x16x32_bf16 v[200:203], v[100:103], v[136:139], v[200:203]
  ds_read_b64_tr_b16 v[116:117], v28 offset:50368
  v_mfma_f32_16x16x32_bf16 v[228:231], v[100:103], v[140:143], v[228:231]
  ds_read_b64_tr_b16 v[118:119], v28 offset:53952
  s_waitcnt lgkmcnt(6)
  v_mfma_f32_16x16x32_bf16 v[204:207], v[104:107], v[136:139], v[204:207]
  ds_read_b64_tr_b16 v[120:121], v28 offset:57344
  v_mfma_f32_16x16x32_bf16 v[232:235], v[104:107], v[140:143], v[232:235]
  ds_read_b64_tr_b16 v[122:123], v28 offset:60928
  s_waitcnt lgkmcnt(6)
  v_mfma_f32_16x16x32_bf16 v[208:211], v[108:111], v[136:139], v[208:211]
  ds_read_b64_tr_b16 v[124:125], v28 offset:57376
  v_mfma_f32_16x16x32_bf16 v[236:239], v[108:111], v[140:143], v[236:239]
  ds_read_b64_tr_b16 v[126:127], v28 offset:60960
  s_waitcnt lgkmcnt(6)
  v_mfma_f32_16x16x32_bf16 v[212:215], v[112:115], v[136:139], v[212:215]
  ds_read_b64_tr_b16 v[96:97], v28 offset:57408
  v_mfma_f32_16x16x32_bf16 v[240:243], v[112:115], v[140:143], v[240:243]
  ds_read_b64_tr_b16 v[98:99], v28 offset:60992
  s_waitcnt lgkmcnt(6)
  v_mfma_f32_16x16x32_bf16 v[216:219], v[116:119], v[136:139], v[216:219]
  ds_read_b64_tr_b16 v[100:101], v28 offset:57440
  v_mfma_f32_16x16x32_bf16 v[244:247], v[116:119], v[140:143], v[244:247]
  ds_read_b64_tr_b16 v[102:103], v28 offset:61024
  s_waitcnt vmcnt(6) lgkmcnt(6)
  v_mfma_f32_16x16x32_bf16 v[192:195], v[120:123], v[144:147], v[192:195]
  ds_read_b64_tr_b16 v[104:105], v28 offset:57472
  v_mfma_f32_16x16x32_bf16 v[220:223], v[120:123], v[148:151], v[220:223]
  ds_read_b64_tr_b16 v[106:107], v28 offset:61056
  s_waitcnt lgkmcnt(6)
  v_mfma_f32_16x16x32_bf16 v[196:199], v[124:127], v[144:147], v[196:199]
  ds_read_b64_tr_b16 v[108:109], v28 offset:57504
  v_mfma_f32_16x16x32_bf16 v[224:227], v[124:127], v[148:151], v[224:227]
  ds_read_b64_tr_b16 v[110:111], v28 offset:61088
  buffer_load_dwordx4 v[176:179], v2, s[4:7], s97 offen offset:2048 sc1
  buffer_load_dwordx4 v[180:183], v2, s[4:7], s101 offen offset:2048 sc1
  s_waitcnt lgkmcnt(6)
  v_mfma_f32_16x16x32_bf16 v[200:203], v[96:99], v[144:147], v[200:203]
  ds_read_b64_tr_b16 v[112:113], v28 offset:57536
  v_mfma_f32_16x16x32_bf16 v[228:231], v[96:99], v[148:151], v[228:231]
  ds_read_b64_tr_b16 v[114:115], v28 offset:61120
  s_waitcnt lgkmcnt(6)
  v_mfma_f32_16x16x32_bf16 v[204:207], v[100:103], v[144:147], v[204:207]
  v_add_u32 v28, 0x1fc00, v22
  ds_read_b64_tr_b16 v[116:117], v28 offset:0
  v_mfma_f32_16x16x32_bf16 v[232:235], v[100:103], v[148:151], v[232:235]
  ds_read_b64_tr_b16 v[118:119], v28 offset:3584
  s_waitcnt lgkmcnt(6)
  v_mfma_f32_16x16x32_bf16 v[208:211], v[104:107], v[144:147], v[208:211]
  ds_read_b64_tr_b16 v[120:121], v28 offset:32
  v_mfma_f32_16x16x32_bf16 v[236:239], v[104:107], v[148:151], v[236:239]
  ds_read_b64_tr_b16 v[122:123], v28 offset:3616
  s_waitcnt lgkmcnt(6)
  v_mfma_f32_16x16x32_bf16 v[212:215], v[108:111], v[144:147], v[212:215]
  ds_read_b64_tr_b16 v[124:125], v28 offset:64
  v_mfma_f32_16x16x32_bf16 v[240:243], v[108:111], v[148:151], v[240:243]
  ds_read_b64_tr_b16 v[126:127], v28 offset:3648
  s_waitcnt lgkmcnt(6)
  v_mfma_f32_16x16x32_bf16 v[216:219], v[112:115], v[144:147], v[216:219]
  ds_read_b64_tr_b16 v[96:97], v28 offset:96
  v_mfma_f32_16x16x32_bf16 v[244:247], v[112:115], v[148:151], v[244:247]
  ds_read_b64_tr_b16 v[98:99], v28 offset:3680
  s_waitcnt vmcnt(6) lgkmcnt(6)
  v_mfma_f32_16x16x32_bf16 v[192:195], v[116:119], v[152:155], v[192:195]
  ds_read_b64_tr_b16 v[100:101], v28 offset:128
  v_mfma_f32_16x16x32_bf16 v[220:223], v[116:119], v[156:159], v[220:223]
  ds_read_b64_tr_b16 v[102:103], v28 offset:3712
  s_waitcnt lgkmcnt(6)
  v_mfma_f32_16x16x32_bf16 v[196:199], v[120:123], v[152:155], v[196:199]
  ds_read_b64_tr_b16 v[104:105], v28 offset:160
  v_mfma_f32_16x16x32_bf16 v[224:227], v[120:123], v[156:159], v[224:227]
  ds_read_b64_tr_b16 v[106:107], v28 offset:3744
  buffer_load_dwordx4 v[184:187], v2, s[4:7], s97 offen offset:3072 sc1
  buffer_load_dwordx4 v[188:191], v2, s[4:7], s101 offen offset:3072 sc1
  s_waitcnt lgkmcnt(6)
  v_mfma_f32_16x16x32_bf16 v[200:203], v[124:127], v[152:155], v[200:203]
  ds_read_b64_tr_b16 v[108:109], v28 offset:192
  v_mfma_f32_16x16x32_bf16 v[228:231], v[124:127], v[156:159], v[228:231]
  ds_read_b64_tr_b16 v[110:111], v28 offset:3776
  s_waitcnt lgkmcnt(6)
  v_mfma_f32_16x16x32_bf16 v[204:207], v[96:99], v[152:155], v[204:207]
  s_barrier
  ds_read_b64_tr_b16 v[112:113], v28 offset:7168
  v_mfma_f32_16x16x32_bf16 v[232:235], v[96:99], v[156:159], v[232:235]
  ds_read_b64_tr_b16 v[114:115], v28 offset:10752
  s_waitcnt lgkmcnt(6)
  v_mfma_f32_16x16x32_bf16 v[208:211], v[100:103], v[152:155], v[208:211]
  ds_read_b64_tr_b16 v[116:117], v28 offset:7200
  v_mfma_f32_16x16x32_bf16 v[236:239], v[100:103], v[156:159], v[236:239]
  ds_read_b64_tr_b16 v[118:119], v28 offset:10784
  s_waitcnt lgkmcnt(6)
  v_mfma_f32_16x16x32_bf16 v[212:215], v[104:107], v[152:155], v[212:215]
  ds_read_b64_tr_b16 v[120:121], v28 offset:7232
  v_mfma_f32_16x16x32_bf16 v[240:243], v[104:107], v[156:159], v[240:243]
  ds_read_b64_tr_b16 v[122:123], v28 offset:10816
  s_waitcnt lgkmcnt(6)
  v_mfma_f32_16x16x32_bf16 v[216:219], v[108:111], v[152:155], v[216:219]
  ds_read_b64_tr_b16 v[124:125], v28 offset:7264
  v_mfma_f32_16x16x32_bf16 v[244:247], v[108:111], v[156:159], v[244:247]
  ds_read_b64_tr_b16 v[126:127], v28 offset:10848
  s_waitcnt vmcnt(6) lgkmcnt(6)
  v_mfma_f32_16x16x32_bf16 v[192:195], v[112:115], v[160:163], v[192:195]
  ds_read_b64_tr_b16 v[96:97], v28 offset:7296
  v_mfma_f32_16x16x32_bf16 v[220:223], v[112:115], v[164:167], v[220:223]
  ds_read_b64_tr_b16 v[98:99], v28 offset:10880
  s_waitcnt lgkmcnt(6)
  v_mfma_f32_16x16x32_bf16 v[196:199], v[116:119], v[160:163], v[196:199]
  ds_read_b64_tr_b16 v[100:101], v28 offset:7328
  v_mfma_f32_16x16x32_bf16 v[224:227], v[116:119], v[164:167], v[224:227]
  ds_read_b64_tr_b16 v[102:103], v28 offset:10912
  s_mov_b32 s33, 0xd80000
  buffer_load_dwordx4 v[56:59], v10, s[4:7], s33 offen offset:0 sc1
  buffer_load_dwordx4 v[60:63], v10, s[4:7], s33 offen offset:512 sc1
  buffer_load_dwordx4 v[248:251], v10, s[4:7], s33 offen offset:256 sc1
  buffer_load_dwordx4 v[252:255], v10, s[4:7], s33 offen offset:768 sc1
  s_waitcnt lgkmcnt(6)
  v_mfma_f32_16x16x32_bf16 v[200:203], v[120:123], v[160:163], v[200:203]
  ds_read_b64_tr_b16 v[104:105], v28 offset:7360
  v_mfma_f32_16x16x32_bf16 v[228:231], v[120:123], v[164:167], v[228:231]
  ds_read_b64_tr_b16 v[106:107], v28 offset:10944
  s_waitcnt lgkmcnt(6)
  v_mfma_f32_16x16x32_bf16 v[204:207], v[124:127], v[160:163], v[204:207]
  ds_read_b64_tr_b16 v[108:109], v28 offset:14336
  v_mfma_f32_16x16x32_bf16 v[232:235], v[124:127], v[164:167], v[232:235]
  ds_read_b64_tr_b16 v[110:111], v28 offset:17920
  s_waitcnt lgkmcnt(6)
  v_mfma_f32_16x16x32_bf16 v[208:211], v[96:99], v[160:163], v[208:211]
  ds_read_b64_tr_b16 v[112:113], v28 offset:14368
  v_mfma_f32_16x16x32_bf16 v[236:239], v[96:99], v[164:167], v[236:239]
  ds_read_b64_tr_b16 v[114:115], v28 offset:17952
  s_waitcnt lgkmcnt(6)
  v_mfma_f32_16x16x32_bf16 v[212:215], v[100:103], v[160:163], v[212:215]
  ds_read_b64_tr_b16 v[116:117], v28 offset:14400
  v_mfma_f32_16x16x32_bf16 v[240:243], v[100:103], v[164:167], v[240:243]
  ds_read_b64_tr_b16 v[118:119], v28 offset:17984
  s_waitcnt lgkmcnt(6)
  v_mfma_f32_16x16x32_bf16 v[216:219], v[104:107], v[160:163], v[216:219]
  ds_read_b64_tr_b16 v[120:121], v28 offset:14432
  v_mfma_f32_16x16x32_bf16 v[244:247], v[104:107], v[164:167], v[244:247]
  ds_read_b64_tr_b16 v[122:123], v28 offset:18016
  s_waitcnt vmcnt(8) lgkmcnt(6)
  v_mfma_f32_16x16x32_bf16 v[192:195], v[108:111], v[168:171], v[192:195]
  ds_read_b64_tr_b16 v[124:125], v28 offset:14464
  v_mfma_f32_16x16x32_bf16 v[220:223], v[108:111], v[172:175], v[220:223]
  ds_read_b64_tr_b16 v[126:127], v28 offset:18048
  s_waitcnt lgkmcnt(6)
  v_mfma_f32_16x16x32_bf16 v[196:199], v[112:115], v[168:171], v[196:199]
  ds_read_b64_tr_b16 v[96:97], v28 offset:14496
  v_mfma_f32_16x16x32_bf16 v[224:227], v[112:115], v[172:175], v[224:227]
  ds_read_b64_tr_b16 v[98:99], v28 offset:18080
  s_waitcnt lgkmcnt(6)
  v_mfma_f32_16x16x32_bf16 v[200:203], v[116:119], v[168:171], v[200:203]
  ds_read_b64_tr_b16 v[100:101], v28 offset:14528
  v_mfma_f32_16x16x32_bf16 v[228:231], v[116:119], v[172:175], v[228:231]
  ds_read_b64_tr_b16 v[102:103], v28 offset:18112
  s_waitcnt lgkmcnt(6)
  v_mfma_f32_16x16x32_bf16 v[204:207], v[120:123], v[168:171], v[204:207]
  ds_read_b64_tr_b16 v[104:105], v28 offset:21504
  v_mfma_f32_16x16x32_bf16 v[232:235], v[120:123], v[172:175], v[232:235]
  ds_read_b64_tr_b16 v[106:107], v28 offset:25088
  s_waitcnt lgkmcnt(6)
  v_mfma_f32_16x16x32_bf16 v[208:211], v[124:127], v[168:171], v[208:211]
  ds_read_b64_tr_b16 v[108:109], v28 offset:21536
  v_mfma_f32_16x16x32_bf16 v[236:239], v[124:127], v[172:175], v[236:239]
  ds_read_b64_tr_b16 v[110:111], v28 offset:25120
  s_waitcnt lgkmcnt(6)
  v_mfma_f32_16x16x32_bf16 v[212:215], v[96:99], v[168:171], v[212:215]
  ds_read_b64_tr_b16 v[112:113], v28 offset:21568
  v_mfma_f32_16x16x32_bf16 v[240:243], v[96:99], v[172:175], v[240:243]
  ds_read_b64_tr_b16 v[114:115], v28 offset:25152
  s_waitcnt lgkmcnt(6)
  v_mfma_f32_16x16x32_bf16 v[216:219], v[100:103], v[168:171], v[216:219]
  ds_read_b64_tr_b16 v[116:117], v28 offset:21600
  v_mfma_f32_16x16x32_bf16 v[244:247], v[100:103], v[172:175], v[244:247]
  ds_read_b64_tr_b16 v[118:119], v28 offset:25184
  s_waitcnt vmcnt(6) lgkmcnt(6)
  v_mfma_f32_16x16x32_bf16 v[192:195], v[104:107], v[176:179], v[192:195]
  ds_read_b64_tr_b16 v[120:121], v28 offset:21632
  v_mfma_f32_16x16x32_bf16 v[220:223], v[104:107], v[180:183], v[220:223]
  ds_read_b64_tr_b16 v[122:123], v28 offset:25216
  s_waitcnt lgkmcnt(6)
  v_mfma_f32_16x16x32_bf16 v[196:199], v[108:111], v[176:179], v[196:199]
  ds_read_b64_tr_b16 v[124:125], v28 offset:21664
  v_mfma_f32_16x16x32_bf16 v[224:227], v[108:111], v[180:183], v[224:227]
  ds_read_b64_tr_b16 v[126:127], v28 offset:25248
  s_waitcnt lgkmcnt(6)
  v_mfma_f32_16x16x32_bf16 v[200:203], v[112:115], v[176:179], v[200:203]
  ds_read_b64_tr_b16 v[96:97], v28 offset:21696
  v_mfma_f32_16x16x32_bf16 v[228:231], v[112:115], v[180:183], v[228:231]
  ds_read_b64_tr_b16 v[98:99], v28 offset:25280
  s_waitcnt lgkmcnt(6)
  v_mfma_f32_16x16x32_bf16 v[204:207], v[116:119], v[176:179], v[204:207]
  v_add_u32 v28, 0x10000, v22
  ds_read_b64_tr_b16 v[100:101], v28 offset:0
  v_mfma_f32_16x16x32_bf16 v[232:235], v[116:119], v[180:183], v[232:235]
  ds_read_b64_tr_b16 v[102:103], v28 offset:3584
  s_waitcnt lgkmcnt(6)
  v_mfma_f32_16x16x32_bf16 v[208:211], v[120:123], v[176:179], v[208:211]
  ds_read_b64_tr_b16 v[104:105], v28 offset:32
  v_mfma_f32_16x16x32_bf16 v[236:239], v[120:123], v[180:183], v[236:239]
  ds_read_b64_tr_b16 v[106:107], v28 offset:3616
  s_waitcnt lgkmcnt(6)
  v_mfma_f32_16x16x32_bf16 v[212:215], v[124:127], v[176:179], v[212:215]
  ds_read_b64_tr_b16 v[108:109], v28 offset:64
  v_mfma_f32_16x16x32_bf16 v[240:243], v[124:127], v[180:183], v[240:243]
  ds_read_b64_tr_b16 v[110:111], v28 offset:3648
  s_waitcnt lgkmcnt(6)
  v_mfma_f32_16x16x32_bf16 v[216:219], v[96:99], v[176:179], v[216:219]
  ds_read_b64_tr_b16 v[112:113], v28 offset:96
  v_mfma_f32_16x16x32_bf16 v[244:247], v[96:99], v[180:183], v[244:247]
  ds_read_b64_tr_b16 v[114:115], v28 offset:3680
  s_waitcnt vmcnt(4) lgkmcnt(6)
  v_mfma_f32_16x16x32_bf16 v[192:195], v[100:103], v[184:187], v[192:195]
  ds_read_b64_tr_b16 v[116:117], v28 offset:128
  v_mfma_f32_16x16x32_bf16 v[220:223], v[100:103], v[188:191], v[220:223]
  ds_read_b64_tr_b16 v[118:119], v28 offset:3712
  s_waitcnt lgkmcnt(6)
  v_mfma_f32_16x16x32_bf16 v[196:199], v[104:107], v[184:187], v[196:199]
  ds_read_b64_tr_b16 v[120:121], v28 offset:160
  v_mfma_f32_16x16x32_bf16 v[224:227], v[104:107], v[188:191], v[224:227]
  ds_read_b64_tr_b16 v[122:123], v28 offset:3744
  s_waitcnt lgkmcnt(6)
  v_mfma_f32_16x16x32_bf16 v[200:203], v[108:111], v[184:187], v[200:203]
  ds_read_b64_tr_b16 v[124:125], v28 offset:192
  v_mfma_f32_16x16x32_bf16 v[228:231], v[108:111], v[188:191], v[228:231]
  ds_read_b64_tr_b16 v[126:127], v28 offset:3776
  s_waitcnt lgkmcnt(6)
  v_mfma_f32_16x16x32_bf16 v[204:207], v[112:115], v[184:187], v[204:207]
  v_mfma_f32_16x16x32_bf16 v[232:235], v[112:115], v[188:191], v[232:235]
  s_waitcnt lgkmcnt(4)
  v_mfma_f32_16x16x32_bf16 v[208:211], v[116:119], v[184:187], v[208:211]
  v_mfma_f32_16x16x32_bf16 v[236:239], v[116:119], v[188:191], v[236:239]
  s_waitcnt lgkmcnt(2)
  v_mfma_f32_16x16x32_bf16 v[212:215], v[120:123], v[184:187], v[212:215]
  v_mfma_f32_16x16x32_bf16 v[240:243], v[120:123], v[188:191], v[240:243]
  s_waitcnt lgkmcnt(0)
  v_mfma_f32_16x16x32_bf16 v[216:219], v[124:127], v[184:187], v[216:219]
  v_mfma_f32_16x16x32_bf16 v[244:247], v[124:127], v[188:191], v[244:247]
  s_barrier
  s_nop 7
  s_waitcnt vmcnt(0)
  v_pk_add_f32 v[56:57], v[56:57], v[58:59]
  v_pk_add_f32 v[60:61], v[60:61], v[62:63]
  v_pk_add_f32 v[56:57], v[56:57], v[60:61]
  v_pk_add_f32 v[248:249], v[248:249], v[250:251]
  v_pk_add_f32 v[252:253], v[252:253], v[254:255]
  v_pk_add_f32 v[248:249], v[248:249], v[252:253]
  v_mov_b32 v50, v56
  v_mov_b32 v51, v57
  v_mov_b32 v52, v248
  v_mov_b32 v53, v249
  s_nop 1
  v_permlane32_swap_b32 v56, v50
  v_permlane32_swap_b32 v57, v51
  v_permlane32_swap_b32 v248, v52
  v_permlane32_swap_b32 v249, v53
  s_nop 0
  v_add_f32 v56, v56, v50
  v_add_f32 v57, v57, v51
  v_add_f32 v248, v248, v52
  v_add_f32 v249, v249, v53
  v_mov_b32 v50, v56
  v_mov_b32 v51, v57
  v_mov_b32 v52, v248
  v_mov_b32 v53, v249
  s_nop 1
  v_permlane16_swap_b32 v56, v50
  v_permlane16_swap_b32 v57, v51
  v_permlane16_swap_b32 v248, v52
  v_permlane16_swap_b32 v249, v53
  s_nop 0
  v_add_f32 v56, v56, v50
  v_add_f32 v57, v57, v51
  v_add_f32 v248, v248, v52
  v_add_f32 v249, v249, v53
  v_mul_f32 v56, 0x3b000000, v56
  v_mul_f32 v57, 0x3b000000, v57
  v_fma_f32 v57, -v56, v56, v57
  v_max_f32 v57, 0, v57
  v_add_f32 v50, 0x3727c5ac, v57
  v_rsq_f32 v50, v50
  s_nop 0
  v_mov_b32 v92, v50
  v_mul_f32 v94, v92, v56
  v_sub_f32 v94, 0, v94
  v_mul_f32 v248, 0x3b000000, v248
  v_mul_f32 v249, 0x3b000000, v249
  v_fma_f32 v249, -v248, v248, v249
  v_max_f32 v249, 0, v249
  v_add_f32 v50, 0x3727c5ac, v249
  v_rsq_f32 v50, v50
  s_nop 0
  v_mov_b32 v252, v50
  v_mul_f32 v254, v252, v248
  v_sub_f32 v254, 0, v254
  s_lshl_b32 s33, s20, 4
  s_lshl_b32 s34, s25, 3
  s_add_u32 s33, s33, s34
  s_lshl_b32 s34, s22, 1
  s_add_u32 s33, s33, s34
  s_mul_i32 s33, s33, 57344
  s_lshr_b32 s34, s26, 1
  s_mul_i32 s34, s34, 7168
  s_add_u32 s33, s33, s34
  s_add_u32 s33, s33, 0x680000
  s_and_b32 s34, s26, 1
  s_mul_i32 s55, s34, 3072
  s_add_u32 s55, s55, s33
  s_add_u32 s56, s55, 57344
  s_lshl_b32 s34, s34, 3
  s_add_u32 s57, s33, s34
  s_add_u32 s57, s57, 6144
  s_add_u32 s58, s57, 57344
  v_lshlrev_b32 v54, 4, v0
  v_pk_mul_f32 v[192:193], v[192:193], v[92:93] op_sel_hi:[1,0]
  v_pk_mul_f32 v[194:195], v[194:195], v[92:93] op_sel_hi:[1,0]
  v_pk_mul_f32 v[196:197], v[196:197], v[92:93] op_sel_hi:[1,0]
  v_pk_mul_f32 v[198:199], v[198:199], v[92:93] op_sel_hi:[1,0]
  v_pk_mul_f32 v[200:201], v[200:201], v[92:93] op_sel_hi:[1,0]
  v_pk_mul_f32 v[202:203], v[202:203], v[92:93] op_sel_hi:[1,0]
  v_pk_mul_f32 v[204:205], v[204:205], v[92:93] op_sel_hi:[1,0]
  v_pk_mul_f32 v[206:207], v[206:207], v[92:93] op_sel_hi:[1,0]
  v_pk_mul_f32 v[208:209], v[208:209], v[92:93] op_sel_hi:[1,0]
  v_pk_mul_f32 v[210:211], v[210:211], v[92:93] op_sel_hi:[1,0]
  v_pk_mul_f32 v[212:213], v[212:213], v[92:93] op_sel_hi:[1,0]
  v_pk_mul_f32 v[214:215], v[214:215], v[92:93] op_sel_hi:[1,0]
  v_pk_mul_f32 v[216:217], v[216:217], v[92:93] op_sel_hi:[1,0]
  v_pk_mul_f32 v[218:219], v[218:219], v[92:93] op_sel_hi:[1,0]
  v_pk_fma_f32 v[192:193], v[64:65], v[94:95], v[192:193] op_sel_hi:[1,0,1]
  v_pk_fma_f32 v[194:195], v[66:67], v[94:95], v[194:195] op_sel_hi:[1,0,1]
  v_pk_fma_f32 v[196:197], v[68:69], v[94:95], v[196:197] op_sel_hi:[1,0,1]
  v_pk_fma_f32 v[198:199], v[70:71], v[94:95], v[198:199] op_sel_hi:[1,0,1]
  v_pk_fma_f32 v[200:201], v[72:73], v[94:95], v[200:201] op_sel_hi:[1,0,1]
  v_pk_fma_f32 v[202:203], v[74:75], v[94:95], v[202:203] op_sel_hi:[1,0,1]
  v_pk_fma_f32 v[204:205], v[76:77], v[94:95], v[204:205] op_sel_hi:[1,0,1]
  v_pk_fma_f32 v[206:207], v[78:79], v[94:95], v[206:207] op_sel_hi:[1,0,1]
  v_pk_fma_f32 v[208:209], v[80:81], v[94:95], v[208:209] op_sel_hi:[1,0,1]
  v_pk_fma_f32 v[210:211], v[82:83], v[94:95], v[210:211] op_sel_hi:[1,0,1]
  v_pk_fma_f32 v[212:213], v[84:85], v[94:95], v[212:213] op_sel_hi:[1,0,1]
  v_pk_fma_f32 v[214:215], v[86:87], v[94:95], v[214:215] op_sel_hi:[1,0,1]
  v_pk_fma_f32 v[216:217], v[88:89], v[94:95], v[216:217] op_sel_hi:[1,0,1]
  v_pk_fma_f32 v[218:219], v[90:91], v[94:95], v[218:219] op_sel_hi:[1,0,1]
  v_mov_b32 v60, s44
  v_pk_mul_f32 v[128:129], v[192:193], v[192:193]
  v_pk_mul_f32 v[130:131], v[194:195], v[194:195]
  v_pk_mul_f32 v[132:133], v[196:197], v[196:197]
  v_pk_mul_f32 v[134:135], v[198:199], v[198:199]
  v_pk_mul_f32 v[136:137], v[200:201], v[200:201]
  v_pk_mul_f32 v[138:139], v[202:203], v[202:203]
  v_pk_mul_f32 v[140:141], v[204:205], v[204:205]
  v_pk_mul_f32 v[142:143], v[206:207], v[206:207]
  v_pk_fma_f32 v[128:129], v[128:129], s[46:47], v[60:61] op_sel_hi:[1,1,0]
  v_pk_fma_f32 v[130:131], v[130:131], s[46:47], v[60:61] op_sel_hi:[1,1,0]
  v_pk_fma_f32 v[132:133], v[132:133], s[46:47], v[60:61] op_sel_hi:[1,1,0]
  v_pk_fma_f32 v[134:135], v[134:135], s[46:47], v[60:61] op_sel_hi:[1,1,0]
  v_pk_fma_f32 v[136:137], v[136:137], s[46:47], v[60:61] op_sel_hi:[1,1,0]
  v_pk_fma_f32 v[138:139], v[138:139], s[46:47], v[60:61] op_sel_hi:[1,1,0]
  v_pk_fma_f32 v[140:141], v[140:141], s[46:47], v[60:61] op_sel_hi:[1,1,0]
  v_pk_fma_f32 v[142:143], v[142:143], s[46:47], v[60:61] op_sel_hi:[1,1,0]
  v_pk_mul_f32 v[128:129], v[128:129], v[192:193]
  v_pk_mul_f32 v[130:131], v[130:131], v[194:195]
  v_pk_mul_f32 v[132:133], v[132:133], v[196:197]
  v_pk_mul_f32 v[134:135], v[134:135], v[198:199]
  v_pk_mul_f32 v[136:137], v[136:137], v[200:201]
  v_pk_mul_f32 v[138:139], v[138:139], v[202:203]
  v_pk_mul_f32 v[140:141], v[140:141], v[204:205]
  v_pk_mul_f32 v[142:143], v[142:143], v[206:207]
  v_exp_f32 v128, v128
  v_exp_f32 v129, v129
  v_exp_f32 v130, v130
  v_exp_f32 v131, v131
  v_exp_f32 v132, v132
  v_exp_f32 v133, v133
  v_exp_f32 v134, v134
  v_exp_f32 v135, v135
  v_exp_f32 v136, v136
  v_exp_f32 v137, v137
  v_exp_f32 v138, v138
  v_exp_f32 v139, v139
  v_exp_f32 v140, v140
  v_exp_f32 v141, v141
  v_exp_f32 v142, v142
  v_exp_f32 v143, v143
  v_pk_add_f32 v[128:129], v[128:129], s[48:49]
  v_pk_add_f32 v[130:131], v[130:131], s[48:49]
  v_pk_add_f32 v[132:133], v[132:133], s[48:49]
  v_pk_add_f32 v[134:135], v[134:135], s[48:49]
  v_pk_add_f32 v[136:137], v[136:137], s[48:49]
  v_pk_add_f32 v[138:139], v[138:139], s[48:49]
  v_pk_add_f32 v[140:141], v[140:141], s[48:49]
  v_pk_add_f32 v[142:143], v[142:143], s[48:49]
  v_rcp_f32 v128, v128
  v_rcp_f32 v129, v129
  v_rcp_f32 v130, v130
  v_rcp_f32 v131, v131
  v_rcp_f32 v132, v132
  v_rcp_f32 v133, v133
  v_rcp_f32 v134, v134
  v_rcp_f32 v135, v135
  v_rcp_f32 v136, v136
  v_rcp_f32 v137, v137
  v_rcp_f32 v138, v138
  v_rcp_f32 v139, v139
  v_rcp_f32 v140, v140
  v_rcp_f32 v141, v141
  v_rcp_f32 v142, v142
  v_rcp_f32 v143, v143
  v_pk_mul_f32 v[192:193], v[192:193], v[128:129]
  v_pk_mul_f32 v[194:195], v[194:195], v[130:131]
  v_pk_mul_f32 v[196:197], v[196:197], v[132:133]
  v_pk_mul_f32 v[198:199], v[198:199], v[134:135]
  v_pk_mul_f32 v[200:201], v[200:201], v[136:137]
  v_pk_mul_f32 v[202:203], v[202:203], v[138:139]
  v_pk_mul_f32 v[204:205], v[204:205], v[140:141]
  v_pk_mul_f32 v[206:207], v[206:207], v[142:143]
  v_pk_mul_f32 v[128:129], v[208:209], v[208:209]
  v_pk_mul_f32 v[130:131], v[210:211], v[210:211]
  v_pk_mul_f32 v[132:133], v[212:213], v[212:213]
  v_pk_mul_f32 v[134:135], v[214:215], v[214:215]
  v_pk_mul_f32 v[136:137], v[216:217], v[216:217]
  v_pk_mul_f32 v[138:139], v[218:219], v[218:219]
  v_pk_fma_f32 v[128:129], v[128:129], s[46:47], v[60:61] op_sel_hi:[1,1,0]
  v_pk_fma_f32 v[130:131], v[130:131], s[46:47], v[60:61] op_sel_hi:[1,1,0]
  v_pk_fma_f32 v[132:133], v[132:133], s[46:47], v[60:61] op_sel_hi:[1,1,0]
  v_pk_fma_f32 v[134:135], v[134:135], s[46:47], v[60:61] op_sel_hi:[1,1,0]
  v_pk_fma_f32 v[136:137], v[136:137], s[46:47], v[60:61] op_sel_hi:[1,1,0]
  v_pk_fma_f32 v[138:139], v[138:139], s[46:47], v[60:61] op_sel_hi:[1,1,0]
  v_pk_mul_f32 v[128:129], v[128:129], v[208:209]
  v_pk_mul_f32 v[130:131], v[130:131], v[210:211]
  v_pk_mul_f32 v[132:133], v[132:133], v[212:213]
  v_pk_mul_f32 v[134:135], v[134:135], v[214:215]
  v_pk_mul_f32 v[136:137], v[136:137], v[216:217]
  v_pk_mul_f32 v[138:139], v[138:139], v[218:219]
  v_exp_f32 v128, v128
  v_exp_f32 v129, v129
  v_exp_f32 v130, v130
  v_exp_f32 v131, v131
  v_exp_f32 v132, v132
  v_exp_f32 v133, v133
  v_exp_f32 v134, v134
  v_exp_f32 v135, v135
  v_exp_f32 v136, v136
  v_exp_f32 v137, v137
  v_exp_f32 v138, v138
  v_exp_f32 v139, v139
  v_pk_add_f32 v[128:129], v[128:129], s[48:49]
  v_pk_add_f32 v[130:131], v[130:131], s[48:49]
  v_pk_add_f32 v[132:133], v[132:133], s[48:49]
  v_pk_add_f32 v[134:135], v[134:135], s[48:49]
  v_pk_add_f32 v[136:137], v[136:137], s[48:49]
  v_pk_add_f32 v[138:139], v[138:139], s[48:49]
  v_rcp_f32 v128, v128
  v_rcp_f32 v129, v129
  v_rcp_f32 v130, v130
  v_rcp_f32 v131, v131
  v_rcp_f32 v132, v132
  v_rcp_f32 v133, v133
  v_rcp_f32 v134, v134
  v_rcp_f32 v135, v135
  v_rcp_f32 v136, v136
  v_rcp_f32 v137, v137
  v_rcp_f32 v138, v138
  v_rcp_f32 v139, v139
  v_pk_mul_f32 v[208:209], v[208:209], v[128:129]
  v_pk_mul_f32 v[210:211], v[210:211], v[130:131]
  v_pk_mul_f32 v[212:213], v[212:213], v[132:133]
  v_pk_mul_f32 v[214:215], v[214:215], v[134:135]
  v_pk_mul_f32 v[216:217], v[216:217], v[136:137]
  v_pk_mul_f32 v[218:219], v[218:219], v[138:139]
  v_cvt_pk_bf16_f32 v144, v192, v193
  v_cvt_pk_bf16_f32 v145, v194, v195
  v_cvt_pk_bf16_f32 v146, v196, v197
  v_cvt_pk_bf16_f32 v147, v198, v199
  v_cvt_pk_bf16_f32 v148, v200, v201
  v_cvt_pk_bf16_f32 v149, v202, v203
  v_cvt_pk_bf16_f32 v150, v204, v205
  v_cvt_pk_bf16_f32 v151, v206, v207
  v_cvt_pk_bf16_f32 v152, v208, v209
  v_cvt_pk_bf16_f32 v153, v210, v211
  v_cvt_pk_bf16_f32 v154, v212, v213
  v_cvt_pk_bf16_f32 v155, v214, v215
  v_cvt_pk_bf16_f32 v156, v216, v217
  v_cvt_pk_bf16_f32 v157, v218, v219
  s_cmp_eq_u32 s27, 0
  s_cbranch_scc1 STF_38
  buffer_store_dwordx4 v[144:147], v54, s[4:7], s55 offen offset:0 sc1
  buffer_store_dwordx4 v[148:151], v54, s[4:7], s55 offen offset:1024 sc1
  buffer_store_dwordx4 v[152:155], v54, s[4:7], s55 offen offset:2048 sc1
  buffer_store_dwordx2 v[156:157], v54, s[4:7], s57 offen sc1
  s_branch STD_39
STF_38:
  buffer_store_dwordx4 v[144:147], v54, s[4:7], s55 offen offset:0
  buffer_store_dwordx4 v[148:151], v54, s[4:7], s55 offen offset:1024
  buffer_store_dwordx4 v[152:155], v54, s[4:7], s55 offen offset:2048
  buffer_store_dwordx2 v[156:157], v54, s[4:7], s57 offen
STD_39:
  v_pk_mul_f32 v[220:221], v[220:221], v[252:253] op_sel_hi:[1,0]
  v_pk_mul_f32 v[222:223], v[222:223], v[252:253] op_sel_hi:[1,0]
  v_pk_mul_f32 v[224:225], v[224:225], v[252:253] op_sel_hi:[1,0]
  v_pk_mul_f32 v[226:227], v[226:227], v[252:253] op_sel_hi:[1,0]
  v_pk_mul_f32 v[228:229], v[228:229], v[252:253] op_sel_hi:[1,0]
  v_pk_mul_f32 v[230:231], v[230:231], v[252:253] op_sel_hi:[1,0]
  v_pk_mul_f32 v[232:233], v[232:233], v[252:253] op_sel_hi:[1,0]
  v_pk_mul_f32 v[234:235], v[234:235], v[252:253] op_sel_hi:[1,0]
  v_pk_mul_f32 v[236:237], v[236:237], v[252:253] op_sel_hi:[1,0]
  v_pk_mul_f32 v[238:239], v[238:239], v[252:253] op_sel_hi:[1,0]
  v_pk_mul_f32 v[240:241], v[240:241], v[252:253] op_sel_hi:[1,0]
  v_pk_mul_f32 v[242:243], v[242:243], v[252:253] op_sel_hi:[1,0]
  v_pk_mul_f32 v[244:245], v[244:245], v[252:253] op_sel_hi:[1,0]
  v_pk_mul_f32 v[246:247], v[246:247], v[252:253] op_sel_hi:[1,0]
  v_pk_fma_f32 v[220:221], v[64:65], v[254:255], v[220:221] op_sel_hi:[1,0,1]
  v_pk_fma_f32 v[222:223], v[66:67], v[254:255], v[222:223] op_sel_hi:[1,0,1]
  v_pk_fma_f32 v[224:225], v[68:69], v[254:255], v[224:225] op_sel_hi:[1,0,1]
  v_pk_fma_f32 v[226:227], v[70:71], v[254:255], v[226:227] op_sel_hi:[1,0,1]
  v_pk_fma_f32 v[228:229], v[72:73], v[254:255], v[228:229] op_sel_hi:[1,0,1]
  v_pk_fma_f32 v[230:231], v[74:75], v[254:255], v[230:231] op_sel_hi:[1,0,1]
  v_pk_fma_f32 v[232:233], v[76:77], v[254:255], v[232:233] op_sel_hi:[1,0,1]
  v_pk_fma_f32 v[234:235], v[78:79], v[254:255], v[234:235] op_sel_hi:[1,0,1]
  v_pk_fma_f32 v[236:237], v[80:81], v[254:255], v[236:237] op_sel_hi:[1,0,1]
  v_pk_fma_f32 v[238:239], v[82:83], v[254:255], v[238:239] op_sel_hi:[1,0,1]
  v_pk_fma_f32 v[240:241], v[84:85], v[254:255], v[240:241] op_sel_hi:[1,0,1]
  v_pk_fma_f32 v[242:243], v[86:87], v[254:255], v[242:243] op_sel_hi:[1,0,1]
  v_pk_fma_f32 v[244:245], v[88:89], v[254:255], v[244:245] op_sel_hi:[1,0,1]
  v_pk_fma_f32 v[246:247], v[90:91], v[254:255], v[246:247] op_sel_hi:[1,0,1]
  v_mov_b32 v60, s44
  v_pk_mul_f32 v[128:129], v[220:221], v[220:221]
  v_pk_mul_f32 v[130:131], v[222:223], v[222:223]
  v_pk_mul_f32 v[132:133], v[224:225], v[224:225]
  v_pk_mul_f32 v[134:135], v[226:227], v[226:227]
  v_pk_mul_f32 v[136:137], v[228:229], v[228:229]
  v_pk_mul_f32 v[138:139], v[230:231], v[230:231]
  v_pk_mul_f32 v[140:141], v[232:233], v[232:233]
  v_pk_mul_f32 v[142:143], v[234:235], v[234:235]
  v_pk_fma_f32 v[128:129], v[128:129], s[46:47], v[60:61] op_sel_hi:[1,1,0]
  v_pk_fma_f32 v[130:131], v[130:131], s[46:47], v[60:61] op_sel_hi:[1,1,0]
  v_pk_fma_f32 v[132:133], v[132:133], s[46:47], v[60:61] op_sel_hi:[1,1,0]
  v_pk_fma_f32 v[134:135], v[134:135], s[46:47], v[60:61] op_sel_hi:[1,1,0]
  v_pk_fma_f32 v[136:137], v[136:137], s[46:47], v[60:61] op_sel_hi:[1,1,0]
  v_pk_fma_f32 v[138:139], v[138:139], s[46:47], v[60:61] op_sel_hi:[1,1,0]
  v_pk_fma_f32 v[140:141], v[140:141], s[46:47], v[60:61] op_sel_hi:[1,1,0]
  v_pk_fma_f32 v[142:143], v[142:143], s[46:47], v[60:61] op_sel_hi:[1,1,0]
  v_pk_mul_f32 v[128:129], v[128:129], v[220:221]
  v_pk_mul_f32 v[130:131], v[130:131], v[222:223]
  v_pk_mul_f32 v[132:133], v[132:133], v[224:225]
  v_pk_mul_f32 v[134:135], v[134:135], v[226:227]
  v_pk_mul_f32 v[136:137], v[136:137], v[228:229]
  v_pk_mul_f32 v[138:139], v[138:139], v[230:231]
  v_pk_mul_f32 v[140:141], v[140:141], v[232:233]
  v_pk_mul_f32 v[142:143], v[142:143], v[234:235]
  v_exp_f32 v128, v128
  v_exp_f32 v129, v129
  v_exp_f32 v130, v130
  v_exp_f32 v131, v131
  v_exp_f32 v132, v132
  v_exp_f32 v133, v133
  v_exp_f32 v134, v134
  v_exp_f32 v135, v135
  v_exp_f32 v136, v136
  v_exp_f32 v137, v137
  v_exp_f32 v138, v138
  v_exp_f32 v139, v139
  v_exp_f32 v140, v140
  v_exp_f32 v141, v141
  v_exp_f32 v142, v142
  v_exp_f32 v143, v143
  v_pk_add_f32 v[128:129], v[128:129], s[48:49]
  v_pk_add_f32 v[130:131], v[130:131], s[48:49]
  v_pk_add_f32 v[132:133], v[132:133], s[48:49]
  v_pk_add_f32 v[134:135], v[134:135], s[48:49]
  v_pk_add_f32 v[136:137], v[136:137], s[48:49]
  v_pk_add_f32 v[138:139], v[138:139], s[48:49]
  v_pk_add_f32 v[140:141], v[140:141], s[48:49]
  v_pk_add_f32 v[142:143], v[142:143], s[48:49]
  v_rcp_f32 v128, v128
  v_rcp_f32 v129, v129
  v_rcp_f32 v130, v130
  v_rcp_f32 v131, v131
  v_rcp_f32 v132, v132
  v_rcp_f32 v133, v133
  v_rcp_f32 v134, v134
  v_rcp_f32 v135, v135
  v_rcp_f32 v136, v136
  v_rcp_f32 v137, v137
  v_rcp_f32 v138, v138
  v_rcp_f32 v139, v139
  v_rcp_f32 v140, v140
  v_rcp_f32 v141, v141
  v_rcp_f32 v142, v142
  v_rcp_f32 v143, v143
  v_pk_mul_f32 v[220:221], v[220:221], v[128:129]
  v_pk_mul_f32 v[222:223], v[222:223], v[130:131]
  v_pk_mul_f32 v[224:225], v[224:225], v[132:133]
  v_pk_mul_f32 v[226:227], v[226:227], v[134:135]
  v_pk_mul_f32 v[228:229], v[228:229], v[136:137]
  v_pk_mul_f32 v[230:231], v[230:231], v[138:139]
  v_pk_mul_f32 v[232:233], v[232:233], v[140:141]
  v_pk_mul_f32 v[234:235], v[234:235], v[142:143]
  v_pk_mul_f32 v[128:129], v[236:237], v[236:237]
  v_pk_mul_f32 v[130:131], v[238:239], v[238:239]
  v_pk_mul_f32 v[132:133], v[240:241], v[240:241]
  v_pk_mul_f32 v[134:135], v[242:243], v[242:243]
  v_pk_mul_f32 v[136:137], v[244:245], v[244:245]
  v_pk_mul_f32 v[138:139], v[246:247], v[246:247]
  v_pk_fma_f32 v[128:129], v[128:129], s[46:47], v[60:61] op_sel_hi:[1,1,0]
  v_pk_fma_f32 v[130:131], v[130:131], s[46:47], v[60:61] op_sel_hi:[1,1,0]
  v_pk_fma_f32 v[132:133], v[132:133], s[46:47], v[60:61] op_sel_hi:[1,1,0]
  v_pk_fma_f32 v[134:135], v[134:135], s[46:47], v[60:61] op_sel_hi:[1,1,0]
  v_pk_fma_f32 v[136:137], v[136:137], s[46:47], v[60:61] op_sel_hi:[1,1,0]
  v_pk_fma_f32 v[138:139], v[138:139], s[46:47], v[60:61] op_sel_hi:[1,1,0]
  v_pk_mul_f32 v[128:129], v[128:129], v[236:237]
  v_pk_mul_f32 v[130:131], v[130:131], v[238:239]
  v_pk_mul_f32 v[132:133], v[132:133], v[240:241]
  v_pk_mul_f32 v[134:135], v[134:135], v[242:243]
  v_pk_mul_f32 v[136:137], v[136:137], v[244:245]
  v_pk_mul_f32 v[138:139], v[138:139], v[246:247]
  v_exp_f32 v128, v128
  v_exp_f32 v129, v129
  v_exp_f32 v130, v130
  v_exp_f32 v131, v131
  v_exp_f32 v132, v132
  v_exp_f32 v133, v133
  v_exp_f32 v134, v134
  v_exp_f32 v135, v135
  v_exp_f32 v136, v136
  v_exp_f32 v137, v137
  v_exp_f32 v138, v138
  v_exp_f32 v139, v139
  v_pk_add_f32 v[128:129], v[128:129], s[48:49]
  v_pk_add_f32 v[130:131], v[130:131], s[48:49]
  v_pk_add_f32 v[132:133], v[132:133], s[48:49]
  v_pk_add_f32 v[134:135], v[134:135], s[48:49]
  v_pk_add_f32 v[136:137], v[136:137], s[48:49]
  v_pk_add_f32 v[138:139], v[138:139], s[48:49]
  v_rcp_f32 v128, v128
  v_rcp_f32 v129, v129
  v_rcp_f32 v130, v130
  v_rcp_f32 v131, v131
  v_rcp_f32 v132, v132
  v_rcp_f32 v133, v133
  v_rcp_f32 v134, v134
  v_rcp_f32 v135, v135
  v_rcp_f32 v136, v136
  v_rcp_f32 v137, v137
  v_rcp_f32 v138, v138
  v_rcp_f32 v139, v139
  v_pk_mul_f32 v[236:237], v[236:237], v[128:129]
  v_pk_mul_f32 v[238:239], v[238:239], v[130:131]
  v_pk_mul_f32 v[240:241], v[240:241], v[132:133]
  v_pk_mul_f32 v[242:243], v[242:243], v[134:135]
  v_pk_mul_f32 v[244:245], v[244:245], v[136:137]
  v_pk_mul_f32 v[246:247], v[246:247], v[138:139]
  v_cvt_pk_bf16_f32 v160, v220, v221
  v_cvt_pk_bf16_f32 v161, v222, v223
  v_cvt_pk_bf16_f32 v162, v224, v225
  v_cvt_pk_bf16_f32 v163, v226, v227
  v_cvt_pk_bf16_f32 v164, v228, v229
  v_cvt_pk_bf16_f32 v165, v230, v231
  v_cvt_pk_bf16_f32 v166, v232, v233
  v_cvt_pk_bf16_f32 v167, v234, v235
  v_cvt_pk_bf16_f32 v168, v236, v237
  v_cvt_pk_bf16_f32 v169, v238, v239
  v_cvt_pk_bf16_f32 v170, v240, v241
  v_cvt_pk_bf16_f32 v171, v242, v243
  v_cvt_pk_bf16_f32 v172, v244, v245
  v_cvt_pk_bf16_f32 v173, v246, v247
  s_cmp_eq_u32 s27, 0
  s_cbranch_scc1 STF_40
  buffer_store_dwordx4 v[160:163], v54, s[4:7], s56 offen offset:0 sc1
  buffer_store_dwordx4 v[164:167], v54, s[4:7], s56 offen offset:1024 sc1
  buffer_store_dwordx4 v[168:171], v54, s[4:7], s56 offen offset:2048 sc1
  buffer_store_dwordx2 v[172:173], v54, s[4:7], s58 offen sc1
  s_branch STD_41
STF_40:
  buffer_store_dwordx4 v[160:163], v54, s[4:7], s56 offen offset:0
  buffer_store_dwordx4 v[164:167], v54, s[4:7], s56 offen offset:1024
  buffer_store_dwordx4 v[168:171], v54, s[4:7], s56 offen offset:2048
  buffer_store_dwordx2 v[172:173], v54, s[4:7], s58 offen
STD_41:
  s_add_u32 s38, s30, 5
  s_lshl_b32 s40, s38, 3
  s_add_u32 s40, s40, s31
  s_add_u32 s40, s40, s32
  v_mov_b32 v25, s40
  s_waitcnt vmcnt(0)
  s_mov_b64 exec, 1
  s_cmp_eq_u32 s27, 0
  s_cbranch_scc1 STF_42
  buffer_store_dword v25, v18, s[4:7], 0 offen sc1
  s_branch STD_43
STF_42:
  buffer_store_dword v25, v18, s[4:7], 0 offen
STD_43:
  s_mov_b64 exec, -1
  s_lshl_b32 s33, s20, 4
  s_lshl_b32 s34, s23, 2
  s_add_u32 s33, s33, s34
  s_add_u32 s33, s33, s22
  s_mul_i32 s33, s33, 57344
  v_lshlrev_b32 v228, 4, v0
  v_add_u32 v228, s33, v228
  s_and_b32 s94, s23, 3
  s_lshl_b32 s94, s94, 1
  s_xor_b32 s94, s94, 0
  s_mul_i32 s94, s94, 7168
  s_and_b32 s95, s23, 3
  s_lshl_b32 s95, s95, 1
  s_xor_b32 s95, s95, 1
  s_mul_i32 s95, s95, 7168
  s_and_b32 s96, s23, 3
  s_lshl_b32 s96, s96, 1
  s_xor_b32 s96, s96, 2
  s_mul_i32 s96, s96, 7168
  s_and_b32 s97, s23, 3
  s_lshl_b32 s97, s97, 1
  s_xor_b32 s97, s97, 3
  s_mul_i32 s97, s97, 7168
  s_and_b32 s98, s23, 3
  s_lshl_b32 s98, s98, 1
  s_xor_b32 s98, s98, 4
  s_mul_i32 s98, s98, 7168
  s_and_b32 s99, s23, 3
  s_lshl_b32 s99, s99, 1
  s_xor_b32 s99, s99, 5
  s_mul_i32 s99, s99, 7168
  s_and_b32 s100, s23, 3
  s_lshl_b32 s100, s100, 1
  s_xor_b32 s100, s100, 6
  s_mul_i32 s100, s100, 7168
  s_and_b32 s101, s23, 3
  s_lshl_b32 s101, s101, 1
  s_xor_b32 s101, s101, 7
  s_mul_i32 s101, s101, 7168
  s_lshl_b32 s35, s20, 9
  s_add_u32 s35, s35, 0xf00000
  s_and_b32 s36, s23, 1
  s_lshl_b32 s36, s36, 1
  s_add_u32 s36, s36, s53
  s_lshl_b32 s36, s36, 7
  s_add_u32 s36, s36, s35
  s_lshr_b32 s37, s23, 1
  s_lshl_b32 s37, s37, 6
  s_add_u32 s36, s36, s37
  v_and_b32 v229, 15, v0
  v_lshlrev_b32 v229, 2, v229
  v_add_u32 v229, s36, v229
  s_lshl_b32 s36, s21, 2
  s_add_u32 s36, s36, s35
  v_and_b32 v26, 3, v0
  v_lshlrev_b32 v26, 7, v26
  v_add_u32 v26, s36, v26
  v_cmp_lt_u32 vcc, 15, v0
  s_nop 1
  v_cndmask_b32 v229, v229, v26, vcc
  s_add_u32 s38, s30, 5
  s_lshl_b32 s40, s38, 3
  s_add_u32 s40, s40, s31
  s_mov_b32 s39, 131072
POLL_44:
  buffer_load_dword v27, v229, s[4:7], 0 offen sc1
  s_waitcnt vmcnt(0)
  v_subrev_u32 v25, s40, v27
  v_cmp_gt_u32 vcc, 0x80, v25
  s_sub_u32 s39, s39, 1
  s_cbranch_scc1 POLLD_45
  s_cmp_eq_u64 vcc, -1
  s_cbranch_scc0 POLL_44
POLLD_45:
  s_add_u32 m0, s52, 0x0
  s_add_u32 s33, s94, 0x680000
  buffer_load_dwordx4 v228, s[4:7], s33 offen offset:0 sc1 lds
  buffer_load_dwordx4 v228, s[4:7], s33 offen offset:1024 sc1 lds
  buffer_load_dwordx4 v228, s[4:7], s33 offen offset:2048 sc1 lds
  buffer_load_dwordx4 v228, s[4:7], s33 offen offset:3072 sc1 lds
  s_add_u32 m0, s52, 0x4000
  s_add_u32 s33, s94, 0x681000
  buffer_load_dwordx4 v228, s[4:7], s33 offen offset:0 sc1 lds
  buffer_load_dwordx4 v228, s[4:7], s33 offen offset:1024 sc1 lds
  buffer_load_dwordx4 v228, s[4:7], s33 offen offset:2048 sc1 lds
  s_add_u32 s33, s95, 0x67f400
  buffer_load_dwordx4 v228, s[4:7], s33 offen offset:3072 sc1 lds
  s_waitcnt vmcnt(4)
  s_barrier
  v_add_u32 v28, 0x11c00, v23
  ds_read_b128 v[80:83], v24 offset:0
  ds_read_b64_tr_b16 v[84:85], v28 offset:0
  ds_read_b64_tr_b16 v[86:87], v28 offset:2048
  ds_read_b128 v[88:91], v24 offset:512
  ds_read_b64_tr_b16 v[92:93], v28 offset:1024
  ds_read_b64_tr_b16 v[94:95], v28 offset:3072
  ds_read_b128 v[96:99], v24 offset:1024
  ds_read_b64_tr_b16 v[100:101], v28 offset:4096
  ds_read_b64_tr_b16 v[102:103], v28 offset:6144
  ds_read_b128 v[104:107], v24 offset:1536
  ds_read_b64_tr_b16 v[108:109], v28 offset:5120
  ds_read_b64_tr_b16 v[110:111], v28 offset:7168
  s_waitcnt lgkmcnt(9)
  v_mfma_f32_32x32x16_bf16 v[64:79], v[84:87], v[80:83], 0
  ds_read_b128 v[112:115], v24 offset:2048
  ds_read_b64_tr_b16 v[116:117], v28 offset:8192
  ds_read_b64_tr_b16 v[118:119], v28 offset:10240
  s_add_u32 m0, s52, 0x8000
  s_add_u32 s33, s95, 0x680400
  buffer_load_dwordx4 v228, s[4:7], s33 offen offset:0 sc1 lds
  s_waitcnt lgkmcnt(9)
  v_mfma_f32_32x32x16_bf16 v[64:79], v[92:95], v[88:91], v[64:79]
  ds_read_b128 v[80:83], v24 offset:2560
  ds_read_b64_tr_b16 v[84:85], v28 offset:9216
  ds_read_b64_tr_b16 v[86:87], v28 offset:11264
  buffer_load_dwordx4 v228, s[4:7], s33 offen offset:1024 sc1 lds
  s_waitcnt lgkmcnt(9)
  v_mfma_f32_32x32x16_bf16 v[64:79], v[100:103], v[96:99], v[64:79]
  ds_read_b128 v[88:91], v24 offset:3072
  ds_read_b64_tr_b16 v[92:93], v28 offset:12288
  ds_read_b64_tr_b16 v[94:95], v28 offset:14336
  buffer_load_dwordx4 v228, s[4:7], s33 offen offset:2048 sc1 lds
  s_waitcnt lgkmcnt(9)
  v_mfma_f32_32x32x16_bf16 v[64:79], v[108:111], v[104:107], v[64:79]
  ds_read_b128 v[96:99], v24 offset:3584
  ds_read_b64_tr_b16 v[100:101], v28 offset:13312
  ds_read_b64_tr_b16 v[102:103], v28 offset:15360
  buffer_load_dwordx4 v228, s[4:7], s33 offen offset:3072 sc1 lds
  s_waitcnt lgkmcnt(9)
  v_mfma_f32_32x32x16_bf16 v[64:79], v[116:119], v[112:115], v[64:79]
  s_waitcnt vmcnt(4)
  s_barrier
  ds_read_b128 v[104:107], v24 offset:16384
  ds_read_b64_tr_b16 v[108:109], v28 offset:16384
  ds_read_b64_tr_b16 v[110:111], v28 offset:18432
  s_add_u32 m0, s52, 0xc000
  s_add_u32 s33, s95, 0x681400
  buffer_load_dwordx4 v228, s[4:7], s33 offen offset:0 sc1 lds
  s_waitcnt lgkmcnt(9)
  v_mfma_f32_32x32x16_bf16 v[64:79], v[84:87], v[80:83], v[64:79]
  ds_read_b128 v[112:115], v24 offset:16896
  ds_read_b64_tr_b16 v[116:117], v28 offset:17408
  ds_read_b64_tr_b16 v[118:119], v28 offset:19456
  buffer_load_dwordx4 v228, s[4:7], s33 offen offset:1024 sc1 lds
  s_waitcnt lgkmcnt(9)
  v_mfma_f32_32x32x16_bf16 v[64:79], v[92:95], v[88:91], v[64:79]
  ds_read_b128 v[80:83], v24 offset:17408
  ds_read_b64_tr_b16 v[84:85], v28 offset:20480
  ds_read_b64_tr_b16 v[86:87], v28 offset:22528
  s_add_u32 s33, s96, 0x67f800
  buffer_load_dwordx4 v228, s[4:7], s33 offen offset:2048 sc1 lds
  s_waitcnt lgkmcnt(9)
  v_mfma_f32_32x32x16_bf16 v[64:79], v[100:103], v[96:99], v[64:79]
  ds_read_b128 v[88:91], v24 offset:17920
  ds_read_b64_tr_b16 v[92:93], v28 offset:21504
  ds_read_b64_tr_b16 v[94:95], v28 offset:23552
  buffer_load_dwordx4 v228, s[4:7], s33 offen offset:3072 sc1 lds
  s_waitcnt lgkmcnt(9)
  v_mfma_f32_32x32x16_bf16 v[64:79], v[108:111], v[104:107], v[64:79]
  ds_read_b128 v[96:99], v24 offset:18432
  ds_read_b64_tr_b16 v[100:101], v28 offset:24576
  ds_read_b64_tr_b16 v[102:103], v28 offset:26624
  s_waitcnt lgkmcnt(9)
  v_mfma_f32_32x32x16_bf16 v[64:79], v[116:119], v[112:115], v[64:79]
  ds_read_b128 v[104:107], v24 offset:18944
  ds_read_b64_tr_b16 v[108:109], v28 offset:25600
  ds_read_b64_tr_b16 v[110:111], v28 offset:27648
  s_waitcnt lgkmcnt(9)
  v_mfma_f32_32x32x16_bf16 v[64:79], v[84:87], v[80:83], v[64:79]
  ds_read_b128 v[112:115], v24 offset:19456
  ds_read_b64_tr_b16 v[116:117], v28 offset:28672
  ds_read_b64_tr_b16 v[118:119], v28 offset:30720
  s_waitcnt lgkmcnt(9)
  v_mfma_f32_32x32x16_bf16 v[64:79], v[92:95], v[88:91], v[64:79]
  ds_read_b128 v[80:83], v24 offset:19968
  ds_read_b64_tr_b16 v[84:85], v28 offset:29696
  ds_read_b64_tr_b16 v[86:87], v28 offset:31744
  s_waitcnt lgkmcnt(9)
  v_mfma_f32_32x32x16_bf16 v[64:79], v[100:103], v[96:99], v[64:79]
  s_waitcnt vmcnt(4)
  s_barrier
  ds_read_b128 v[88:91], v24 offset:32768
  ds_read_b64_tr_b16 v[92:93], v28 offset:32768
  ds_read_b64_tr_b16 v[94:95], v28 offset:34816
  s_add_u32 m0, s52, 0x0
  s_add_u32 s33, s96, 0x680800
  buffer_load_dwordx4 v228, s[4:7], s33 offen offset:0 sc1 lds
  s_waitcnt lgkmcnt(9)
  v_mfma_f32_32x32x16_bf16 v[64:79], v[108:111], v[104:107], v[64:79]
  ds_read_b128 v[96:99], v24 offset:33280
  ds_read_b64_tr_b16 v[100:101], v28 offset:33792
  ds_read_b64_tr_b16 v[102:103], v28 offset:35840
  buffer_load_dwordx4 v228, s[4:7], s33 offen offset:1024 sc1 lds
  s_waitcnt lgkmcnt(9)
  v_mfma_f32_32x32x16_bf16 v[64:79], v[116:119], v[112:115], v[64:79]
  ds_read_b128 v[104:107], v24 offset:33792
  ds_read_b64_tr_b16 v[108:109], v28 offset:36864
  ds_read_b64_tr_b16 v[110:111], v28 offset:38912
  buffer_load_dwordx4 v228, s[4:7], s33 offen offset:2048 sc1 lds
  s_waitcnt lgkmcnt(9)
  v_mfma_f32_32x32x16_bf16 v[64:79], v[84:87], v[80:83], v[64:79]
  ds_read_b128 v[112:115], v24 offset:34304
  ds_read_b64_tr_b16 v[116:117], v28 offset:37888
  ds_read_b64_tr_b16 v[118:119], v28 offset:39936
  buffer_load_dwordx4 v228, s[4:7], s33 offen offset:3072 sc1 lds
  s_waitcnt lgkmcnt(9)
  v_mfma_f32_32x32x16_bf16 v[64:79], v[92:95], v[88:91], v[64:79]
  ds_read_b128 v[80:83], v24 offset:34816
  ds_read_b64_tr_b16 v[84:85], v28 offset:40960
  ds_read_b64_tr_b16 v[86:87], v28 offset:43008
  s_waitcnt lgkmcnt(9)
  v_mfma_f32_32x32x16_bf16 v[64:79], v[100:103], v[96:99], v[64:79]
  ds_read_b128 v[88:91], v24 offset:35328
  ds_read_b64_tr_b16 v[92:93], v28 offset:41984
  ds_read_b64_tr_b16 v[94:95], v28 offset:44032
  s_waitcnt lgkmcnt(9)
  v_mfma_f32_32x32x16_bf16 v[64:79], v[108:111], v[104:107], v[64:79]
  ds_read_b128 v[96:99], v24 offset:35840
  ds_read_b64_tr_b16 v[100:101], v28 offset:45056
  ds_read_b64_tr_b16 v[102:103], v28 offset:47104
  s_waitcnt lgkmcnt(9)
  v_mfma_f32_32x32x16_bf16 v[64:79], v[116:119], v[112:115], v[64:79]
  ds_read_b128 v[104:107], v24 offset:36352
  ds_read_b64_tr_b16 v[108:109], v28 offset:46080
  ds_read_b64_tr_b16 v[110:111], v28 offset:48128
  s_waitcnt lgkmcnt(9)
  v_mfma_f32_32x32x16_bf16 v[64:79], v[84:87], v[80:83], v[64:79]
  s_waitcnt vmcnt(4)
  s_barrier
  ds_read_b128 v[112:115], v24 offset:49152
  ds_read_b64_tr_b16 v[116:117], v28 offset:49152
  ds_read_b64_tr_b16 v[118:119], v28 offset:51200
  s_add_u32 m0, s52, 0x4000
  s_add_u32 s33, s96, 0x681800
  buffer_load_dwordx4 v228, s[4:7], s33 offen offset:0 sc1 lds
  s_waitcnt lgkmcnt(9)
  v_mfma_f32_32x32x16_bf16 v[64:79], v[92:95], v[88:91], v[64:79]
  ds_read_b128 v[80:83], v24 offset:49664
  ds_read_b64_tr_b16 v[84:85], v28 offset:50176
  ds_read_b64_tr_b16 v[86:87], v28 offset:52224
  s_add_u32 s33, s97, 0x67fc00
  buffer_load_dwordx4 v228, s[4:7], s33 offen offset:1024 sc1 lds
  s_waitcnt lgkmcnt(9)
  v_mfma_f32_32x32x16_bf16 v[64:79], v[100:103], v[96:99], v[64:79]
  ds_read_b128 v[88:91], v24 offset:50176
  ds_read_b64_tr_b16 v[92:93], v28 offset:53248
  ds_read_b64_tr_b16 v[94:95], v28 offset:55296
  buffer_load_dwordx4 v228, s[4:7], s33 offen offset:2048 sc1 lds
  s_waitcnt lgkmcnt(9)
  v_mfma_f32_32x32x16_bf16 v[64:79], v[108:111], v[104:107], v[64:79]
  ds_read_b128 v[96:99], v24 offset:50688
  ds_read_b64_tr_b16 v[100:101], v28 offset:54272
  ds_read_b64_tr_b16 v[102:103], v28 offset:56320
  buffer_load_dwordx4 v228, s[4:7], s33 offen offset:3072 sc1 lds
  s_waitcnt lgkmcnt(9)
  v_mfma_f32_32x32x16_bf16 v[64:79], v[116:119], v[112:115], v[64:79]
  ds_read_b128 v[104:107], v24 offset:51200
  ds_read_b64_tr_b16 v[108:109], v28 offset:57344
  ds_read_b64_tr_b16 v[110:111], v28 offset:59392
  s_waitcnt lgkmcnt(9)
  v_mfma_f32_32x32x16_bf16 v[64:79], v[84:87], v[80:83], v[64:79]
  ds_read_b128 v[112:115], v24 offset:51712
  ds_read_b64_tr_b16 v[116:117], v28 offset:58368
  ds_read_b64_tr_b16 v[118:119], v28 offset:60416
  s_waitcnt lgkmcnt(9)
  v_mfma_f32_32x32x16_bf16 v[64:79], v[92:95], v[88:91], v[64:79]
  v_add_u32 v28, 0x20c00, v23
  ds_read_b128 v[80:83], v24 offset:52224
  ds_read_b64_tr_b16 v[84:85], v28 offset:0
  ds_read_b64_tr_b16 v[86:87], v28 offset:2048
  s_waitcnt lgkmcnt(9)
  v_mfma_f32_32x32x16_bf16 v[64:79], v[100:103], v[96:99], v[64:79]
  ds_read_b128 v[88:91], v24 offset:52736
  ds_read_b64_tr_b16 v[92:93], v28 offset:1024
  ds_read_b64_tr_b16 v[94:95], v28 offset:3072
  s_waitcnt lgkmcnt(9)
  v_mfma_f32_32x32x16_bf16 v[64:79], v[108:111], v[104:107], v[64:79]
  s_waitcnt vmcnt(4)
  s_barrier
  ds_read_b128 v[96:99], v24 offset:0
  ds_read_b64_tr_b16 v[100:101], v28 offset:4096
  ds_read_b64_tr_b16 v[102:103], v28 offset:6144
  s_add_u32 m0, s52, 0x8000
  s_add_u32 s33, s97, 0x680c00
  buffer_load_dwordx4 v228, s[4:7], s33 offen offset:0 sc1 lds
  s_waitcnt lgkmcnt(9)
  v_mfma_f32_32x32x16_bf16 v[64:79], v[116:119], v[112:115], v[64:79]
  ds_read_b128 v[104:107], v24 offset:512
  ds_read_b64_tr_b16 v[108:109], v28 offset:5120
  ds_read_b64_tr_b16 v[110:111], v28 offset:7168
  buffer_load_dwordx4 v228, s[4:7], s33 offen offset:1024 sc1 lds
  s_waitcnt lgkmcnt(9)
  v_mfma_f32_32x32x16_bf16 v[64:79], v[84:87], v[80:83], v[64:79]
  ds_read_b128 v[112:115], v24 offset:1024
  ds_read_b64_tr_b16 v[116:117], v28 offset:8192
  ds_read_b64_tr_b16 v[118:119], v28 offset:10240
  buffer_load_dwordx4 v228, s[4:7], s33 offen offset:2048 sc1 lds
  s_waitcnt lgkmcnt(9)
  v_mfma_f32_32x32x16_bf16 v[64:79], v[92:95], v[88:91], v[64:79]
  ds_read_b128 v[80:83], v24 offset:1536
  ds_read_b64_tr_b16 v[84:85], v28 offset:9216
  ds_read_b64_tr_b16 v[86:87], v28 offset:11264
  buffer_load_dwordx4 v228, s[4:7], s33 offen offset:3072 sc1 lds
  s_waitcnt lgkmcnt(9)
  v_mfma_f32_32x32x16_bf16 v[64:79], v[100:103], v[96:99], v[64:79]
  ds_read_b128 v[88:91], v24 offset:2048
  ds_read_b64_tr_b16 v[92:93], v28 offset:12288
  ds_read_b64_tr_b16 v[94:95], v28 offset:14336
  s_waitcnt lgkmcnt(9)
  v_mfma_f32_32x32x16_bf16 v[64:79], v[108:111], v[104:107], v[64:79]
  ds_read_b128 v[96:99], v24 offset:2560
  ds_read_b64_tr_b16 v[100:101], v28 offset:13312
  ds_read_b64_tr_b16 v[102:103], v28 offset:15360
  s_waitcnt lgkmcnt(9)
  v_mfma_f32_32x32x16_bf16 v[64:79], v[116:119], v[112:115], v[64:79]
  ds_read_b128 v[104:107], v24 offset:3072
  ds_read_b64_tr_b16 v[108:109], v28 offset:16384
  ds_read_b64_tr_b16 v[110:111], v28 offset:18432
  s_waitcnt lgkmcnt(9)
  v_mfma_f32_32x32x16_bf16 v[64:79], v[84:87], v[80:83], v[64:79]
  ds_read_b128 v[112:115], v24 offset:3584
  ds_read_b64_tr_b16 v[116:117], v28 offset:17408
  ds_read_b64_tr_b16 v[118:119], v28 offset:19456
  s_waitcnt lgkmcnt(9)
  v_mfma_f32_32x32x16_bf16 v[64:79], v[92:95], v[88:91], v[64:79]
  s_waitcnt vmcnt(4)
  s_barrier
  ds_read_b128 v[80:83], v24 offset:16384
  ds_read_b64_tr_b16 v[84:85], v28 offset:20480
  ds_read_b64_tr_b16 v[86:87], v28 offset:22528
  s_add_u32 m0, s52, 0xc000
  s_add_u32 s33, s98, 0x680000
  buffer_load_dwordx4 v228, s[4:7], s33 offen offset:0 sc1 lds
  s_waitcnt lgkmcnt(9)
  v_mfma_f32_32x32x16_bf16 v[64:79], v[100:103], v[96:99], v[64:79]
  ds_read_b128 v[88:91], v24 offset:16896
  ds_read_b64_tr_b16 v[92:93], v28 offset:21504
  ds_read_b64_tr_b16 v[94:95], v28 offset:23552
  buffer_load_dwordx4 v228, s[4:7], s33 offen offset:1024 sc1 lds
  s_waitcnt lgkmcnt(9)
  v_mfma_f32_32x32x16_bf16 v[64:79], v[108:111], v[104:107], v[64:79]
  v_add_u32 v28, 0x10000, v23
  ds_read_b128 v[96:99], v24 offset:17408
  ds_read_b64_tr_b16 v[100:101], v28 offset:0
  ds_read_b64_tr_b16 v[102:103], v28 offset:2048
  buffer_load_dwordx4 v228, s[4:7], s33 offen offset:2048 sc1 lds
  s_waitcnt lgkmcnt(9)
  v_mfma_f32_32x32x16_bf16 v[64:79], v[116:119], v[112:115], v[64:79]
  ds_read_b128 v[104:107], v24 offset:17920
  ds_read_b64_tr_b16 v[108:109], v28 offset:1024
  ds_read_b64_tr_b16 v[110:111], v28 offset:3072
  buffer_load_dwordx4 v228, s[4:7], s33 offen offset:3072 sc1 lds
  s_waitcnt lgkmcnt(9)
  v_mfma_f32_32x32x16_bf16 v[64:79], v[84:87], v[80:83], v[64:79]
  ds_read_b128 v[112:115], v24 offset:18432
  ds_read_b64_tr_b16 v[116:117], v28 offset:4096
  ds_read_b64_tr_b16 v[118:119], v28 offset:6144
  s_waitcnt lgkmcnt(9)
  v_mfma_f32_32x32x16_bf16 v[64:79], v[92:95], v[88:91], v[64:79]
  ds_read_b128 v[80:83], v24 offset:18944
  ds_read_b64_tr_b16 v[84:85], v28 offset:5120
  ds_read_b64_tr_b16 v[86:87], v28 offset:7168
  s_waitcnt lgkmcnt(9)
  v_mfma_f32_32x32x16_bf16 v[64:79], v[100:103], v[96:99], v[64:79]
  ds_read_b128 v[88:91], v24 offset:19456
  ds_read_b64_tr_b16 v[92:93], v28 offset:8192
  ds_read_b64_tr_b16 v[94:95], v28 offset:10240
  s_waitcnt lgkmcnt(9)
  v_mfma_f32_32x32x16_bf16 v[64:79], v[108:111], v[104:107], v[64:79]
  ds_read_b128 v[96:99], v24 offset:19968
  ds_read_b64_tr_b16 v[100:101], v28 offset:9216
  ds_read_b64_tr_b16 v[102:103], v28 offset:11264
  s_waitcnt lgkmcnt(9)
  v_mfma_f32_32x32x16_bf16 v[64:79], v[116:119], v[112:115], v[64:79]
  s_waitcnt vmcnt(4)
  s_barrier
  ds_read_b128 v[104:107], v24 offset:32768
  ds_read_b64_tr_b16 v[108:109], v28 offset:12288
  ds_read_b64_tr_b16 v[110:111], v28 offset:14336
  s_add_u32 m0, s52, 0x0
  s_add_u32 s33, s98, 0x681000
  buffer_load_dwordx4 v228, s[4:7], s33 offen offset:0 sc1 lds
  s_waitcnt lgkmcnt(9)
  v_mfma_f32_32x32x16_bf16 v[64:79], v[84:87], v[80:83], v[64:79]
  ds_read_b128 v[112:115], v24 offset:33280
  ds_read_b64_tr_b16 v[116:117], v28 offset:13312
  ds_read_b64_tr_b16 v[118:119], v28 offset:15360
  buffer_load_dwordx4 v228, s[4:7], s33 offen offset:1024 sc1 lds
  s_waitcnt lgkmcnt(9)
  v_mfma_f32_32x32x16_bf16 v[64:79], v[92:95], v[88:91], v[64:79]
  ds_read_b128 v[80:83], v24 offset:33792
  ds_read_b64_tr_b16 v[84:85], v28 offset:16384
  ds_read_b64_tr_b16 v[86:87], v28 offset:18432
  buffer_load_dwordx4 v228, s[4:7], s33 offen offset:2048 sc1 lds
  s_waitcnt lgkmcnt(9)
  v_mfma_f32_32x32x16_bf16 v[64:79], v[100:103], v[96:99], v[64:79]
  ds_read_b128 v[88:91], v24 offset:34304
  ds_read_b64_tr_b16 v[92:93], v28 offset:17408
  ds_read_b64_tr_b16 v[94:95], v28 offset:19456
  s_add_u32 s33, s99, 0x67f400
  buffer_load_dwordx4 v228, s[4:7], s33 offen offset:3072 sc1 lds
  s_waitcnt lgkmcnt(9)
  v_mfma_f32_32x32x16_bf16 v[64:79], v[108:111], v[104:107], v[64:79]
  ds_read_b128 v[96:99], v24 offset:34816
  ds_read_b64_tr_b16 v[100:101], v28 offset:20480
  ds_read_b64_tr_b16 v[102:103], v28 offset:22528
  s_waitcnt lgkmcnt(9)
  v_mfma_f32_32x32x16_bf16 v[64:79], v[116:119], v[112:115], v[64:79]
  ds_read_b128 v[104:107], v24 offset:35328
  ds_read_b64_tr_b16 v[108:109], v28 offset:21504
  ds_read_b64_tr_b16 v[110:111], v28 offset:23552
  s_waitcnt lgkmcnt(9)
  v_mfma_f32_32x32x16_bf16 v[64:79], v[84:87], v[80:83], v[64:79]
  ds_read_b128 v[112:115], v24 offset:35840
  ds_read_b64_tr_b16 v[116:117], v28 offset:24576
  ds_read_b64_tr_b16 v[118:119], v28 offset:26624
  s_waitcnt lgkmcnt(9)
  v_mfma_f32_32x32x16_bf16 v[64:79], v[92:95], v[88:91], v[64:79]
  ds_read_b128 v[80:83], v24 offset:36352
  ds_read_b64_tr_b16 v[84:85], v28 offset:25600
  ds_read_b64_tr_b16 v[86:87], v28 offset:27648
  s_waitcnt lgkmcnt(9)
  v_mfma_f32_32x32x16_bf16 v[64:79], v[100:103], v[96:99], v[64:79]
  s_waitcnt vmcnt(4)
  s_barrier
  ds_read_b128 v[88:91], v24 offset:49152
  ds_read_b64_tr_b16 v[92:93], v28 offset:28672
  ds_read_b64_tr_b16 v[94:95], v28 offset:30720
  s_add_u32 m0, s52, 0x4000
  s_add_u32 s33, s99, 0x680400
  buffer_load_dwordx4 v228, s[4:7], s33 offen offset:0 sc1 lds
  s_waitcnt lgkmcnt(9)
  v_mfma_f32_32x32x16_bf16 v[64:79], v[108:111], v[104:107], v[64:79]
  ds_read_b128 v[96:99], v24 offset:49664
  ds_read_b64_tr_b16 v[100:101], v28 offset:29696
  ds_read_b64_tr_b16 v[102:103], v28 offset:31744
  buffer_load_dwordx4 v228, s[4:7], s33 offen offset:1024 sc1 lds
  s_waitcnt lgkmcnt(9)
  v_mfma_f32_32x32x16_bf16 v[64:79], v[116:119], v[112:115], v[64:79]
  ds_read_b128 v[104:107], v24 offset:50176
  ds_read_b64_tr_b16 v[108:109], v28 offset:32768
  ds_read_b64_tr_b16 v[110:111], v28 offset:34816
  buffer_load_dwordx4 v228, s[4:7], s33 offen offset:2048 sc1 lds
  s_waitcnt lgkmcnt(9)
  v_mfma_f32_32x32x16_bf16 v[64:79], v[84:87], v[80:83], v[64:79]
  ds_read_b128 v[112:115], v24 offset:50688
  ds_read_b64_tr_b16 v[116:117], v28 offset:33792
  ds_read_b64_tr_b16 v[118:119], v28 offset:35840
  buffer_load_dwordx4 v228, s[4:7], s33 offen offset:3072 sc1 lds
  s_waitcnt lgkmcnt(9)
  v_mfma_f32_32x32x16_bf16 v[64:79], v[92:95], v[88:91], v[64:79]
  ds_read_b128 v[80:83], v24 offset:51200
  ds_read_b64_tr_b16 v[84:85], v28 offset:36864
  ds_read_b64_tr_b16 v[86:87], v28 offset:38912
  s_waitcnt lgkmcnt(9)
  v_mfma_f32_32x32x16_bf16 v[64:79], v[100:103], v[96:99], v[64:79]
  ds_read_b128 v[88:91], v24 offset:51712
  ds_read_b64_tr_b16 v[92:93], v28 offset:37888
  ds_read_b64_tr_b16 v[94:95], v28 offset:39936
  s_waitcnt lgkmcnt(9)
  v_mfma_f32_32x32x16_bf16 v[64:79], v[108:111], v[104:107], v[64:79]
  ds_read_b128 v[96:99], v24 offset:52224
  ds_read_b64_tr_b16 v[100:101], v28 offset:40960
  ds_read_b64_tr_b16 v[102:103], v28 offset:43008
  s_waitcnt lgkmcnt(9)
  v_mfma_f32_32x32x16_bf16 v[64:79], v[116:119], v[112:115], v[64:79]
  ds_read_b128 v[104:107], v24 offset:52736
  ds_read_b64_tr_b16 v[108:109], v28 offset:41984
  ds_read_b64_tr_b16 v[110:111], v28 offset:44032
  s_waitcnt lgkmcnt(9)
  v_mfma_f32_32x32x16_bf16 v[64:79], v[84:87], v[80:83], v[64:79]
  s_waitcnt vmcnt(4)
  s_barrier
  ds_read_b128 v[112:115], v24 offset:0
  ds_read_b64_tr_b16 v[116:117], v28 offset:45056
  ds_read_b64_tr_b16 v[118:119], v28 offset:47104
  s_add_u32 m0, s52, 0x8000
  s_add_u32 s33, s99, 0x681400
  buffer_load_dwordx4 v228, s[4:7], s33 offen offset:0 sc1 lds
  s_waitcnt lgkmcnt(9)
  v_mfma_f32_32x32x16_bf16 v[64:79], v[92:95], v[88:91], v[64:79]
  ds_read_b128 v[80:83], v24 offset:512
  ds_read_b64_tr_b16 v[84:85], v28 offset:46080
  ds_read_b64_tr_b16 v[86:87], v28 offset:48128
  buffer_load_dwordx4 v228, s[4:7], s33 offen offset:1024 sc1 lds
  s_waitcnt lgkmcnt(9)
  v_mfma_f32_32x32x16_bf16 v[64:79], v[100:103], v[96:99], v[64:79]
  ds_read_b128 v[88:91], v24 offset:1024
  ds_read_b64_tr_b16 v[92:93], v28 offset:49152
  ds_read_b64_tr_b16 v[94:95], v28 offset:51200
  s_add_u32 s33, s100, 0x67f800
  buffer_load_dwordx4 v228, s[4:7], s33 offen offset:2048 sc1 lds
  s_waitcnt lgkmcnt(9)
  v_mfma_f32_32x32x16_bf16 v[64:79], v[108:111], v[104:107], v[64:79]
  ds_read_b128 v[96:99], v24 offset:1536
  ds_read_b64_tr_b16 v[100:101], v28 offset:50176
  ds_read_b64_tr_b16 v[102:103], v28 offset:52224
  buffer_load_dwordx4 v228, s[4:7], s33 offen offset:3072 sc1 lds
  s_waitcnt lgkmcnt(9)
  v_mfma_f32_32x32x16_bf16 v[64:79], v[116:119], v[112:115], v[64:79]
  ds_read_b128 v[104:107], v24 offset:2048
  ds_read_b64_tr_b16 v[108:109], v28 offset:53248
  ds_read_b64_tr_b16 v[110:111], v28 offset:55296
  s_waitcnt lgkmcnt(9)
  v_mfma_f32_32x32x16_bf16 v[64:79], v[84:87], v[80:83], v[64:79]
  ds_read_b128 v[112:115], v24 offset:2560
  ds_read_b64_tr_b16 v[116:117], v28 offset:54272
  ds_read_b64_tr_b16 v[118:119], v28 offset:56320
  s_waitcnt lgkmcnt(9)
  v_mfma_f32_32x32x16_bf16 v[64:79], v[92:95], v[88:91], v[64:79]
  ds_read_b128 v[80:83], v24 offset:3072
  ds_read_b64_tr_b16 v[84:85], v28 offset:57344
  ds_read_b64_tr_b16 v[86:87], v28 offset:59392
  s_waitcnt lgkmcnt(9)
  v_mfma_f32_32x32x16_bf16 v[64:79], v[100:103], v[96:99], v[64:79]
  ds_read_b128 v[88:91], v24 offset:3584
  ds_read_b64_tr_b16 v[92:93], v28 offset:58368
  ds_read_b64_tr_b16 v[94:95], v28 offset:60416
  s_waitcnt lgkmcnt(9)
  v_mfma_f32_32x32x16_bf16 v[64:79], v[108:111], v[104:107], v[64:79]
  s_waitcnt vmcnt(4)
  s_barrier
  v_add_u32 v28, 0x1f000, v23
  ds_read_b128 v[96:99], v24 offset:16384
  ds_read_b64_tr_b16 v[100:101], v28 offset:0
  ds_read_b64_tr_b16 v[102:103], v28 offset:2048
  s_add_u32 m0, s52, 0xc000
  s_add_u32 s33, s100, 0x680800
  buffer_load_dwordx4 v228, s[4:7], s33 offen offset:0 sc1 lds
  s_waitcnt lgkmcnt(9)
  v_mfma_f32_32x32x16_bf16 v[64:79], v[116:119], v[112:115], v[64:79]
  ds_read_b128 v[104:107], v24 offset:16896
  ds_read_b64_tr_b16 v[108:109], v28 offset:1024
  ds_read_b64_tr_b16 v[110:111], v28 offset:3072
  buffer_load_dwordx4 v228, s[4:7], s33 offen offset:1024 sc1 lds
  s_waitcnt lgkmcnt(9)
  v_mfma_f32_32x32x16_bf16 v[64:79], v[84:87], v[80:83], v[64:79]
  ds_read_b128 v[112:115], v24 offset:17408
  ds_read_b64_tr_b16 v[116:117], v28 offset:4096
  ds_read_b64_tr_b16 v[118:119], v28 offset:6144
  buffer_load_dwordx4 v228, s[4:7], s33 offen offset:2048 sc1 lds
  s_waitcnt lgkmcnt(9)
  v_mfma_f32_32x32x16_bf16 v[64:79], v[92:95], v[88:91], v[64:79]
  ds_read_b128 v[80:83], v24 offset:17920
  ds_read_b64_tr_b16 v[84:85], v28 offset:5120
  ds_read_b64_tr_b16 v[86:87], v28 offset:7168
  buffer_load_dwordx4 v228, s[4:7], s33 offen offset:3072 sc1 lds
  s_waitcnt lgkmcnt(9)
  v_mfma_f32_32x32x16_bf16 v[64:79], v[100:103], v[96:99], v[64:79]
  ds_read_b128 v[88:91], v24 offset:18432
  ds_read_b64_tr_b16 v[92:93], v28 offset:8192
  ds_read_b64_tr_b16 v[94:95], v28 offset:10240
  s_waitcnt lgkmcnt(9)
  v_mfma_f32_32x32x16_bf16 v[64:79], v[108:111], v[104:107], v[64:79]
  ds_read_b128 v[96:99], v24 offset:18944
  ds_read_b64_tr_b16 v[100:101], v28 offset:9216
  ds_read_b64_tr_b16 v[102:103], v28 offset:11264
  s_waitcnt lgkmcnt(9)
  v_mfma_f32_32x32x16_bf16 v[64:79], v[116:119], v[112:115], v[64:79]
  ds_read_b128 v[104:107], v24 offset:19456
  ds_read_b64_tr_b16 v[108:109], v28 offset:12288
  ds_read_b64_tr_b16 v[110:111], v28 offset:14336
  s_waitcnt lgkmcnt(9)
  v_mfma_f32_32x32x16_bf16 v[64:79], v[84:87], v[80:83], v[64:79]
  ds_read_b128 v[112:115], v24 offset:19968
  ds_read_b64_tr_b16 v[116:117], v28 offset:13312
  ds_read_b64_tr_b16 v[118:119], v28 offset:15360
  s_waitcnt lgkmcnt(9)
  v_mfma_f32_32x32x16_bf16 v[64:79], v[92:95], v[88:91], v[64:79]
  s_waitcnt vmcnt(4)
  s_barrier
  ds_read_b128 v[80:83], v24 offset:32768
  ds_read_b64_tr_b16 v[84:85], v28 offset:16384
  ds_read_b64_tr_b16 v[86:87], v28 offset:18432
  s_add_u32 m0, s52, 0x0
  s_add_u32 s33, s100, 0x681800
  buffer_load_dwordx4 v228, s[4:7], s33 offen offset:0 sc1 lds
  s_waitcnt lgkmcnt(9)
  v_mfma_f32_32x32x16_bf16 v[64:79], v[100:103], v[96:99], v[64:79]
  ds_read_b128 v[88:91], v24 offset:33280
  ds_read_b64_tr_b16 v[92:93], v28 offset:17408
  ds_read_b64_tr_b16 v[94:95], v28 offset:19456
  s_add_u32 s33, s101, 0x67fc00
  buffer_load_dwordx4 v228, s[4:7], s33 offen offset:1024 sc1 lds
  s_waitcnt lgkmcnt(9)
  v_mfma_f32_32x32x16_bf16 v[64:79], v[108:111], v[104:107], v[64:79]
  ds_read_b128 v[96:99], v24 offset:33792
  ds_read_b64_tr_b16 v[100:101], v28 offset:20480
  ds_read_b64_tr_b16 v[102:103], v28 offset:22528
  buffer_load_dwordx4 v228, s[4:7], s33 offen offset:2048 sc1 lds
  s_waitcnt lgkmcnt(9)
  v_mfma_f32_32x32x16_bf16 v[64:79], v[116:119], v[112:115], v[64:79]
  ds_read_b128 v[104:107], v24 offset:34304
  ds_read_b64_tr_b16 v[108:109], v28 offset:21504
  ds_read_b64_tr_b16 v[110:111], v28 offset:23552
  buffer_load_dwordx4 v228, s[4:7], s33 offen offset:3072 sc1 lds
  s_waitcnt lgkmcnt(9)
  v_mfma_f32_32x32x16_bf16 v[64:79], v[84:87], v[80:83], v[64:79]
  ds_read_b128 v[112:115], v24 offset:34816
  ds_read_b64_tr_b16 v[116:117], v28 offset:24576
  ds_read_b64_tr_b16 v[118:119], v28 offset:26624
  s_waitcnt lgkmcnt(9)
  v_mfma_f32_32x32x16_bf16 v[64:79], v[92:95], v[88:91], v[64:79]
  ds_read_b128 v[80:83], v24 offset:35328
  ds_read_b64_tr_b16 v[84:85], v28 offset:25600
  ds_read_b64_tr_b16 v[86:87], v28 offset:27648
  s_waitcnt lgkmcnt(9)
  v_mfma_f32_32x32x16_bf16 v[64:79], v[100:103], v[96:99], v[64:79]
  v_add_u32 v28, 0x10000, v23
  ds_read_b128 v[88:91], v24 offset:35840
  ds_read_b64_tr_b16 v[92:93], v28 offset:0
  ds_read_b64_tr_b16 v[94:95], v28 offset:2048
  s_waitcnt lgkmcnt(9)
  v_mfma_f32_32x32x16_bf16 v[64:79], v[108:111], v[104:107], v[64:79]
  ds_read_b128 v[96:99], v24 offset:36352
  ds_read_b64_tr_b16 v[100:101], v28 offset:1024
  ds_read_b64_tr_b16 v[102:103], v28 offset:3072
  s_waitcnt lgkmcnt(9)
  v_mfma_f32_32x32x16_bf16 v[64:79], v[116:119], v[112:115], v[64:79]
  s_waitcnt vmcnt(4)
  s_barrier
  ds_read_b128 v[104:107], v24 offset:49152
  ds_read_b64_tr_b16 v[108:109], v28 offset:4096
  ds_read_b64_tr_b16 v[110:111], v28 offset:6144
  s_add_u32 m0, s52, 0x4000
  s_add_u32 s33, s101, 0x680c00
  buffer_load_dwordx4 v228, s[4:7], s33 offen offset:0 sc1 lds
  s_waitcnt lgkmcnt(9)
  v_mfma_f32_32x32x16_bf16 v[64:79], v[84:87], v[80:83], v[64:79]
  ds_read_b128 v[112:115], v24 offset:49664
  ds_read_b64_tr_b16 v[116:117], v28 offset:5120
  ds_read_b64_tr_b16 v[118:119], v28 offset:7168
  buffer_load_dwordx4 v228, s[4:7], s33 offen offset:1024 sc1 lds
  s_waitcnt lgkmcnt(9)
  v_mfma_f32_32x32x16_bf16 v[64:79], v[92:95], v[88:91], v[64:79]
  ds_read_b128 v[80:83], v24 offset:50176
  ds_read_b64_tr_b16 v[84:85], v28 offset:8192
  ds_read_b64_tr_b16 v[86:87], v28 offset:10240
  buffer_load_dwordx4 v228, s[4:7], s33 offen offset:2048 sc1 lds
  s_waitcnt lgkmcnt(9)
  v_mfma_f32_32x32x16_bf16 v[64:79], v[100:103], v[96:99], v[64:79]
  ds_read_b128 v[88:91], v24 offset:50688
  ds_read_b64_tr_b16 v[92:93], v28 offset:9216
  ds_read_b64_tr_b16 v[94:95], v28 offset:11264
  buffer_load_dwordx4 v228, s[4:7], s33 offen offset:3072 sc1 lds
  s_waitcnt lgkmcnt(9)
  v_mfma_f32_32x32x16_bf16 v[64:79], v[108:111], v[104:107], v[64:79]
  ds_read_b128 v[96:99], v24 offset:51200
  ds_read_b64_tr_b16 v[100:101], v28 offset:12288
  ds_read_b64_tr_b16 v[102:103], v28 offset:14336
  s_waitcnt lgkmcnt(9)
  v_mfma_f32_32x32x16_bf16 v[64:79], v[116:119], v[112:115], v[64:79]
  ds_read_b128 v[104:107], v24 offset:51712
  ds_read_b64_tr_b16 v[108:109], v28 offset:13312
  ds_read_b64_tr_b16 v[110:111], v28 offset:15360
  s_waitcnt lgkmcnt(9)
  v_mfma_f32_32x32x16_bf16 v[64:79], v[84:87], v[80:83], v[64:79]
  ds_read_b128 v[112:115], v24 offset:52224
  ds_read_b64_tr_b16 v[116:117], v28 offset:16384
  ds_read_b64_tr_b16 v[118:119], v28 offset:18432
  s_waitcnt lgkmcnt(9)
  v_mfma_f32_32x32x16_bf16 v[64:79], v[92:95], v[88:91], v[64:79]
  ds_read_b128 v[80:83], v24 offset:52736
  ds_read_b64_tr_b16 v[84:85], v28 offset:17408
  ds_read_b64_tr_b16 v[86:87], v28 offset:19456
  s_waitcnt lgkmcnt(9)
  v_mfma_f32_32x32x16_bf16 v[64:79], v[100:103], v[96:99], v[64:79]
  s_waitcnt vmcnt(4)
  s_barrier
  ds_read_b128 v[88:91], v24 offset:0
  ds_read_b64_tr_b16 v[92:93], v28 offset:20480
  ds_read_b64_tr_b16 v[94:95], v28 offset:22528
  s_waitcnt lgkmcnt(9)
  v_mfma_f32_32x32x16_bf16 v[64:79], v[108:111], v[104:107], v[64:79]
  ds_read_b128 v[96:99], v24 offset:512
  ds_read_b64_tr_b16 v[100:101], v28 offset:21504
  ds_read_b64_tr_b16 v[102:103], v28 offset:23552
  s_waitcnt lgkmcnt(9)
  v_mfma_f32_32x32x16_bf16 v[64:79], v[116:119], v[112:115], v[64:79]
  ds_read_b128 v[104:107], v24 offset:1024
  ds_read_b64_tr_b16 v[108:109], v28 offset:24576
  ds_read_b64_tr_b16 v[110:111], v28 offset:26624
  s_waitcnt lgkmcnt(9)
  v_mfma_f32_32x32x16_bf16 v[64:79], v[84:87], v[80:83], v[64:79]
  ds_read_b128 v[112:115], v24 offset:1536
  ds_read_b64_tr_b16 v[116:117], v28 offset:25600
  ds_read_b64_tr_b16 v[118:119], v28 offset:27648
  s_waitcnt lgkmcnt(9)
  v_mfma_f32_32x32x16_bf16 v[64:79], v[92:95], v[88:91], v[64:79]
  ds_read_b128 v[80:83], v24 offset:2048
  ds_read_b64_tr_b16 v[84:85], v28 offset:28672
  ds_read_b64_tr_b16 v[86:87], v28 offset:30720
  s_waitcnt lgkmcnt(9)
  v_mfma_f32_32x32x16_bf16 v[64:79], v[100:103], v[96:99], v[64:79]
  ds_read_b128 v[88:91], v24 offset:2560
  ds_read_b64_tr_b16 v[92:93], v28 offset:29696
  ds_read_b64_tr_b16 v[94:95], v28 offset:31744
  s_waitcnt lgkmcnt(9)
  v_mfma_f32_32x32x16_bf16 v[64:79], v[108:111], v[104:107], v[64:79]
  ds_read_b128 v[96:99], v24 offset:3072
  ds_read_b64_tr_b16 v[100:101], v28 offset:32768
  ds_read_b64_tr_b16 v[102:103], v28 offset:34816
  s_waitcnt lgkmcnt(9)
  v_mfma_f32_32x32x16_bf16 v[64:79], v[116:119], v[112:115], v[64:79]
  ds_read_b128 v[104:107], v24 offset:3584
  ds_read_b64_tr_b16 v[108:109], v28 offset:33792
  ds_read_b64_tr_b16 v[110:111], v28 offset:35840
  s_waitcnt lgkmcnt(9)
  v_mfma_f32_32x32x16_bf16 v[64:79], v[84:87], v[80:83], v[64:79]
  s_waitcnt vmcnt(0)
  s_barrier
  ds_read_b128 v[112:115], v24 offset:16384
  ds_read_b64_tr_b16 v[116:117], v28 offset:36864
  ds_read_b64_tr_b16 v[118:119], v28 offset:38912
  s_waitcnt lgkmcnt(9)
  v_mfma_f32_32x32x16_bf16 v[64:79], v[92:95], v[88:91], v[64:79]
  ds_read_b128 v[80:83], v24 offset:16896
  ds_read_b64_tr_b16 v[84:85], v28 offset:37888
  ds_read_b64_tr_b16 v[86:87], v28 offset:39936
  s_waitcnt lgkmcnt(9)
  v_mfma_f32_32x32x16_bf16 v[64:79], v[100:103], v[96:99], v[64:79]
  ds_read_b128 v[88:91], v24 offset:17408
  ds_read_b64_tr_b16 v[92:93], v28 offset:40960
  ds_read_b64_tr_b16 v[94:95], v28 offset:43008
  s_waitcnt lgkmcnt(9)
  v_mfma_f32_32x32x16_bf16 v[64:79], v[108:111], v[104:107], v[64:79]
  ds_read_b128 v[96:99], v24 offset:17920
  ds_read_b64_tr_b16 v[100:101], v28 offset:41984
  ds_read_b64_tr_b16 v[102:103], v28 offset:44032
  s_waitcnt lgkmcnt(9)
  v_mfma_f32_32x32x16_bf16 v[64:79], v[116:119], v[112:115], v[64:79]
  ds_read_b128 v[104:107], v24 offset:18432
  ds_read_b64_tr_b16 v[108:109], v28 offset:45056
  ds_read_b64_tr_b16 v[110:111], v28 offset:47104
  s_waitcnt lgkmcnt(9)
  v_mfma_f32_32x32x16_bf16 v[64:79], v[84:87], v[80:83], v[64:79]
  ds_read_b128 v[112:115], v24 offset:18944
  ds_read_b64_tr_b16 v[116:117], v28 offset:46080
  ds_read_b64_tr_b16 v[118:119], v28 offset:48128
  s_waitcnt lgkmcnt(9)
  v_mfma_f32_32x32x16_bf16 v[64:79], v[92:95], v[88:91], v[64:79]
  ds_read_b128 v[80:83], v24 offset:19456
  ds_read_b64_tr_b16 v[84:85], v28 offset:49152
  ds_read_b64_tr_b16 v[86:87], v28 offset:51200
  s_waitcnt lgkmcnt(9)
  v_mfma_f32_32x32x16_bf16 v[64:79], v[100:103], v[96:99], v[64:79]
  ds_read_b128 v[88:91], v24 offset:19968
  ds_read_b64_tr_b16 v[92:93], v28 offset:50176
  ds_read_b64_tr_b16 v[94:95], v28 offset:52224
  s_waitcnt lgkmcnt(9)
  v_mfma_f32_32x32x16_bf16 v[64:79], v[108:111], v[104:107], v[64:79]
  s_waitcnt lgkmcnt(6)
  v_mfma_f32_32x32x16_bf16 v[64:79], v[116:119], v[112:115], v[64:79]
  s_waitcnt lgkmcnt(3)
  v_mfma_f32_32x32x16_bf16 v[64:79], v[84:87], v[80:83], v[64:79]
  s_waitcnt lgkmcnt(0)
  v_mfma_f32_32x32x16_bf16 v[64:79], v[92:95], v[88:91], v[64:79]
  s_barrier
  s_nop 7
  s_nop 3
  v_pk_add_f32 v[32:33], v[32:33], v[64:65]
  v_pk_add_f32 v[34:35], v[34:35], v[66:67]
  v_pk_add_f32 v[36:37], v[36:37], v[68:69]
  v_pk_add_f32 v[38:39], v[38:39], v[70:71]
  v_pk_add_f32 v[40:41], v[40:41], v[72:73]
  v_pk_add_f32 v[42:43], v[42:43], v[74:75]
  v_pk_add_f32 v[44:45], v[44:45], v[76:77]
  v_pk_add_f32 v[46:47], v[46:47], v[78:79]
  v_cvt_pk_bf16_f32 v128, v32, v33
  v_cvt_pk_bf16_f32 v129, v34, v35
  v_cvt_pk_bf16_f32 v130, v40, v41
  v_cvt_pk_bf16_f32 v131, v42, v43
  v_cvt_pk_bf16_f32 v132, v36, v37
  v_cvt_pk_bf16_f32 v133, v38, v39
  v_cvt_pk_bf16_f32 v134, v44, v45
  v_cvt_pk_bf16_f32 v135, v46, v47
  s_cmp_eq_u32 s28, 1
  s_cbranch_scc1 FIN_46
  s_mov_b32 s33, 0x480000
  s_cmp_eq_u32 s27, 0
  s_cbranch_scc1 STF_47
  buffer_store_dwordx4 v[128:131], v13, s[4:7], s33 offen sc1
  buffer_store_dwordx4 v[132:135], v13, s[4:7], s33 offen offset:512 sc1
  s_branch STD_48
STF_47:
  buffer_store_dwordx4 v[128:131], v13, s[4:7], s33 offen
  buffer_store_dwordx4 v[132:135], v13, s[4:7], s33 offen offset:512
STD_48:
  s_mov_b32 s34, 0xd80000
  v_pk_add_f32 v[136:137], v[32:33], v[34:35]
  v_pk_mul_f32 v[138:139], v[32:33], v[32:33]
  v_pk_fma_f32 v[138:139], v[34:35], v[34:35], v[138:139]
  v_pk_add_f32 v[136:137], v[136:137], v[36:37]
  v_pk_fma_f32 v[138:139], v[36:37], v[36:37], v[138:139]
  v_pk_add_f32 v[136:137], v[136:137], v[38:39]
  v_pk_fma_f32 v[138:139], v[38:39], v[38:39], v[138:139]
  v_pk_add_f32 v[136:137], v[136:137], v[40:41]
  v_pk_fma_f32 v[138:139], v[40:41], v[40:41], v[138:139]
  v_pk_add_f32 v[136:137], v[136:137], v[42:43]
  v_pk_fma_f32 v[138:139], v[42:43], v[42:43], v[138:139]
  v_pk_add_f32 v[136:137], v[136:137], v[44:45]
  v_pk_fma_f32 v[138:139], v[44:45], v[44:45], v[138:139]
  v_pk_add_f32 v[136:137], v[136:137], v[46:47]
  v_pk_fma_f32 v[138:139], v[46:47], v[46:47], v[138:139]
  v_add_f32 v136, v136, v137
  v_add_f32 v137, v138, v139
  v_mov_b32 v140, v136
  v_mov_b32 v141, v137
  s_nop 1
  v_permlane32_swap_b32 v136, v140
  v_permlane32_swap_b32 v137, v141
  s_nop 0
  v_add_f32 v136, v136, v140
  v_add_f32 v137, v137, v141
  s_mov_b32 exec_lo, 0xffffffff
  s_mov_b32 exec_hi, 0x0
  s_cmp_eq_u32 s27, 0
  s_cbranch_scc1 STF_49
  buffer_store_dwordx2 v[136:137], v11, s[4:7], s34 offen sc1
  s_branch STD_50
STF_49:
  buffer_store_dwordx2 v[136:137], v11, s[4:7], s34 offen
STD_50:
  s_mov_b64 exec, -1
  s_add_u32 s30, s30, 6
  s_lshl_b32 s40, s30, 3
  s_add_u32 s40, s40, s31
  s_add_u32 s40, s40, s32
  v_mov_b32 v25, s40
  s_waitcnt vmcnt(0)
  s_mov_b64 exec, 1
  s_cmp_eq_u32 s27, 0
  s_cbranch_scc1 STF_51
  buffer_store_dword v25, v18, s[4:7], 0 offen sc1
  s_branch STD_52
STF_51:
  buffer_store_dword v25, v18, s[4:7], 0 offen
STD_52:
  s_mov_b64 exec, -1
  s_mov_b32 s28, 1
  s_mov_b32 s29, 0x88000
  s_mov_b32 s62, s27
  s_xor_b32 s90, s45, 0
  s_lshl_b32 s90, s90, 12
  s_add_u32 s90, s90, 0x480000
  s_add_u32 s94, s90, 0x4000
  s_xor_b32 s91, s45, 1
  s_lshl_b32 s91, s91, 12
  s_add_u32 s91, s91, 0x480000
  s_add_u32 s95, s91, 0x4000
  s_xor_b32 s92, s45, 2
  s_lshl_b32 s92, s92, 12
  s_add_u32 s92, s92, 0x480000
  s_add_u32 s96, s92, 0x4000
  s_xor_b32 s93, s45, 3
  s_lshl_b32 s93, s93, 12
  s_add_u32 s93, s93, 0x480000
  s_add_u32 s97, s93, 0x4000
  s_branch LAYER_LOOP
FIN_46:
  v_cvt_pk_bf16_f32 v128, v32, v33
  v_cvt_pk_bf16_f32 v129, v34, v35
  v_cvt_pk_bf16_f32 v130, v36, v37
  v_cvt_pk_bf16_f32 v131, v38, v39
  v_cvt_pk_bf16_f32 v132, v40, v41
  v_cvt_pk_bf16_f32 v133, v42, v43
  v_cvt_pk_bf16_f32 v134, v44, v45
  v_cvt_pk_bf16_f32 v135, v46, v47
  buffer_store_dwordx2 v[128:129], v12, s[12:15], 0 offen offset:0
  buffer_store_dwordx2 v[130:131], v12, s[12:15], 0 offen offset:16
  buffer_store_dwordx2 v[132:133], v12, s[12:15], 0 offen offset:32
  buffer_store_dwordx2 v[134:135], v12, s[12:15], 0 offen offset:48
L_END_COMPUTE:
  s_or_b32 s33, s2, s22
  s_cmp_eq_u32 s33, 0
  s_cbranch_scc0 NON_53
  s_add_u32 s33, s3, 1
  v_mov_b32 v25, s33
  v_mov_b32 v26, 0xf07800
  s_mov_b64 exec, 1
  buffer_store_dword v25, v26, s[4:7], 0 offen
  s_mov_b64 exec, -1
NON_53:
  s_waitcnt vmcnt(0)
  s_endpgm
L_LOADER:
  s_mov_b32 s40, s66
  s_mov_b32 s41, s67
  s_mov_b32 s42, 0x180000
  s_mov_b32 s43, 0x20000
  s_mov_b32 s44, s68
  s_mov_b32 s45, s69
  s_mov_b32 s46, 0x80000
  s_mov_b32 s47, 0x20000
  s_mov_b32 s48, s72
  s_mov_b32 s49, s73
  s_mov_b32 s50, 0x80000
  s_mov_b32 s51, 0x20000
  s_mov_b32 s52, s74
  s_mov_b32 s53, s75
  s_mov_b32 s54, 0x80000
  s_mov_b32 s55, 0x20000
  s_mov_b32 s56, s76
  s_mov_b32 s57, s77
  s_mov_b32 s58, 0x1c0000
  s_mov_b32 s59, 0x20000
  s_mov_b32 s60, s78
  s_mov_b32 s61, s79
  s_mov_b32 s62, 0x1c0000
  s_mov_b32 s63, 0x20000
  s_lshl_b32 s34, s25, 1
  s_add_u32 s34, s34, s26
  s_and_b32 s34, s34, 3
  s_xor_b32 s68, s34, 0
  s_mul_i32 s68, s68, 393216
  s_xor_b32 s69, s34, 1
  s_mul_i32 s69, s69, 393216
  s_xor_b32 s70, s34, 2
  s_mul_i32 s70, s70, 393216
  s_xor_b32 s71, s34, 3
  s_mul_i32 s71, s71, 393216
  s_min_u32 s92, s2, 239
  s_lshr_b32 s93, s92, 2
  s_and_b32 s94, s92, 3
  s_cmp_lt_u32 s93, 24
  s_cbranch_scc0 CS_54
  s_mov_b32 s88, s40
  s_mov_b32 s89, s41
  s_mov_b32 s90, s42
  s_mov_b32 s33, 3072
  s_lshl_b32 s34, s93, 7
  s_branch CS_56
CS_54:
  s_cmp_lt_u32 s93, 32
  s_cbranch_scc0 CS_55
  s_mov_b32 s88, s48
  s_mov_b32 s89, s49
  s_mov_b32 s90, s50
  s_mov_b32 s33, 1024
  s_sub_u32 s34, s93, 24
  s_lshl_b32 s34, s34, 7
  s_branch CS_56
CS_55:
  s_mov_b32 s88, s56
  s_mov_b32 s89, s57
  s_mov_b32 s90, s58
  s_mov_b32 s33, 3584
  s_sub_u32 s34, s93, 32
  s_lshl_b32 s34, s34, 7
CS_56:
  s_mov_b32 s91, 0x20000
  v_lshrrev_b32 v2, 3, v0
  v_mul_lo_u32 v2, v2, s33
  v_and_b32 v3, 7, v0
  v_lshl_add_u32 v2, v3, 4, v2
  v_add_u32 v2, s34, v2
  s_lshl_b32 s34, s94, 7
  s_mul_i32 s34, s34, s33
  s_lshl_b32 s33, s33, 3
  s_mov_b32 m0, 0x17000
  s_nop 0
  buffer_load_dwordx4 v2, s[88:91], s34 offen lds
  s_add_u32 m0, m0, 1024
  s_add_u32 s34, s34, s33
  s_nop 0
  buffer_load_dwordx4 v2, s[88:91], s34 offen lds
  s_add_u32 m0, m0, 1024
  s_add_u32 s34, s34, s33
  s_nop 0
  buffer_load_dwordx4 v2, s[88:91], s34 offen lds
  s_add_u32 m0, m0, 1024
  s_add_u32 s34, s34, s33
  s_nop 0
  buffer_load_dwordx4 v2, s[88:91], s34 offen lds
  s_add_u32 m0, m0, 1024
  s_add_u32 s34, s34, s33
  s_nop 0
  buffer_load_dwordx4 v2, s[88:91], s34 offen lds
  s_add_u32 m0, m0, 1024
  s_add_u32 s34, s34, s33
  s_nop 0
  buffer_load_dwordx4 v2, s[88:91], s34 offen lds
  s_add_u32 m0, m0, 1024
  s_add_u32 s34, s34, s33
  s_nop 0
  buffer_load_dwordx4 v2, s[88:91], s34 offen lds
  s_add_u32 m0, m0, 1024
  s_add_u32 s34, s34, s33
  s_nop 0
  buffer_load_dwordx4 v2, s[88:91], s34 offen lds
  s_add_u32 m0, m0, 1024
  s_add_u32 s34, s34, s33
  s_nop 0
  buffer_load_dwordx4 v2, s[88:91], s34 offen lds
  s_add_u32 m0, m0, 1024
  s_add_u32 s34, s34, s33
  s_nop 0
  buffer_load_dwordx4 v2, s[88:91], s34 offen lds
  s_add_u32 m0, m0, 1024
  s_add_u32 s34, s34, s33
  s_nop 0
  buffer_load_dwordx4 v2, s[88:91], s34 offen lds
  s_add_u32 m0, m0, 1024
  s_add_u32 s34, s34, s33
  s_nop 0
  buffer_load_dwordx4 v2, s[88:91], s34 offen lds
  s_add_u32 m0, m0, 1024
  s_add_u32 s34, s34, s33
  s_nop 0
  buffer_load_dwordx4 v2, s[88:91], s34 offen lds
  s_add_u32 m0, m0, 1024
  s_add_u32 s34, s34, s33
  s_nop 0
  buffer_load_dwordx4 v2, s[88:91], s34 offen lds
  s_add_u32 m0, m0, 1024
  s_add_u32 s34, s34, s33
  s_nop 0
  buffer_load_dwordx4 v2, s[88:91], s34 offen lds
  s_add_u32 m0, m0, 1024
  s_add_u32 s34, s34, s33
  s_nop 0
  buffer_load_dwordx4 v2, s[88:91], s34 offen lds
  v_lshrrev_b32 v1, 3, v0
  v_bfe_u32 v2, v1, 1, 2
  v_lshlrev_b32 v2, 1, v2
  v_and_b32 v3, 7, v0
  v_xor_b32 v3, v3, v2
  v_and_b32 v2, 3, v3
  v_lshlrev_b32 v4, 4, v2
  v_lshrrev_b32 v2, 2, v3
  v_lshl_add_u32 v4, v2, 10, v4
  s_lshl_b32 s33, s26, 6
  s_add_u32 s34, s33, 1024
  v_add_u32 v4, s34, v4
  v_lshrrev_b32 v2, 2, v1
  v_lshlrev_b32 v2, 3, v2
  v_and_b32 v3, 3, v1
  v_add_u32 v2, v2, v3
  v_mul_u32_u24 v2, 3072, v2
  v_add_u32 v2, v2, v4
  v_add_u32 v28, 0x0, v2
  v_add_u32 v29, 0xbc00, v2
  v_add_u32 v30, 0x2800, v2
  v_add_u32 v31, 0xe400, v2
  v_mul_u32_u24 v12, 3072, v1
  v_add_u32 v12, v12, v4
  v_add_u32 v13, 0x5c00, v12
  v_add_u32 v14, 0xb800, v12
  v_add_u32 v15, 0x11400, v12
  s_mov_b32 m0, 0x1d000
  s_add_u32 s33, s68, 0x0
  buffer_load_dwordx4 v28, s[40:43], s33 offen offset:0 lds
  buffer_load_dwordx4 v29, s[40:43], s33 offen offset:1024 lds
  buffer_load_dwordx4 v30, s[40:43], s33 offen offset:2048 lds
  buffer_load_dwordx4 v31, s[40:43], s33 offen offset:3072 lds
  s_mov_b32 m0, 0x1e000
  s_add_u32 s33, s68, 0x18000
  buffer_load_dwordx4 v28, s[40:43], s33 offen offset:0 lds
  buffer_load_dwordx4 v29, s[40:43], s33 offen offset:1024 lds
  buffer_load_dwordx4 v30, s[40:43], s33 offen offset:2048 lds
  buffer_load_dwordx4 v31, s[40:43], s33 offen offset:3072 lds
  s_mov_b32 m0, 0x1f000
  s_add_u32 s33, s68, 0x30000
  buffer_load_dwordx4 v28, s[40:43], s33 offen offset:0 lds
  buffer_load_dwordx4 v29, s[40:43], s33 offen offset:1024 lds
  buffer_load_dwordx4 v30, s[40:43], s33 offen offset:2048 lds
  buffer_load_dwordx4 v31, s[40:43], s33 offen offset:3072 lds
  s_mov_b32 m0, 0x20000
  s_add_u32 s33, s68, 0x48000
  buffer_load_dwordx4 v28, s[40:43], s33 offen offset:0 lds
  buffer_load_dwordx4 v29, s[40:43], s33 offen offset:1024 lds
  buffer_load_dwordx4 v30, s[40:43], s33 offen offset:2048 lds
  buffer_load_dwordx4 v31, s[40:43], s33 offen offset:3072 lds
  s_mov_b32 m0, 0x21000
  s_add_u32 s33, s69, 0x0
  buffer_load_dwordx4 v28, s[40:43], s33 offen offset:0 lds
  buffer_load_dwordx4 v29, s[40:43], s33 offen offset:1024 lds
  buffer_load_dwordx4 v30, s[40:43], s33 offen offset:2048 lds
  buffer_load_dwordx4 v31, s[40:43], s33 offen offset:3072 lds
  s_mov_b32 m0, 0x22000
  s_add_u32 s33, s69, 0x18000
  buffer_load_dwordx4 v28, s[40:43], s33 offen offset:0 lds
  buffer_load_dwordx4 v29, s[40:43], s33 offen offset:1024 lds
  buffer_load_dwordx4 v30, s[40:43], s33 offen offset:2048 lds
  buffer_load_dwordx4 v31, s[40:43], s33 offen offset:3072 lds
  s_mov_b32 m0, 0x23000
  s_add_u32 s33, s69, 0x30000
  buffer_load_dwordx4 v28, s[40:43], s33 offen offset:0 lds
  buffer_load_dwordx4 v29, s[40:43], s33 offen offset:1024 lds
  buffer_load_dwordx4 v30, s[40:43], s33 offen offset:2048 lds
  buffer_load_dwordx4 v31, s[40:43], s33 offen offset:3072 lds
  s_mov_b32 m0, 0x24000
  s_add_u32 s33, s69, 0x48000
  buffer_load_dwordx4 v28, s[40:43], s33 offen offset:0 lds
  buffer_load_dwordx4 v29, s[40:43], s33 offen offset:1024 lds
  buffer_load_dwordx4 v30, s[40:43], s33 offen offset:2048 lds
  buffer_load_dwordx4 v31, s[40:43], s33 offen offset:3072 lds
  s_waitcnt vmcnt(32)
  v_bfe_u32 v1, v0, 2, 2
  v_lshrrev_b32 v2, 4, v0
  v_lshl_add_u32 v1, v2, 2, v1
  v_lshlrev_b32 v1, 7, v1
  v_and_b32 v3, 3, v0
  v_lshl_add_u32 v1, v3, 3, v1
  v_add_u32 v1, 0x17000, v1
  v_mov_b32 v40, 0x3f803f80
  v_mov_b32 v41, 0x3f803f80
  v_mov_b32 v42, 0x3f803f80
  v_mov_b32 v43, 0x3f803f80
  ds_read_b64_tr_b16 v[64:65], v1 offset:0
  ds_read_b64_tr_b16 v[66:67], v1 offset:2048
  ds_read_b64_tr_b16 v[68:69], v1 offset:32
  ds_read_b64_tr_b16 v[70:71], v1 offset:2080
  ds_read_b64_tr_b16 v[72:73], v1 offset:64
  ds_read_b64_tr_b16 v[74:75], v1 offset:2112
  ds_read_b64_tr_b16 v[76:77], v1 offset:96
  ds_read_b64_tr_b16 v[78:79], v1 offset:2144
  s_waitcnt lgkmcnt(0)
  v_mfma_f32_16x16x32_bf16 v[44:47], v[64:67], v[40:43], 0
  v_mfma_f32_16x16x32_bf16 v[48:51], v[68:71], v[40:43], 0
  v_mfma_f32_16x16x32_bf16 v[52:55], v[72:75], v[40:43], 0
  v_mfma_f32_16x16x32_bf16 v[56:59], v[76:79], v[40:43], 0
  ds_read_b64_tr_b16 v[64:65], v1 offset:4096
  ds_read_b64_tr_b16 v[66:67], v1 offset:6144
  ds_read_b64_tr_b16 v[68:69], v1 offset:4128
  ds_read_b64_tr_b16 v[70:71], v1 offset:6176
  ds_read_b64_tr_b16 v[72:73], v1 offset:4160
  ds_read_b64_tr_b16 v[74:75], v1 offset:6208
  ds_read_b64_tr_b16 v[76:77], v1 offset:4192
  ds_read_b64_tr_b16 v[78:79], v1 offset:6240
  s_waitcnt lgkmcnt(0)
  v_mfma_f32_16x16x32_bf16 v[44:47], v[64:67], v[40:43], v[44:47]
  v_mfma_f32_16x16x32_bf16 v[48:51], v[68:71], v[40:43], v[48:51]
  v_mfma_f32_16x16x32_bf16 v[52:55], v[72:75], v[40:43], v[52:55]
  v_mfma_f32_16x16x32_bf16 v[56:59], v[76:79], v[40:43], v[56:59]
  ds_read_b64_tr_b16 v[64:65], v1 offset:8192
  ds_read_b64_tr_b16 v[66:67], v1 offset:10240
  ds_read_b64_tr_b16 v[68:69], v1 offset:8224
  ds_read_b64_tr_b16 v[70:71], v1 offset:10272
  ds_read_b64_tr_b16 v[72:73], v1 offset:8256
  ds_read_b64_tr_b16 v[74:75], v1 offset:10304
  ds_read_b64_tr_b16 v[76:77], v1 offset:8288
  ds_read_b64_tr_b16 v[78:79], v1 offset:10336
  s_waitcnt lgkmcnt(0)
  v_mfma_f32_16x16x32_bf16 v[44:47], v[64:67], v[40:43], v[44:47]
  v_mfma_f32_16x16x32_bf16 v[48:51], v[68:71], v[40:43], v[48:51]
  v_mfma_f32_16x16x32_bf16 v[52:55], v[72:75], v[40:43], v[52:55]
  v_mfma_f32_16x16x32_bf16 v[56:59], v[76:79], v[40:43], v[56:59]
  ds_read_b64_tr_b16 v[64:65], v1 offset:12288
  ds_read_b64_tr_b16 v[66:67], v1 offset:14336
  ds_read_b64_tr_b16 v[68:69], v1 offset:12320
  ds_read_b64_tr_b16 v[70:71], v1 offset:14368
  ds_read_b64_tr_b16 v[72:73], v1 offset:12352
  ds_read_b64_tr_b16 v[74:75], v1 offset:14400
  ds_read_b64_tr_b16 v[76:77], v1 offset:12384
  ds_read_b64_tr_b16 v[78:79], v1 offset:14432
  s_waitcnt lgkmcnt(0)
  v_mfma_f32_16x16x32_bf16 v[44:47], v[64:67], v[40:43], v[44:47]
  v_mfma_f32_16x16x32_bf16 v[48:51], v[68:71], v[40:43], v[48:51]
  v_mfma_f32_16x16x32_bf16 v[52:55], v[72:75], v[40:43], v[52:55]
  v_mfma_f32_16x16x32_bf16 v[56:59], v[76:79], v[40:43], v[56:59]
  s_mul_i32 s33, s94, 15360
  s_lshl_b32 s34, s93, 8
  s_add_u32 s33, s33, s34
  s_add_u32 s33, s33, 0xf18000
  v_lshlrev_b32 v2, 4, v2
  s_nop 7
  s_mov_b32 exec_lo, 0x10001
  s_mov_b32 exec_hi, 0x10001
  buffer_store_dwordx4 v[44:47], v2, s[4:7], s33 offen offset:0 sc1
  buffer_store_dwordx4 v[48:51], v2, s[4:7], s33 offen offset:64 sc1
  buffer_store_dwordx4 v[52:55], v2, s[4:7], s33 offen offset:128 sc1
  buffer_store_dwordx4 v[56:59], v2, s[4:7], s33 offen offset:192 sc1
  s_mov_b64 exec, -1
  s_lshr_b32 s33, s2, 3
  s_mul_i32 s33, s33, 2176
  s_add_u32 s33, s33, 0xed0000
  s_and_b32 s34, s2, 0x87
  s_cmp_eq_u32 s34, 0
  s_cselect_b32 s34, 0, 0x80000000
  v_mov_b32 v60, 0
  v_mov_b32 v61, 0
  v_mov_b32 v62, 0
  v_mov_b32 v63, 0
  v_lshlrev_b32 v1, 4, v0
  v_or_b32 v1, s34, v1
  buffer_store_dwordx4 v[60:63], v1, s[4:7], s33 offen sc1
  buffer_store_dwordx4 v[60:63], v1, s[4:7], s33 offen offset:1024 sc1
  s_mov_b64 exec, 0xff
  buffer_store_dwordx4 v[60:63], v1, s[4:7], s33 offen offset:2048 sc1
  s_mov_b64 exec, -1
  s_add_u32 s33, s33, 34816
  buffer_store_dwordx4 v[60:63], v1, s[4:7], s33 offen sc1
  buffer_store_dwordx4 v[60:63], v1, s[4:7], s33 offen offset:1024 sc1
  s_mov_b64 exec, 0xff
  buffer_store_dwordx4 v[60:63], v1, s[4:7], s33 offen offset:2048 sc1
  s_mov_b64 exec, -1
  s_waitcnt vmcnt(26)
  s_barrier
  s_mov_b32 m0, 0x25000
  s_add_u32 s33, s70, 0x0
  buffer_load_dwordx4 v28, s[40:43], s33 offen offset:0 lds
  buffer_load_dwordx4 v29, s[40:43], s33 offen offset:1024 lds
  buffer_load_dwordx4 v30, s[40:43], s33 offen offset:2048 lds
  buffer_load_dwordx4 v31, s[40:43], s33 offen offset:3072 lds
  s_mov_b32 m0, 0x10000
  s_add_u32 s33, s70, 0x18000
  buffer_load_dwordx4 v28, s[40:43], s33 offen offset:0 lds
  buffer_load_dwordx4 v29, s[40:43], s33 offen offset:1024 lds
  buffer_load_dwordx4 v30, s[40:43], s33 offen offset:2048 lds
  buffer_load_dwordx4 v31, s[40:43], s33 offen offset:3072 lds
  s_mov_b32 m0, 0x11000
  s_add_u32 s33, s70, 0x30000
  buffer_load_dwordx4 v28, s[40:43], s33 offen offset:0 lds
  buffer_load_dwordx4 v29, s[40:43], s33 offen offset:1024 lds
  buffer_load_dwordx4 v30, s[40:43], s33 offen offset:2048 lds
  buffer_load_dwordx4 v31, s[40:43], s33 offen offset:3072 lds
  s_mov_b32 m0, 0x12000
  s_add_u32 s33, s70, 0x48000
  buffer_load_dwordx4 v28, s[40:43], s33 offen offset:0 lds
  buffer_load_dwordx4 v29, s[40:43], s33 offen offset:1024 lds
  buffer_load_dwordx4 v30, s[40:43], s33 offen offset:2048 lds
  buffer_load_dwordx4 v31, s[40:43], s33 offen offset:3072 lds
  s_mov_b32 m0, 0x13000
  s_add_u32 s33, s71, 0x0
  buffer_load_dwordx4 v28, s[40:43], s33 offen offset:0 lds
  buffer_load_dwordx4 v29, s[40:43], s33 offen offset:1024 lds
  buffer_load_dwordx4 v30, s[40:43], s33 offen offset:2048 lds
  buffer_load_dwordx4 v31, s[40:43], s33 offen offset:3072 lds
  s_mov_b32 m0, 0x14000
  s_add_u32 s33, s71, 0x18000
  buffer_load_dwordx4 v28, s[40:43], s33 offen offset:0 lds
  buffer_load_dwordx4 v29, s[40:43], s33 offen offset:1024 lds
  buffer_load_dwordx4 v30, s[40:43], s33 offen offset:2048 lds
  buffer_load_dwordx4 v31, s[40:43], s33 offen offset:3072 lds
  s_mov_b32 m0, 0x15000
  s_add_u32 s33, s71, 0x30000
  buffer_load_dwordx4 v28, s[40:43], s33 offen offset:0 lds
  buffer_load_dwordx4 v29, s[40:43], s33 offen offset:1024 lds
  buffer_load_dwordx4 v30, s[40:43], s33 offen offset:2048 lds
  buffer_load_dwordx4 v31, s[40:43], s33 offen offset:3072 lds
  s_mov_b32 m0, 0x16000
  s_add_u32 s33, s71, 0x48000
  buffer_load_dwordx4 v28, s[40:43], s33 offen offset:0 lds
  buffer_load_dwordx4 v29, s[40:43], s33 offen offset:1024 lds
  buffer_load_dwordx4 v30, s[40:43], s33 offen offset:2048 lds
  buffer_load_dwordx4 v31, s[40:43], s33 offen offset:3072 lds
  s_waitcnt lgkmcnt(0)
  s_mul_i32 s31, s3, 0x9e3779b1
  s_add_u32 s31, s31, 0x7f4a7c15
  s_and_b32 s31, s31, 0xffffff00
  s_lshl_b32 s33, s20, 7
  s_lshl_b32 s34, s21, 2
  s_add_u32 s33, s33, s34
  s_add_u32 s33, s33, 0xf07400
  v_mov_b32 v2, s33
  s_add_u32 s34, s31, s32
  v_mov_b32 v1, s34
  s_mov_b64 exec, 1
  buffer_store_dword v1, v2, s[4:7], 0 offen sc1
  s_mov_b64 exec, -1
  s_and_b32 s64, s23, 3
  s_xor_b32 s64, s64, 0
  s_lshl_b32 s64, s64, 17
  s_lshl_b32 s72, s25, 1
  s_and_b32 s72, s72, 3
  s_xor_b32 s72, s72, 0
  s_mul_i32 s72, s72, 458752
  s_and_b32 s65, s23, 3
  s_xor_b32 s65, s65, 1
  s_lshl_b32 s65, s65, 17
  s_lshl_b32 s73, s25, 1
  s_and_b32 s73, s73, 3
  s_xor_b32 s73, s73, 1
  s_mul_i32 s73, s73, 458752
  s_and_b32 s66, s23, 3
  s_xor_b32 s66, s66, 2
  s_lshl_b32 s66, s66, 17
  s_lshl_b32 s74, s25, 1
  s_and_b32 s74, s74, 3
  s_xor_b32 s74, s74, 2
  s_mul_i32 s74, s74, 458752
  s_and_b32 s67, s23, 3
  s_xor_b32 s67, s67, 3
  s_lshl_b32 s67, s67, 17
  s_lshl_b32 s75, s25, 1
  s_and_b32 s75, s75, 3
  s_xor_b32 s75, s75, 3
  s_mul_i32 s75, s75, 458752
  s_and_b32 s76, s23, 3
  s_lshl_b32 s76, s76, 1
  s_xor_b32 s76, s76, 0
  s_mul_i32 s76, s76, 229376
  s_and_b32 s77, s23, 3
  s_lshl_b32 s77, s77, 1
  s_xor_b32 s77, s77, 1
  s_mul_i32 s77, s77, 229376
  s_and_b32 s78, s23, 3
  s_lshl_b32 s78, s78, 1
  s_xor_b32 s78, s78, 2
  s_mul_i32 s78, s78, 229376
  s_and_b32 s79, s23, 3
  s_lshl_b32 s79, s79, 1
  s_xor_b32 s79, s79, 3
  s_mul_i32 s79, s79, 229376
  s_and_b32 s80, s23, 3
  s_lshl_b32 s80, s80, 1
  s_xor_b32 s80, s80, 4
  s_mul_i32 s80, s80, 229376
  s_and_b32 s81, s23, 3
  s_lshl_b32 s81, s81, 1
  s_xor_b32 s81, s81, 5
  s_mul_i32 s81, s81, 229376
  s_and_b32 s82, s23, 3
  s_lshl_b32 s82, s82, 1
  s_xor_b32 s82, s82, 6
  s_mul_i32 s82, s82, 229376
  s_and_b32 s83, s23, 3
  s_lshl_b32 s83, s83, 1
  s_xor_b32 s83, s83, 7
  s_mul_i32 s83, s83, 229376
  v_lshrrev_b32 v1, 3, v0
  v_bfe_u32 v2, v1, 1, 1
  v_lshlrev_b32 v2, 2, v2
  v_and_b32 v3, 7, v0
  v_xor_b32 v3, v3, v2
  v_lshlrev_b32 v8, 10, v1
  v_lshl_add_u32 v8, v3, 4, v8
  s_lshl_b32 s33, s24, 7
  v_add_u32 v8, s33, v8
  v_add_u32 v9, 0x1c00, v8
  v_add_u32 v10, 0x3800, v8
  v_add_u32 v11, 0x5400, v8
  v_lshrrev_b32 v1, 2, v0
  v_bfe_u32 v2, v1, 2, 1
  v_lshlrev_b32 v2, 1, v2
  v_and_b32 v3, 3, v0
  v_xor_b32 v3, v3, v2
  v_lshlrev_b32 v4, 4, v3
  s_lshl_b32 s33, s26, 6
  v_add_u32 v4, s33, v4
  v_mul_u32_u24 v16, 3072, v1
  v_add_u32 v16, v16, v4
  v_add_u32 v17, 0xbc00, v16
  v_add_u32 v18, 0x17800, v16
  v_add_u32 v19, 0x23400, v16
  v_lshrrev_b32 v2, 2, v1
  v_lshlrev_b32 v2, 3, v2
  v_and_b32 v3, 3, v1
  v_add_u32 v2, v2, v3
  v_mul_u32_u24 v2, 3072, v2
  v_add_u32 v2, v2, v4
  v_add_u32 v32, 0x0, v2
  v_add_u32 v33, 0x2c00, v2
  v_add_u32 v34, 0x17800, v2
  v_add_u32 v35, 0x1a400, v2
  s_mul_i32 s33, s26, 224
  s_mov_b32 s34, 0x12493
  v_add_u32 v1, 0, v0
  v_mul_lo_u32 v2, v1, s34
  v_lshrrev_b32 v2, 20, v2
  v_mul_u32_u24 v3, 14, v2
  v_sub_u32 v3, v1, v3
  v_mul_u32_u24 v20, 3584, v2
  v_lshl_add_u32 v20, v3, 4, v20
  v_add_u32 v20, s33, v20
  v_add_u32 v1, 64, v0
  v_mul_lo_u32 v2, v1, s34
  v_lshrrev_b32 v2, 20, v2
  v_mul_u32_u24 v3, 14, v2
  v_sub_u32 v3, v1, v3
  v_mul_u32_u24 v21, 3584, v2
  v_lshl_add_u32 v21, v3, 4, v21
  v_add_u32 v21, s33, v21
  v_subrev_u32 v21, 1024, v21
  v_add_u32 v1, 128, v0
  v_mul_lo_u32 v2, v1, s34
  v_lshrrev_b32 v2, 20, v2
  v_mul_u32_u24 v3, 14, v2
  v_sub_u32 v3, v1, v3
  v_mul_u32_u24 v22, 3584, v2
  v_lshl_add_u32 v22, v3, 4, v22
  v_add_u32 v22, s33, v22
  v_subrev_u32 v22, 2048, v22
  v_add_u32 v1, 192, v0
  v_mul_lo_u32 v2, v1, s34
  v_lshrrev_b32 v2, 20, v2
  v_mul_u32_u24 v3, 14, v2
  v_sub_u32 v3, v1, v3
  v_mul_u32_u24 v23, 3584, v2
  v_lshl_add_u32 v23, v3, 4, v23
  v_add_u32 v23, s33, v23
  v_subrev_u32 v23, 3072, v23
  v_add_u32 v1, 256, v0
  v_mul_lo_u32 v2, v1, s34
  v_lshrrev_b32 v2, 20, v2
  v_mul_u32_u24 v3, 14, v2
  v_sub_u32 v3, v1, v3
  v_mul_u32_u24 v24, 3584, v2
  v_lshl_add_u32 v24, v3, 4, v24
  v_add_u32 v24, s33, v24
  v_add_u32 v1, 320, v0
  v_mul_lo_u32 v2, v1, s34
  v_lshrrev_b32 v2, 20, v2
  v_mul_u32_u24 v3, 14, v2
  v_sub_u32 v3, v1, v3
  v_mul_u32_u24 v25, 3584, v2
  v_lshl_add_u32 v25, v3, 4, v25
  v_add_u32 v25, s33, v25
  v_subrev_u32 v25, 1024, v25
  v_add_u32 v1, 384, v0
  v_mul_lo_u32 v2, v1, s34
  v_lshrrev_b32 v2, 20, v2
  v_mul_u32_u24 v3, 14, v2
  v_sub_u32 v3, v1, v3
  v_mul_u32_u24 v26, 3584, v2
  v_lshl_add_u32 v26, v3, 4, v26
  v_add_u32 v26, s33, v26
  v_subrev_u32 v26, 2048, v26
  s_lshl_b32 s33, s2, 7
  s_add_u32 s33, s33, 0xf28000
  v_mov_b32 v2, s33
  s_add_u32 s34, s31, 8
  v_mov_b32 v1, s34
  s_waitcnt vmcnt(33)
  s_mov_b64 exec, 1
  buffer_store_dword v1, v2, s[4:7], 0 offen sc1
  s_mov_b64 exec, -1
  s_barrier
  s_waitcnt vmcnt(18)
  s_barrier
  v_min_u32 v1, 27, v0
  v_lshrrev_b32 v3, 2, v1
  s_lshr_b32 s33, s26, 1
  v_lshlrev_b32 v2, 3, v3
  v_add_u32 v2, s33, v2
  s_add_u32 s33, s24, 24
  v_mov_b32 v4, s33
  v_cmp_eq_u32 vcc, 3, v3
  s_nop 1
  v_cndmask_b32 v2, v2, v4, vcc
  s_mul_i32 s33, s26, 112
  s_lshr_b32 s33, s33, 6
  s_add_u32 s33, s33, 28
  v_add_u32 v4, s33, v3
  v_min_u32 v4, 59, v4
  v_cmp_lt_u32 vcc, 3, v3
  s_nop 1
  v_cndmask_b32 v2, v2, v4, vcc
  v_and_b32 v1, 3, v1
  v_lshl_add_u32 v2, v2, 2, v1
  s_lshl_b32 s33, s26, 3
  v_mov_b32 v4, s33
  v_cmp_lt_u32 vcc, 27, v0
  s_nop 1
  v_cndmask_b32 v2, v2, v4, vcc
  v_lshlrev_b32 v2, 7, v2
  s_mov_b32 s33, 0xf28000
  s_add_u32 s34, s31, 8
  s_mov_b32 s95, 131072
CPOLL_58:
  buffer_load_dword v40, v2, s[4:7], s33 offen sc1
  s_waitcnt vmcnt(0)
  v_subrev_u32 v40, s34, v40
  v_cmp_gt_u32 vcc, 0x80, v40
  s_sub_u32 s95, s95, 1
  s_cbranch_scc1 CPOLLD_59
  s_cmp_eq_u64 vcc, -1
  s_cbranch_scc0 CPOLL_58
CPOLLD_59:
  v_add_u32 v1, 0, v0
  v_lshlrev_b32 v3, 2, v1
  s_lshl_b32 s33, s26, 5
  s_mul_i32 s34, s26, 112
  s_add_u32 s34, s34, 1888
  v_add_u32 v36, s34, v3
  s_lshl_b32 s34, s24, 6
  s_add_u32 s34, s34, 1440
  v_add_u32 v4, s34, v3
  v_cmp_gt_u32 vcc, 40, v1
  s_nop 1
  v_cndmask_b32 v36, v36, v4, vcc
  s_add_u32 s34, s33, 0xffffffc0
  v_add_u32 v4, s34, v3
  v_cmp_gt_u32 vcc, 24, v1
  s_nop 1
  v_cndmask_b32 v36, v36, v4, vcc
  s_add_u32 s34, s33, 0x3e0
  v_add_u32 v4, s34, v3
  v_cmp_gt_u32 vcc, 16, v1
  s_nop 1
  v_cndmask_b32 v36, v36, v4, vcc
  s_add_u32 s34, s33, 0x200
  v_add_u32 v4, s34, v3
  v_cmp_gt_u32 vcc, 8, v1
  s_nop 1
  v_cndmask_b32 v36, v36, v4, vcc
  v_lshlrev_b32 v36, 2, v36
  v_add_u32 v1, 64, v0
  v_lshlrev_b32 v3, 2, v1
  s_lshl_b32 s33, s26, 5
  s_mul_i32 s34, s26, 112
  s_add_u32 s34, s34, 1888
  v_add_u32 v37, s34, v3
  s_lshl_b32 s34, s24, 6
  s_add_u32 s34, s34, 1440
  v_add_u32 v4, s34, v3
  v_cmp_gt_u32 vcc, 40, v1
  s_nop 1
  v_cndmask_b32 v37, v37, v4, vcc
  s_add_u32 s34, s33, 0xffffffc0
  v_add_u32 v4, s34, v3
  v_cmp_gt_u32 vcc, 24, v1
  s_nop 1
  v_cndmask_b32 v37, v37, v4, vcc
  s_add_u32 s34, s33, 0x3e0
  v_add_u32 v4, s34, v3
  v_cmp_gt_u32 vcc, 16, v1
  s_nop 1
  v_cndmask_b32 v37, v37, v4, vcc
  s_add_u32 s34, s33, 0x200
  v_add_u32 v4, s34, v3
  v_cmp_gt_u32 vcc, 8, v1
  s_nop 1
  v_cndmask_b32 v37, v37, v4, vcc
  v_lshlrev_b32 v37, 2, v37
  s_mov_b32 s33, 0xf18000
  buffer_load_dwordx4 v[40:43], v36, s[4:7], s33 offen sc1
  s_mov_b64 exec, 0xf
  buffer_load_dwordx4 v[56:59], v37, s[4:7], s33 offen sc1
  s_mov_b64 exec, -1
  s_add_u32 s33, s33, 15360
  buffer_load_dwordx4 v[44:47], v36, s[4:7], s33 offen sc1
  s_mov_b64 exec, 0xf
  buffer_load_dwordx4 v[60:63], v37, s[4:7], s33 offen sc1
  s_mov_b64 exec, -1
  s_add_u32 s33, s33, 15360
  buffer_load_dwordx4 v[48:51], v36, s[4:7], s33 offen sc1
  s_mov_b64 exec, 0xf
  buffer_load_dwordx4 v[64:67], v37, s[4:7], s33 offen sc1
  s_mov_b64 exec, -1
  s_add_u32 s33, s33, 15360
  buffer_load_dwordx4 v[52:55], v36, s[4:7], s33 offen sc1
  s_mov_b64 exec, 0xf
  buffer_load_dwordx4 v[68:71], v37, s[4:7], s33 offen sc1
  s_mov_b64 exec, -1
  v_lshlrev_b32 v1, 4, v0
  v_add_u32 v1, 0x26f00, v1
  s_waitcnt vmcnt(0)
  v_pk_add_f32 v[40:41], v[40:41], v[44:45]
  v_pk_add_f32 v[48:49], v[48:49], v[52:53]
  v_pk_add_f32 v[40:41], v[40:41], v[48:49]
  v_pk_add_f32 v[42:43], v[42:43], v[46:47]
  v_pk_add_f32 v[50:51], v[50:51], v[54:55]
  v_pk_add_f32 v[42:43], v[42:43], v[50:51]
  v_pk_add_f32 v[56:57], v[56:57], v[60:61]
  v_pk_add_f32 v[64:65], v[64:65], v[68:69]
  v_pk_add_f32 v[56:57], v[56:57], v[64:65]
  v_pk_add_f32 v[58:59], v[58:59], v[62:63]
  v_pk_add_f32 v[66:67], v[66:67], v[70:71]
  v_pk_add_f32 v[58:59], v[58:59], v[66:67]
  ds_write_b128 v1, v[40:43]
  s_mov_b64 exec, 0xf
  ds_write_b128 v1, v[56:59] offset:1024
  s_mov_b64 exec, -1
  s_waitcnt lgkmcnt(0)
  s_barrier
  s_barrier
  s_mov_b32 m0, 0x17000
  s_add_u32 s33, s68, 0x0
  buffer_load_dwordx4 v32, s[40:43], s33 offen offset:0 lds
  buffer_load_dwordx4 v33, s[40:43], s33 offen offset:1024 lds
  buffer_load_dwordx4 v34, s[40:43], s33 offen offset:2048 lds
  buffer_load_dwordx4 v35, s[40:43], s33 offen offset:3072 lds
  s_mov_b32 m0, 0x18000
  s_add_u32 s33, s68, 0x30000
  buffer_load_dwordx4 v32, s[40:43], s33 offen offset:0 lds
  buffer_load_dwordx4 v33, s[40:43], s33 offen offset:1024 lds
  buffer_load_dwordx4 v34, s[40:43], s33 offen offset:2048 lds
  buffer_load_dwordx4 v35, s[40:43], s33 offen offset:3072 lds
  s_mov_b32 m0, 0x19000
  s_add_u32 s33, s69, 0x0
  buffer_load_dwordx4 v32, s[40:43], s33 offen offset:0 lds
  buffer_load_dwordx4 v33, s[40:43], s33 offen offset:1024 lds
  buffer_load_dwordx4 v34, s[40:43], s33 offen offset:2048 lds
  buffer_load_dwordx4 v35, s[40:43], s33 offen offset:3072 lds
  s_mov_b32 m0, 0x1a000
  s_add_u32 s33, s69, 0x30000
  buffer_load_dwordx4 v32, s[40:43], s33 offen offset:0 lds
  buffer_load_dwordx4 v33, s[40:43], s33 offen offset:1024 lds
  buffer_load_dwordx4 v34, s[40:43], s33 offen offset:2048 lds
  buffer_load_dwordx4 v35, s[40:43], s33 offen offset:3072 lds
  s_mov_b32 m0, 0x1b000
  s_add_u32 s33, s70, 0x0
  buffer_load_dwordx4 v32, s[40:43], s33 offen offset:0 lds
  buffer_load_dwordx4 v33, s[40:43], s33 offen offset:1024 lds
  buffer_load_dwordx4 v34, s[40:43], s33 offen offset:2048 lds
  buffer_load_dwordx4 v35, s[40:43], s33 offen offset:3072 lds
  s_mov_b32 m0, 0x1c000
  s_add_u32 s33, s70, 0x30000
  buffer_load_dwordx4 v32, s[40:43], s33 offen offset:0 lds
  buffer_load_dwordx4 v33, s[40:43], s33 offen offset:1024 lds
  buffer_load_dwordx4 v34, s[40:43], s33 offen offset:2048 lds
  buffer_load_dwordx4 v35, s[40:43], s33 offen offset:3072 lds
  s_mov_b32 m0, 0x1d000
  s_add_u32 s33, s71, 0x0
  buffer_load_dwordx4 v32, s[40:43], s33 offen offset:0 lds
  buffer_load_dwordx4 v33, s[40:43], s33 offen offset:1024 lds
  buffer_load_dwordx4 v34, s[40:43], s33 offen offset:2048 lds
  buffer_load_dwordx4 v35, s[40:43], s33 offen offset:3072 lds
  s_mov_b32 m0, 0x1e000
  s_add_u32 s33, s71, 0x30000
  buffer_load_dwordx4 v32, s[40:43], s33 offen offset:0 lds
  buffer_load_dwordx4 v33, s[40:43], s33 offen offset:1024 lds
  buffer_load_dwordx4 v34, s[40:43], s33 offen offset:2048 lds
  buffer_load_dwordx4 v35, s[40:43], s33 offen offset:3072 lds
  s_mov_b32 m0, 0x1f000
  s_add_u32 s33, s64, 0x0
  buffer_load_dwordx4 v8, s[44:47], s33 offen offset:0 lds
  buffer_load_dwordx4 v9, s[44:47], s33 offen offset:1024 lds
  buffer_load_dwordx4 v10, s[44:47], s33 offen offset:2048 lds
  buffer_load_dwordx4 v11, s[44:47], s33 offen offset:3072 lds
  s_mov_b32 m0, 0x20000
  s_add_u32 s33, s64, 0x8000
  buffer_load_dwordx4 v8, s[44:47], s33 offen offset:0 lds
  buffer_load_dwordx4 v9, s[44:47], s33 offen offset:1024 lds
  buffer_load_dwordx4 v10, s[44:47], s33 offen offset:2048 lds
  buffer_load_dwordx4 v11, s[44:47], s33 offen offset:3072 lds
  s_mov_b32 m0, 0x21000
  s_add_u32 s33, s64, 0x10000
  buffer_load_dwordx4 v8, s[44:47], s33 offen offset:0 lds
  buffer_load_dwordx4 v9, s[44:47], s33 offen offset:1024 lds
  buffer_load_dwordx4 v10, s[44:47], s33 offen offset:2048 lds
  buffer_load_dwordx4 v11, s[44:47], s33 offen offset:3072 lds
  s_waitcnt vmcnt(40)
  s_mov_b32 m0, 0x22000
  s_add_u32 s33, s64, 0x18000
  buffer_load_dwordx4 v8, s[44:47], s33 offen offset:0 lds
  buffer_load_dwordx4 v9, s[44:47], s33 offen offset:1024 lds
  buffer_load_dwordx4 v10, s[44:47], s33 offen offset:2048 lds
  buffer_load_dwordx4 v11, s[44:47], s33 offen offset:3072 lds
  s_waitcnt vmcnt(40)
  s_mov_b32 m0, 0x23000
  s_add_u32 s33, s65, 0x0
  buffer_load_dwordx4 v8, s[44:47], s33 offen offset:0 lds
  buffer_load_dwordx4 v9, s[44:47], s33 offen offset:1024 lds
  buffer_load_dwordx4 v10, s[44:47], s33 offen offset:2048 lds
  buffer_load_dwordx4 v11, s[44:47], s33 offen offset:3072 lds
  s_waitcnt vmcnt(40)
  s_mov_b32 m0, 0x24000
  s_add_u32 s33, s65, 0x8000
  buffer_load_dwordx4 v8, s[44:47], s33 offen offset:0 lds
  buffer_load_dwordx4 v9, s[44:47], s33 offen offset:1024 lds
  buffer_load_dwordx4 v10, s[44:47], s33 offen offset:2048 lds
  buffer_load_dwordx4 v11, s[44:47], s33 offen offset:3072 lds
  s_waitcnt vmcnt(40)
  s_mov_b32 m0, 0x25000
  s_add_u32 s33, s65, 0x10000
  buffer_load_dwordx4 v8, s[44:47], s33 offen offset:0 lds
  buffer_load_dwordx4 v9, s[44:47], s33 offen offset:1024 lds
  buffer_load_dwordx4 v10, s[44:47], s33 offen offset:2048 lds
  buffer_load_dwordx4 v11, s[44:47], s33 offen offset:3072 lds
  s_waitcnt vmcnt(40)
  s_mov_b32 m0, 0x10000
  s_add_u32 s33, s65, 0x18000
  buffer_load_dwordx4 v8, s[44:47], s33 offen offset:0 lds
  buffer_load_dwordx4 v9, s[44:47], s33 offen offset:1024 lds
  buffer_load_dwordx4 v10, s[44:47], s33 offen offset:2048 lds
  buffer_load_dwordx4 v11, s[44:47], s33 offen offset:3072 lds
  s_waitcnt vmcnt(40)
  s_barrier
  s_barrier
  s_mov_b32 m0, 0x11000
  s_add_u32 s33, s66, 0x0
  buffer_load_dwordx4 v8, s[44:47], s33 offen offset:0 lds
  buffer_load_dwordx4 v9, s[44:47], s33 offen offset:1024 lds
  buffer_load_dwordx4 v10, s[44:47], s33 offen offset:2048 lds
  buffer_load_dwordx4 v11, s[44:47], s33 offen offset:3072 lds
  s_waitcnt vmcnt(40)
  s_mov_b32 m0, 0x12000
  s_add_u32 s33, s66, 0x8000
  buffer_load_dwordx4 v8, s[44:47], s33 offen offset:0 lds
  buffer_load_dwordx4 v9, s[44:47], s33 offen offset:1024 lds
  buffer_load_dwordx4 v10, s[44:47], s33 offen offset:2048 lds
  buffer_load_dwordx4 v11, s[44:47], s33 offen offset:3072 lds
  s_waitcnt vmcnt(40)
  s_mov_b32 m0, 0x13000
  s_add_u32 s33, s66, 0x10000
  buffer_load_dwordx4 v8, s[44:47], s33 offen offset:0 lds
  buffer_load_dwordx4 v9, s[44:47], s33 offen offset:1024 lds
  buffer_load_dwordx4 v10, s[44:47], s33 offen offset:2048 lds
  buffer_load_dwordx4 v11, s[44:47], s33 offen offset:3072 lds
  s_waitcnt vmcnt(40)
  s_mov_b32 m0, 0x14000
  s_add_u32 s33, s66, 0x18000
  buffer_load_dwordx4 v8, s[44:47], s33 offen offset:0 lds
  buffer_load_dwordx4 v9, s[44:47], s33 offen offset:1024 lds
  buffer_load_dwordx4 v10, s[44:47], s33 offen offset:2048 lds
  buffer_load_dwordx4 v11, s[44:47], s33 offen offset:3072 lds
  s_waitcnt vmcnt(40)
  s_barrier
  s_mov_b32 m0, 0x15000
  s_add_u32 s33, s67, 0x0
  buffer_load_dwordx4 v8, s[44:47], s33 offen offset:0 lds
  buffer_load_dwordx4 v9, s[44:47], s33 offen offset:1024 lds
  buffer_load_dwordx4 v10, s[44:47], s33 offen offset:2048 lds
  buffer_load_dwordx4 v11, s[44:47], s33 offen offset:3072 lds
  s_waitcnt vmcnt(40)
  s_mov_b32 m0, 0x16000
  s_add_u32 s33, s67, 0x8000
  buffer_load_dwordx4 v8, s[44:47], s33 offen offset:0 lds
  buffer_load_dwordx4 v9, s[44:47], s33 offen offset:1024 lds
  buffer_load_dwordx4 v10, s[44:47], s33 offen offset:2048 lds
  buffer_load_dwordx4 v11, s[44:47], s33 offen offset:3072 lds
  s_waitcnt vmcnt(40)
  s_barrier
  s_mov_b32 m0, 0x17000
  s_add_u32 s33, s67, 0x10000
  buffer_load_dwordx4 v8, s[44:47], s33 offen offset:0 lds
  buffer_load_dwordx4 v9, s[44:47], s33 offen offset:1024 lds
  buffer_load_dwordx4 v10, s[44:47], s33 offen offset:2048 lds
  buffer_load_dwordx4 v11, s[44:47], s33 offen offset:3072 lds
  s_waitcnt vmcnt(40)
  s_mov_b32 m0, 0x18000
  s_add_u32 s33, s67, 0x18000
  buffer_load_dwordx4 v8, s[44:47], s33 offen offset:0 lds
  buffer_load_dwordx4 v9, s[44:47], s33 offen offset:1024 lds
  buffer_load_dwordx4 v10, s[44:47], s33 offen offset:2048 lds
  buffer_load_dwordx4 v11, s[44:47], s33 offen offset:3072 lds
  s_waitcnt vmcnt(40)
  s_mov_b32 m0, 0x19000
  s_add_u32 s33, s64, 0x0
  buffer_load_dwordx4 v8, s[48:51], s33 offen offset:0 lds
  buffer_load_dwordx4 v9, s[48:51], s33 offen offset:1024 lds
  buffer_load_dwordx4 v10, s[48:51], s33 offen offset:2048 lds
  buffer_load_dwordx4 v11, s[48:51], s33 offen offset:3072 lds
  s_waitcnt vmcnt(40)
  s_mov_b32 m0, 0x1a000
  s_add_u32 s33, s64, 0x8000
  buffer_load_dwordx4 v8, s[48:51], s33 offen offset:0 lds
  buffer_load_dwordx4 v9, s[48:51], s33 offen offset:1024 lds
  buffer_load_dwordx4 v10, s[48:51], s33 offen offset:2048 lds
  buffer_load_dwordx4 v11, s[48:51], s33 offen offset:3072 lds
  s_waitcnt vmcnt(40)
  s_mov_b32 m0, 0x1b000
  s_add_u32 s33, s64, 0x10000
  buffer_load_dwordx4 v8, s[48:51], s33 offen offset:0 lds
  buffer_load_dwordx4 v9, s[48:51], s33 offen offset:1024 lds
  buffer_load_dwordx4 v10, s[48:51], s33 offen offset:2048 lds
  buffer_load_dwordx4 v11, s[48:51], s33 offen offset:3072 lds
  s_waitcnt vmcnt(40)
  s_mov_b32 m0, 0x1c000
  s_add_u32 s33, s64, 0x18000
  buffer_load_dwordx4 v8, s[48:51], s33 offen offset:0 lds
  buffer_load_dwordx4 v9, s[48:51], s33 offen offset:1024 lds
  buffer_load_dwordx4 v10, s[48:51], s33 offen offset:2048 lds
  buffer_load_dwordx4 v11, s[48:51], s33 offen offset:3072 lds
  s_waitcnt vmcnt(40)
  s_mov_b32 m0, 0x1d000
  s_add_u32 s33, s65, 0x0
  buffer_load_dwordx4 v8, s[48:51], s33 offen offset:0 lds
  buffer_load_dwordx4 v9, s[48:51], s33 offen offset:1024 lds
  buffer_load_dwordx4 v10, s[48:51], s33 offen offset:2048 lds
  buffer_load_dwordx4 v11, s[48:51], s33 offen offset:3072 lds
  s_waitcnt vmcnt(40)
  s_mov_b32 m0, 0x1e000
  s_add_u32 s33, s65, 0x8000
  buffer_load_dwordx4 v8, s[48:51], s33 offen offset:0 lds
  buffer_load_dwordx4 v9, s[48:51], s33 offen offset:1024 lds
  buffer_load_dwordx4 v10, s[48:51], s33 offen offset:2048 lds
  buffer_load_dwordx4 v11, s[48:51], s33 offen offset:3072 lds
  s_waitcnt vmcnt(40)
  s_barrier
  s_barrier
  s_barrier
  s_mov_b32 m0, 0x1f000
  s_add_u32 s33, s65, 0x10000
  buffer_load_dwordx4 v8, s[48:51], s33 offen offset:0 lds
  buffer_load_dwordx4 v9, s[48:51], s33 offen offset:1024 lds
  buffer_load_dwordx4 v10, s[48:51], s33 offen offset:2048 lds
  buffer_load_dwordx4 v11, s[48:51], s33 offen offset:3072 lds
  s_waitcnt vmcnt(40)
  s_mov_b32 m0, 0x20000
  s_add_u32 s33, s65, 0x18000
  buffer_load_dwordx4 v8, s[48:51], s33 offen offset:0 lds
  buffer_load_dwordx4 v9, s[48:51], s33 offen offset:1024 lds
  buffer_load_dwordx4 v10, s[48:51], s33 offen offset:2048 lds
  buffer_load_dwordx4 v11, s[48:51], s33 offen offset:3072 lds
  s_waitcnt vmcnt(40)
  s_mov_b32 m0, 0x21000
  s_add_u32 s33, s66, 0x0
  buffer_load_dwordx4 v8, s[48:51], s33 offen offset:0 lds
  buffer_load_dwordx4 v9, s[48:51], s33 offen offset:1024 lds
  buffer_load_dwordx4 v10, s[48:51], s33 offen offset:2048 lds
  buffer_load_dwordx4 v11, s[48:51], s33 offen offset:3072 lds
  s_waitcnt vmcnt(40)
  s_mov_b32 m0, 0x22000
  s_add_u32 s33, s66, 0x8000
  buffer_load_dwordx4 v8, s[48:51], s33 offen offset:0 lds
  buffer_load_dwordx4 v9, s[48:51], s33 offen offset:1024 lds
  buffer_load_dwordx4 v10, s[48:51], s33 offen offset:2048 lds
  buffer_load_dwordx4 v11, s[48:51], s33 offen offset:3072 lds
  s_waitcnt vmcnt(40)
  s_barrier
  s_mov_b32 m0, 0x23000
  s_add_u32 s33, s66, 0x10000
  buffer_load_dwordx4 v8, s[48:51], s33 offen offset:0 lds
  buffer_load_dwordx4 v9, s[48:51], s33 offen offset:1024 lds
  buffer_load_dwordx4 v10, s[48:51], s33 offen offset:2048 lds
  buffer_load_dwordx4 v11, s[48:51], s33 offen offset:3072 lds
  s_waitcnt vmcnt(40)
  s_mov_b32 m0, 0x24000
  s_add_u32 s33, s66, 0x18000
  buffer_load_dwordx4 v8, s[48:51], s33 offen offset:0 lds
  buffer_load_dwordx4 v9, s[48:51], s33 offen offset:1024 lds
  buffer_load_dwordx4 v10, s[48:51], s33 offen offset:2048 lds
  buffer_load_dwordx4 v11, s[48:51], s33 offen offset:3072 lds
  s_waitcnt vmcnt(40)
  s_mov_b32 m0, 0x25000
  s_add_u32 s33, s67, 0x0
  buffer_load_dwordx4 v8, s[48:51], s33 offen offset:0 lds
  buffer_load_dwordx4 v9, s[48:51], s33 offen offset:1024 lds
  buffer_load_dwordx4 v10, s[48:51], s33 offen offset:2048 lds
  buffer_load_dwordx4 v11, s[48:51], s33 offen offset:3072 lds
  s_waitcnt vmcnt(40)
  s_mov_b32 m0, 0x10000
  s_add_u32 s33, s67, 0x8000
  buffer_load_dwordx4 v8, s[48:51], s33 offen offset:0 lds
  buffer_load_dwordx4 v9, s[48:51], s33 offen offset:1024 lds
  buffer_load_dwordx4 v10, s[48:51], s33 offen offset:2048 lds
  buffer_load_dwordx4 v11, s[48:51], s33 offen offset:3072 lds
  s_waitcnt vmcnt(40)
  s_barrier
  s_waitcnt vmcnt(24)
  s_barrier
  s_mov_b32 m0, 0x11000
  s_add_u32 s33, s67, 0x10000
  buffer_load_dwordx4 v8, s[48:51], s33 offen offset:0 lds
  buffer_load_dwordx4 v9, s[48:51], s33 offen offset:1024 lds
  buffer_load_dwordx4 v10, s[48:51], s33 offen offset:2048 lds
  buffer_load_dwordx4 v11, s[48:51], s33 offen offset:3072 lds
  s_mov_b32 m0, 0x12000
  s_add_u32 s33, s67, 0x18000
  buffer_load_dwordx4 v8, s[48:51], s33 offen offset:0 lds
  buffer_load_dwordx4 v9, s[48:51], s33 offen offset:1024 lds
  buffer_load_dwordx4 v10, s[48:51], s33 offen offset:2048 lds
  buffer_load_dwordx4 v11, s[48:51], s33 offen offset:3072 lds
  s_mov_b32 m0, 0x13000
  s_add_u32 s33, s64, 0x0
  buffer_load_dwordx4 v8, s[52:55], s33 offen offset:0 lds
  buffer_load_dwordx4 v9, s[52:55], s33 offen offset:1024 lds
  buffer_load_dwordx4 v10, s[52:55], s33 offen offset:2048 lds
  buffer_load_dwordx4 v11, s[52:55], s33 offen offset:3072 lds
  s_mov_b32 m0, 0x14000
  s_add_u32 s33, s64, 0x8000
  buffer_load_dwordx4 v8, s[52:55], s33 offen offset:0 lds
  buffer_load_dwordx4 v9, s[52:55], s33 offen offset:1024 lds
  buffer_load_dwordx4 v10, s[52:55], s33 offen offset:2048 lds
  buffer_load_dwordx4 v11, s[52:55], s33 offen offset:3072 lds
  s_mov_b32 m0, 0x15000
  s_add_u32 s33, s64, 0x10000
  buffer_load_dwordx4 v8, s[52:55], s33 offen offset:0 lds
  buffer_load_dwordx4 v9, s[52:55], s33 offen offset:1024 lds
  buffer_load_dwordx4 v10, s[52:55], s33 offen offset:2048 lds
  buffer_load_dwordx4 v11, s[52:55], s33 offen offset:3072 lds
  s_waitcnt vmcnt(40)
  s_mov_b32 m0, 0x16000
  s_add_u32 s33, s64, 0x18000
  buffer_load_dwordx4 v8, s[52:55], s33 offen offset:0 lds
  buffer_load_dwordx4 v9, s[52:55], s33 offen offset:1024 lds
  buffer_load_dwordx4 v10, s[52:55], s33 offen offset:2048 lds
  buffer_load_dwordx4 v11, s[52:55], s33 offen offset:3072 lds
  s_waitcnt vmcnt(40)
  s_mov_b32 m0, 0x17000
  s_add_u32 s33, s65, 0x0
  buffer_load_dwordx4 v8, s[52:55], s33 offen offset:0 lds
  buffer_load_dwordx4 v9, s[52:55], s33 offen offset:1024 lds
  buffer_load_dwordx4 v10, s[52:55], s33 offen offset:2048 lds
  buffer_load_dwordx4 v11, s[52:55], s33 offen offset:3072 lds
  s_waitcnt vmcnt(40)
  s_mov_b32 m0, 0x18000
  s_add_u32 s33, s65, 0x8000
  buffer_load_dwordx4 v8, s[52:55], s33 offen offset:0 lds
  buffer_load_dwordx4 v9, s[52:55], s33 offen offset:1024 lds
  buffer_load_dwordx4 v10, s[52:55], s33 offen offset:2048 lds
  buffer_load_dwordx4 v11, s[52:55], s33 offen offset:3072 lds
  s_waitcnt vmcnt(40)
  s_barrier
  s_mov_b32 m0, 0x19000
  s_add_u32 s33, s65, 0x10000
  buffer_load_dwordx4 v8, s[52:55], s33 offen offset:0 lds
  buffer_load_dwordx4 v9, s[52:55], s33 offen offset:1024 lds
  buffer_load_dwordx4 v10, s[52:55], s33 offen offset:2048 lds
  buffer_load_dwordx4 v11, s[52:55], s33 offen offset:3072 lds
  s_waitcnt vmcnt(40)
  s_mov_b32 m0, 0x1a000
  s_add_u32 s33, s65, 0x18000
  buffer_load_dwordx4 v8, s[52:55], s33 offen offset:0 lds
  buffer_load_dwordx4 v9, s[52:55], s33 offen offset:1024 lds
  buffer_load_dwordx4 v10, s[52:55], s33 offen offset:2048 lds
  buffer_load_dwordx4 v11, s[52:55], s33 offen offset:3072 lds
  s_waitcnt vmcnt(40)
  s_mov_b32 m0, 0x1b000
  s_add_u32 s33, s66, 0x0
  buffer_load_dwordx4 v8, s[52:55], s33 offen offset:0 lds
  buffer_load_dwordx4 v9, s[52:55], s33 offen offset:1024 lds
  buffer_load_dwordx4 v10, s[52:55], s33 offen offset:2048 lds
  buffer_load_dwordx4 v11, s[52:55], s33 offen offset:3072 lds
  s_waitcnt vmcnt(40)
  s_mov_b32 m0, 0x1c000
  s_add_u32 s33, s66, 0x8000
  buffer_load_dwordx4 v8, s[52:55], s33 offen offset:0 lds
  buffer_load_dwordx4 v9, s[52:55], s33 offen offset:1024 lds
  buffer_load_dwordx4 v10, s[52:55], s33 offen offset:2048 lds
  buffer_load_dwordx4 v11, s[52:55], s33 offen offset:3072 lds
  s_waitcnt vmcnt(40)
  s_barrier
  s_mov_b32 m0, 0x1d000
  s_add_u32 s33, s66, 0x10000
  buffer_load_dwordx4 v8, s[52:55], s33 offen offset:0 lds
  buffer_load_dwordx4 v9, s[52:55], s33 offen offset:1024 lds
  buffer_load_dwordx4 v10, s[52:55], s33 offen offset:2048 lds
  buffer_load_dwordx4 v11, s[52:55], s33 offen offset:3072 lds
  s_waitcnt vmcnt(40)
  s_mov_b32 m0, 0x1e000
  s_add_u32 s33, s66, 0x18000
  buffer_load_dwordx4 v8, s[52:55], s33 offen offset:0 lds
  buffer_load_dwordx4 v9, s[52:55], s33 offen offset:1024 lds
  buffer_load_dwordx4 v10, s[52:55], s33 offen offset:2048 lds
  buffer_load_dwordx4 v11, s[52:55], s33 offen offset:3072 lds
  s_waitcnt vmcnt(40)
  s_mov_b32 m0, 0x1f000
  s_add_u32 s33, s67, 0x0
  buffer_load_dwordx4 v8, s[52:55], s33 offen offset:0 lds
  buffer_load_dwordx4 v9, s[52:55], s33 offen offset:1024 lds
  buffer_load_dwordx4 v10, s[52:55], s33 offen offset:2048 lds
  buffer_load_dwordx4 v11, s[52:55], s33 offen offset:3072 lds
  s_waitcnt vmcnt(40)
  s_mov_b32 m0, 0x20000
  s_add_u32 s33, s67, 0x8000
  buffer_load_dwordx4 v8, s[52:55], s33 offen offset:0 lds
  buffer_load_dwordx4 v9, s[52:55], s33 offen offset:1024 lds
  buffer_load_dwordx4 v10, s[52:55], s33 offen offset:2048 lds
  buffer_load_dwordx4 v11, s[52:55], s33 offen offset:3072 lds
  s_waitcnt vmcnt(40)
  s_barrier
  s_waitcnt vmcnt(24)
  s_barrier
  s_mov_b32 m0, 0x21000
  s_add_u32 s33, s67, 0x10000
  buffer_load_dwordx4 v8, s[52:55], s33 offen offset:0 lds
  buffer_load_dwordx4 v9, s[52:55], s33 offen offset:1024 lds
  buffer_load_dwordx4 v10, s[52:55], s33 offen offset:2048 lds
  buffer_load_dwordx4 v11, s[52:55], s33 offen offset:3072 lds
  s_mov_b32 m0, 0x22000
  s_add_u32 s33, s67, 0x18000
  buffer_load_dwordx4 v8, s[52:55], s33 offen offset:0 lds
  buffer_load_dwordx4 v9, s[52:55], s33 offen offset:1024 lds
  buffer_load_dwordx4 v10, s[52:55], s33 offen offset:2048 lds
  buffer_load_dwordx4 v11, s[52:55], s33 offen offset:3072 lds
  s_mov_b32 m0, 0x23000
  s_add_u32 s33, s72, 0x0
  buffer_load_dwordx4 v20, s[56:59], s33 offen offset:0 lds
  buffer_load_dwordx4 v21, s[56:59], s33 offen offset:1024 lds
  buffer_load_dwordx4 v22, s[56:59], s33 offen offset:2048 lds
  buffer_load_dwordx4 v23, s[56:59], s33 offen offset:3072 lds
  s_mov_b32 m0, 0x24000
  s_add_u32 s33, s72, 0x0
  buffer_load_dwordx4 v24, s[56:59], s33 offen offset:0 lds
  buffer_load_dwordx4 v25, s[56:59], s33 offen offset:1024 lds
  buffer_load_dwordx4 v26, s[56:59], s33 offen offset:2048 lds
  s_mov_b32 m0, 0x24c00
  s_add_u32 s33, s72, 0x1c000
  buffer_load_dwordx4 v20, s[56:59], s33 offen offset:0 lds
  buffer_load_dwordx4 v21, s[56:59], s33 offen offset:1024 lds
  buffer_load_dwordx4 v22, s[56:59], s33 offen offset:2048 lds
  buffer_load_dwordx4 v23, s[56:59], s33 offen offset:3072 lds
  s_mov_b32 m0, 0x25c00
  s_add_u32 s33, s72, 0x1c000
  buffer_load_dwordx4 v24, s[56:59], s33 offen offset:0 lds
  buffer_load_dwordx4 v25, s[56:59], s33 offen offset:1024 lds
  buffer_load_dwordx4 v26, s[56:59], s33 offen offset:2048 lds
  s_waitcnt vmcnt(40)
  s_mov_b32 m0, 0x10000
  s_add_u32 s33, s72, 0x38000
  buffer_load_dwordx4 v20, s[56:59], s33 offen offset:0 lds
  buffer_load_dwordx4 v21, s[56:59], s33 offen offset:1024 lds
  buffer_load_dwordx4 v22, s[56:59], s33 offen offset:2048 lds
  buffer_load_dwordx4 v23, s[56:59], s33 offen offset:3072 lds
  s_mov_b32 m0, 0x11000
  s_add_u32 s33, s72, 0x38000
  buffer_load_dwordx4 v24, s[56:59], s33 offen offset:0 lds
  buffer_load_dwordx4 v25, s[56:59], s33 offen offset:1024 lds
  buffer_load_dwordx4 v26, s[56:59], s33 offen offset:2048 lds
  s_waitcnt vmcnt(40)
  s_waitcnt vmcnt(37)
  s_barrier
  s_mov_b32 m0, 0x11c00
  s_add_u32 s33, s72, 0x54000
  buffer_load_dwordx4 v20, s[56:59], s33 offen offset:0 lds
  buffer_load_dwordx4 v21, s[56:59], s33 offen offset:1024 lds
  buffer_load_dwordx4 v22, s[56:59], s33 offen offset:2048 lds
  buffer_load_dwordx4 v23, s[56:59], s33 offen offset:3072 lds
  s_mov_b32 m0, 0x12c00
  s_add_u32 s33, s72, 0x54000
  buffer_load_dwordx4 v24, s[56:59], s33 offen offset:0 lds
  buffer_load_dwordx4 v25, s[56:59], s33 offen offset:1024 lds
  buffer_load_dwordx4 v26, s[56:59], s33 offen offset:2048 lds
  s_waitcnt vmcnt(40)
  s_waitcnt vmcnt(28)
  s_barrier
  s_waitcnt vmcnt(0)
  s_barrier
  s_barrier
  s_barrier
  s_mov_b32 m0, 0x11c00
  s_add_u32 s33, s76, 0x0
  buffer_load_dwordx4 v8, s[60:63], s33 offen offset:0 lds
  buffer_load_dwordx4 v9, s[60:63], s33 offen offset:1024 lds
  buffer_load_dwordx4 v10, s[60:63], s33 offen offset:2048 lds
  buffer_load_dwordx4 v11, s[60:63], s33 offen offset:3072 lds
  s_barrier
  s_mov_b32 m0, 0x12c00
  s_add_u32 s33, s76, 0x8000
  buffer_load_dwordx4 v8, s[60:63], s33 offen offset:0 lds
  buffer_load_dwordx4 v9, s[60:63], s33 offen offset:1024 lds
  buffer_load_dwordx4 v10, s[60:63], s33 offen offset:2048 lds
  buffer_load_dwordx4 v11, s[60:63], s33 offen offset:3072 lds
  s_mov_b32 m0, 0x13c00
  s_add_u32 s33, s76, 0x10000
  buffer_load_dwordx4 v8, s[60:63], s33 offen offset:0 lds
  buffer_load_dwordx4 v9, s[60:63], s33 offen offset:1024 lds
  buffer_load_dwordx4 v10, s[60:63], s33 offen offset:2048 lds
  buffer_load_dwordx4 v11, s[60:63], s33 offen offset:3072 lds
  s_mov_b32 m0, 0x14c00
  s_add_u32 s33, s76, 0x1c000
  buffer_load_dwordx4 v8, s[60:63], s33 offen offset:0 lds
  buffer_load_dwordx4 v9, s[60:63], s33 offen offset:1024 lds
  buffer_load_dwordx4 v10, s[60:63], s33 offen offset:2048 lds
  buffer_load_dwordx4 v11, s[60:63], s33 offen offset:3072 lds
  s_mov_b32 m0, 0x15c00
  s_add_u32 s33, s76, 0x24000
  buffer_load_dwordx4 v8, s[60:63], s33 offen offset:0 lds
  buffer_load_dwordx4 v9, s[60:63], s33 offen offset:1024 lds
  buffer_load_dwordx4 v10, s[60:63], s33 offen offset:2048 lds
  buffer_load_dwordx4 v11, s[60:63], s33 offen offset:3072 lds
  s_barrier
  s_mov_b32 m0, 0x16c00
  s_add_u32 s33, s76, 0x2c000
  buffer_load_dwordx4 v8, s[60:63], s33 offen offset:0 lds
  buffer_load_dwordx4 v9, s[60:63], s33 offen offset:1024 lds
  buffer_load_dwordx4 v10, s[60:63], s33 offen offset:2048 lds
  buffer_load_dwordx4 v11, s[60:63], s33 offen offset:3072 lds
  s_mov_b32 m0, 0x17c00
  s_add_u32 s33, s76, 0x18000
  buffer_load_dwordx4 v8, s[60:63], s33 offen offset:0 lds
  buffer_load_dwordx4 v9, s[60:63], s33 offen offset:1024 lds
  s_mov_b32 m0, 0x18400
  s_add_u32 s33, s76, 0x34000
  buffer_load_dwordx4 v8, s[60:63], s33 offen offset:0 lds
  buffer_load_dwordx4 v9, s[60:63], s33 offen offset:1024 lds
  s_mov_b32 m0, 0x18c00
  s_add_u32 s33, s77, 0x0
  buffer_load_dwordx4 v8, s[60:63], s33 offen offset:0 lds
  buffer_load_dwordx4 v9, s[60:63], s33 offen offset:1024 lds
  buffer_load_dwordx4 v10, s[60:63], s33 offen offset:2048 lds
  buffer_load_dwordx4 v11, s[60:63], s33 offen offset:3072 lds
  s_mov_b32 m0, 0x19c00
  s_add_u32 s33, s77, 0x8000
  buffer_load_dwordx4 v8, s[60:63], s33 offen offset:0 lds
  buffer_load_dwordx4 v9, s[60:63], s33 offen offset:1024 lds
  buffer_load_dwordx4 v10, s[60:63], s33 offen offset:2048 lds
  buffer_load_dwordx4 v11, s[60:63], s33 offen offset:3072 lds
  s_mov_b32 m0, 0x1ac00
  s_add_u32 s33, s77, 0x10000
  buffer_load_dwordx4 v8, s[60:63], s33 offen offset:0 lds
  buffer_load_dwordx4 v9, s[60:63], s33 offen offset:1024 lds
  buffer_load_dwordx4 v10, s[60:63], s33 offen offset:2048 lds
  buffer_load_dwordx4 v11, s[60:63], s33 offen offset:3072 lds
  s_mov_b32 m0, 0x1bc00
  s_add_u32 s33, s77, 0x1c000
  buffer_load_dwordx4 v8, s[60:63], s33 offen offset:0 lds
  buffer_load_dwordx4 v9, s[60:63], s33 offen offset:1024 lds
  buffer_load_dwordx4 v10, s[60:63], s33 offen offset:2048 lds
  buffer_load_dwordx4 v11, s[60:63], s33 offen offset:3072 lds
  s_waitcnt vmcnt(40)
  s_mov_b32 m0, 0x1cc00
  s_add_u32 s33, s77, 0x24000
  buffer_load_dwordx4 v8, s[60:63], s33 offen offset:0 lds
  buffer_load_dwordx4 v9, s[60:63], s33 offen offset:1024 lds
  buffer_load_dwordx4 v10, s[60:63], s33 offen offset:2048 lds
  buffer_load_dwordx4 v11, s[60:63], s33 offen offset:3072 lds
  s_waitcnt vmcnt(40)
  s_mov_b32 m0, 0x1dc00
  s_add_u32 s33, s77, 0x2c000
  buffer_load_dwordx4 v8, s[60:63], s33 offen offset:0 lds
  buffer_load_dwordx4 v9, s[60:63], s33 offen offset:1024 lds
  buffer_load_dwordx4 v10, s[60:63], s33 offen offset:2048 lds
  buffer_load_dwordx4 v11, s[60:63], s33 offen offset:3072 lds
  s_waitcnt vmcnt(40)
  s_mov_b32 m0, 0x1ec00
  s_add_u32 s33, s77, 0x18000
  buffer_load_dwordx4 v8, s[60:63], s33 offen offset:0 lds
  buffer_load_dwordx4 v9, s[60:63], s33 offen offset:1024 lds
  s_mov_b32 m0, 0x1f400
  s_add_u32 s33, s77, 0x34000
  buffer_load_dwordx4 v8, s[60:63], s33 offen offset:0 lds
  buffer_load_dwordx4 v9, s[60:63], s33 offen offset:1024 lds
  s_waitcnt vmcnt(40)
  s_mov_b32 m0, 0x1fc00
  s_add_u32 s33, s78, 0x0
  buffer_load_dwordx4 v8, s[60:63], s33 offen offset:0 lds
  buffer_load_dwordx4 v9, s[60:63], s33 offen offset:1024 lds
  buffer_load_dwordx4 v10, s[60:63], s33 offen offset:2048 lds
  buffer_load_dwordx4 v11, s[60:63], s33 offen offset:3072 lds
  s_waitcnt vmcnt(40)
  s_mov_b32 m0, 0x20c00
  s_add_u32 s33, s78, 0x8000
  buffer_load_dwordx4 v8, s[60:63], s33 offen offset:0 lds
  buffer_load_dwordx4 v9, s[60:63], s33 offen offset:1024 lds
  buffer_load_dwordx4 v10, s[60:63], s33 offen offset:2048 lds
  buffer_load_dwordx4 v11, s[60:63], s33 offen offset:3072 lds
  s_waitcnt vmcnt(40)
  s_mov_b32 m0, 0x21c00
  s_add_u32 s33, s78, 0x10000
  buffer_load_dwordx4 v8, s[60:63], s33 offen offset:0 lds
  buffer_load_dwordx4 v9, s[60:63], s33 offen offset:1024 lds
  buffer_load_dwordx4 v10, s[60:63], s33 offen offset:2048 lds
  buffer_load_dwordx4 v11, s[60:63], s33 offen offset:3072 lds
  s_waitcnt vmcnt(40)
  s_mov_b32 m0, 0x22c00
  s_add_u32 s33, s78, 0x1c000
  buffer_load_dwordx4 v8, s[60:63], s33 offen offset:0 lds
  buffer_load_dwordx4 v9, s[60:63], s33 offen offset:1024 lds
  buffer_load_dwordx4 v10, s[60:63], s33 offen offset:2048 lds
  buffer_load_dwordx4 v11, s[60:63], s33 offen offset:3072 lds
  s_waitcnt vmcnt(40)
  s_mov_b32 m0, 0x23c00
  s_add_u32 s33, s78, 0x24000
  buffer_load_dwordx4 v8, s[60:63], s33 offen offset:0 lds
  buffer_load_dwordx4 v9, s[60:63], s33 offen offset:1024 lds
  buffer_load_dwordx4 v10, s[60:63], s33 offen offset:2048 lds
  buffer_load_dwordx4 v11, s[60:63], s33 offen offset:3072 lds
  s_waitcnt vmcnt(40)
  s_mov_b32 m0, 0x24c00
  s_add_u32 s33, s78, 0x2c000
  buffer_load_dwordx4 v8, s[60:63], s33 offen offset:0 lds
  buffer_load_dwordx4 v9, s[60:63], s33 offen offset:1024 lds
  buffer_load_dwordx4 v10, s[60:63], s33 offen offset:2048 lds
  buffer_load_dwordx4 v11, s[60:63], s33 offen offset:3072 lds
  s_waitcnt vmcnt(40)
  s_mov_b32 m0, 0x25c00
  s_add_u32 s33, s78, 0x18000
  buffer_load_dwordx4 v8, s[60:63], s33 offen offset:0 lds
  buffer_load_dwordx4 v9, s[60:63], s33 offen offset:1024 lds
  s_mov_b32 m0, 0x26400
  s_add_u32 s33, s78, 0x34000
  buffer_load_dwordx4 v8, s[60:63], s33 offen offset:0 lds
  buffer_load_dwordx4 v9, s[60:63], s33 offen offset:1024 lds
  s_waitcnt vmcnt(40)
  s_barrier
  s_mov_b32 m0, 0x10000
  s_add_u32 s33, s79, 0x0
  buffer_load_dwordx4 v8, s[60:63], s33 offen offset:0 lds
  buffer_load_dwordx4 v9, s[60:63], s33 offen offset:1024 lds
  buffer_load_dwordx4 v10, s[60:63], s33 offen offset:2048 lds
  buffer_load_dwordx4 v11, s[60:63], s33 offen offset:3072 lds
  s_waitcnt vmcnt(40)
  s_barrier
  s_barrier
  s_mov_b32 m0, 0x11000
  s_add_u32 s33, s79, 0x8000
  buffer_load_dwordx4 v8, s[60:63], s33 offen offset:0 lds
  buffer_load_dwordx4 v9, s[60:63], s33 offen offset:1024 lds
  buffer_load_dwordx4 v10, s[60:63], s33 offen offset:2048 lds
  buffer_load_dwordx4 v11, s[60:63], s33 offen offset:3072 lds
  s_waitcnt vmcnt(40)
  s_mov_b32 m0, 0x12000
  s_add_u32 s33, s79, 0x10000
  buffer_load_dwordx4 v8, s[60:63], s33 offen offset:0 lds
  buffer_load_dwordx4 v9, s[60:63], s33 offen offset:1024 lds
  buffer_load_dwordx4 v10, s[60:63], s33 offen offset:2048 lds
  buffer_load_dwordx4 v11, s[60:63], s33 offen offset:3072 lds
  s_waitcnt vmcnt(40)
  s_mov_b32 m0, 0x13000
  s_add_u32 s33, s79, 0x1c000
  buffer_load_dwordx4 v8, s[60:63], s33 offen offset:0 lds
  buffer_load_dwordx4 v9, s[60:63], s33 offen offset:1024 lds
  buffer_load_dwordx4 v10, s[60:63], s33 offen offset:2048 lds
  buffer_load_dwordx4 v11, s[60:63], s33 offen offset:3072 lds
  s_waitcnt vmcnt(40)
  s_mov_b32 m0, 0x14000
  s_add_u32 s33, s79, 0x24000
  buffer_load_dwordx4 v8, s[60:63], s33 offen offset:0 lds
  buffer_load_dwordx4 v9, s[60:63], s33 offen offset:1024 lds
  buffer_load_dwordx4 v10, s[60:63], s33 offen offset:2048 lds
  buffer_load_dwordx4 v11, s[60:63], s33 offen offset:3072 lds
  s_waitcnt vmcnt(40)
  s_barrier
  s_mov_b32 m0, 0x15000
  s_add_u32 s33, s79, 0x2c000
  buffer_load_dwordx4 v8, s[60:63], s33 offen offset:0 lds
  buffer_load_dwordx4 v9, s[60:63], s33 offen offset:1024 lds
  buffer_load_dwordx4 v10, s[60:63], s33 offen offset:2048 lds
  buffer_load_dwordx4 v11, s[60:63], s33 offen offset:3072 lds
  s_waitcnt vmcnt(40)
  s_mov_b32 m0, 0x16000
  s_add_u32 s33, s79, 0x18000
  buffer_load_dwordx4 v8, s[60:63], s33 offen offset:0 lds
  buffer_load_dwordx4 v9, s[60:63], s33 offen offset:1024 lds
  s_mov_b32 m0, 0x16800
  s_add_u32 s33, s79, 0x34000
  buffer_load_dwordx4 v8, s[60:63], s33 offen offset:0 lds
  buffer_load_dwordx4 v9, s[60:63], s33 offen offset:1024 lds
  s_waitcnt vmcnt(40)
  s_mov_b32 m0, 0x17000
  s_add_u32 s33, s80, 0x0
  buffer_load_dwordx4 v8, s[60:63], s33 offen offset:0 lds
  buffer_load_dwordx4 v9, s[60:63], s33 offen offset:1024 lds
  buffer_load_dwordx4 v10, s[60:63], s33 offen offset:2048 lds
  buffer_load_dwordx4 v11, s[60:63], s33 offen offset:3072 lds
  s_waitcnt vmcnt(40)
  s_mov_b32 m0, 0x18000
  s_add_u32 s33, s80, 0x8000
  buffer_load_dwordx4 v8, s[60:63], s33 offen offset:0 lds
  buffer_load_dwordx4 v9, s[60:63], s33 offen offset:1024 lds
  buffer_load_dwordx4 v10, s[60:63], s33 offen offset:2048 lds
  buffer_load_dwordx4 v11, s[60:63], s33 offen offset:3072 lds
  s_waitcnt vmcnt(40)
  s_barrier
  s_mov_b32 m0, 0x19000
  s_add_u32 s33, s80, 0x10000
  buffer_load_dwordx4 v8, s[60:63], s33 offen offset:0 lds
  buffer_load_dwordx4 v9, s[60:63], s33 offen offset:1024 lds
  buffer_load_dwordx4 v10, s[60:63], s33 offen offset:2048 lds
  buffer_load_dwordx4 v11, s[60:63], s33 offen offset:3072 lds
  s_waitcnt vmcnt(40)
  s_mov_b32 m0, 0x1a000
  s_add_u32 s33, s80, 0x1c000
  buffer_load_dwordx4 v8, s[60:63], s33 offen offset:0 lds
  buffer_load_dwordx4 v9, s[60:63], s33 offen offset:1024 lds
  buffer_load_dwordx4 v10, s[60:63], s33 offen offset:2048 lds
  buffer_load_dwordx4 v11, s[60:63], s33 offen offset:3072 lds
  s_waitcnt vmcnt(40)
  s_mov_b32 m0, 0x1b000
  s_add_u32 s33, s80, 0x24000
  buffer_load_dwordx4 v8, s[60:63], s33 offen offset:0 lds
  buffer_load_dwordx4 v9, s[60:63], s33 offen offset:1024 lds
  buffer_load_dwordx4 v10, s[60:63], s33 offen offset:2048 lds
  buffer_load_dwordx4 v11, s[60:63], s33 offen offset:3072 lds
  s_waitcnt vmcnt(40)
  s_mov_b32 m0, 0x1c000
  s_add_u32 s33, s80, 0x2c000
  buffer_load_dwordx4 v8, s[60:63], s33 offen offset:0 lds
  buffer_load_dwordx4 v9, s[60:63], s33 offen offset:1024 lds
  buffer_load_dwordx4 v10, s[60:63], s33 offen offset:2048 lds
  buffer_load_dwordx4 v11, s[60:63], s33 offen offset:3072 lds
  s_waitcnt vmcnt(40)
  s_barrier
  s_mov_b32 m0, 0x1d000
  s_add_u32 s33, s80, 0x18000
  buffer_load_dwordx4 v8, s[60:63], s33 offen offset:0 lds
  buffer_load_dwordx4 v9, s[60:63], s33 offen offset:1024 lds
  s_mov_b32 m0, 0x1d800
  s_add_u32 s33, s80, 0x34000
  buffer_load_dwordx4 v8, s[60:63], s33 offen offset:0 lds
  buffer_load_dwordx4 v9, s[60:63], s33 offen offset:1024 lds
  s_waitcnt vmcnt(40)
  s_mov_b32 m0, 0x1e000
  s_add_u32 s33, s81, 0x0
  buffer_load_dwordx4 v8, s[60:63], s33 offen offset:0 lds
  buffer_load_dwordx4 v9, s[60:63], s33 offen offset:1024 lds
  buffer_load_dwordx4 v10, s[60:63], s33 offen offset:2048 lds
  buffer_load_dwordx4 v11, s[60:63], s33 offen offset:3072 lds
  s_waitcnt vmcnt(40)
  s_mov_b32 m0, 0x1f000
  s_add_u32 s33, s81, 0x8000
  buffer_load_dwordx4 v8, s[60:63], s33 offen offset:0 lds
  buffer_load_dwordx4 v9, s[60:63], s33 offen offset:1024 lds
  buffer_load_dwordx4 v10, s[60:63], s33 offen offset:2048 lds
  buffer_load_dwordx4 v11, s[60:63], s33 offen offset:3072 lds
  s_waitcnt vmcnt(40)
  s_mov_b32 m0, 0x20000
  s_add_u32 s33, s81, 0x10000
  buffer_load_dwordx4 v8, s[60:63], s33 offen offset:0 lds
  buffer_load_dwordx4 v9, s[60:63], s33 offen offset:1024 lds
  buffer_load_dwordx4 v10, s[60:63], s33 offen offset:2048 lds
  buffer_load_dwordx4 v11, s[60:63], s33 offen offset:3072 lds
  s_waitcnt vmcnt(40)
  s_barrier
  s_mov_b32 m0, 0x21000
  s_add_u32 s33, s81, 0x1c000
  buffer_load_dwordx4 v8, s[60:63], s33 offen offset:0 lds
  buffer_load_dwordx4 v9, s[60:63], s33 offen offset:1024 lds
  buffer_load_dwordx4 v10, s[60:63], s33 offen offset:2048 lds
  buffer_load_dwordx4 v11, s[60:63], s33 offen offset:3072 lds
  s_waitcnt vmcnt(40)
  s_mov_b32 m0, 0x22000
  s_add_u32 s33, s81, 0x24000
  buffer_load_dwordx4 v8, s[60:63], s33 offen offset:0 lds
  buffer_load_dwordx4 v9, s[60:63], s33 offen offset:1024 lds
  buffer_load_dwordx4 v10, s[60:63], s33 offen offset:2048 lds
  buffer_load_dwordx4 v11, s[60:63], s33 offen offset:3072 lds
  s_waitcnt vmcnt(40)
  s_mov_b32 m0, 0x23000
  s_add_u32 s33, s81, 0x2c000
  buffer_load_dwordx4 v8, s[60:63], s33 offen offset:0 lds
  buffer_load_dwordx4 v9, s[60:63], s33 offen offset:1024 lds
  buffer_load_dwordx4 v10, s[60:63], s33 offen offset:2048 lds
  buffer_load_dwordx4 v11, s[60:63], s33 offen offset:3072 lds
  s_waitcnt vmcnt(40)
  s_mov_b32 m0, 0x24000
  s_add_u32 s33, s81, 0x18000
  buffer_load_dwordx4 v8, s[60:63], s33 offen offset:0 lds
  buffer_load_dwordx4 v9, s[60:63], s33 offen offset:1024 lds
  s_mov_b32 m0, 0x24800
  s_add_u32 s33, s81, 0x34000
  buffer_load_dwordx4 v8, s[60:63], s33 offen offset:0 lds
  buffer_load_dwordx4 v9, s[60:63], s33 offen offset:1024 lds
  s_waitcnt vmcnt(40)
  s_barrier
  s_mov_b32 m0, 0x25000
  s_add_u32 s33, s82, 0x0
  buffer_load_dwordx4 v8, s[60:63], s33 offen offset:0 lds
  buffer_load_dwordx4 v9, s[60:63], s33 offen offset:1024 lds
  buffer_load_dwordx4 v10, s[60:63], s33 offen offset:2048 lds
  buffer_load_dwordx4 v11, s[60:63], s33 offen offset:3072 lds
  s_waitcnt vmcnt(40)
  s_mov_b32 m0, 0x10000
  s_add_u32 s33, s82, 0x8000
  buffer_load_dwordx4 v8, s[60:63], s33 offen offset:0 lds
  buffer_load_dwordx4 v9, s[60:63], s33 offen offset:1024 lds
  buffer_load_dwordx4 v10, s[60:63], s33 offen offset:2048 lds
  buffer_load_dwordx4 v11, s[60:63], s33 offen offset:3072 lds
  s_waitcnt vmcnt(40)
  s_mov_b32 m0, 0x11000
  s_add_u32 s33, s82, 0x10000
  buffer_load_dwordx4 v8, s[60:63], s33 offen offset:0 lds
  buffer_load_dwordx4 v9, s[60:63], s33 offen offset:1024 lds
  buffer_load_dwordx4 v10, s[60:63], s33 offen offset:2048 lds
  buffer_load_dwordx4 v11, s[60:63], s33 offen offset:3072 lds
  s_waitcnt vmcnt(40)
  s_mov_b32 m0, 0x12000
  s_add_u32 s33, s82, 0x1c000
  buffer_load_dwordx4 v8, s[60:63], s33 offen offset:0 lds
  buffer_load_dwordx4 v9, s[60:63], s33 offen offset:1024 lds
  buffer_load_dwordx4 v10, s[60:63], s33 offen offset:2048 lds
  buffer_load_dwordx4 v11, s[60:63], s33 offen offset:3072 lds
  s_waitcnt vmcnt(40)
  s_barrier
  s_mov_b32 m0, 0x13000
  s_add_u32 s33, s82, 0x24000
  buffer_load_dwordx4 v8, s[60:63], s33 offen offset:0 lds
  buffer_load_dwordx4 v9, s[60:63], s33 offen offset:1024 lds
  buffer_load_dwordx4 v10, s[60:63], s33 offen offset:2048 lds
  buffer_load_dwordx4 v11, s[60:63], s33 offen offset:3072 lds
  s_waitcnt vmcnt(40)
  s_mov_b32 m0, 0x14000
  s_add_u32 s33, s82, 0x2c000
  buffer_load_dwordx4 v8, s[60:63], s33 offen offset:0 lds
  buffer_load_dwordx4 v9, s[60:63], s33 offen offset:1024 lds
  buffer_load_dwordx4 v10, s[60:63], s33 offen offset:2048 lds
  buffer_load_dwordx4 v11, s[60:63], s33 offen offset:3072 lds
  s_waitcnt vmcnt(40)
  s_mov_b32 m0, 0x15000
  s_add_u32 s33, s82, 0x18000
  buffer_load_dwordx4 v8, s[60:63], s33 offen offset:0 lds
  buffer_load_dwordx4 v9, s[60:63], s33 offen offset:1024 lds
  s_mov_b32 m0, 0x15800
  s_add_u32 s33, s82, 0x34000
  buffer_load_dwordx4 v8, s[60:63], s33 offen offset:0 lds
  buffer_load_dwordx4 v9, s[60:63], s33 offen offset:1024 lds
  s_waitcnt vmcnt(40)
  s_mov_b32 m0, 0x16000
  s_add_u32 s33, s83, 0x0
  buffer_load_dwordx4 v8, s[60:63], s33 offen offset:0 lds
  buffer_load_dwordx4 v9, s[60:63], s33 offen offset:1024 lds
  buffer_load_dwordx4 v10, s[60:63], s33 offen offset:2048 lds
  buffer_load_dwordx4 v11, s[60:63], s33 offen offset:3072 lds
  s_waitcnt vmcnt(40)
  s_barrier
  s_mov_b32 m0, 0x17000
  s_add_u32 s33, s83, 0x8000
  buffer_load_dwordx4 v8, s[60:63], s33 offen offset:0 lds
  buffer_load_dwordx4 v9, s[60:63], s33 offen offset:1024 lds
  buffer_load_dwordx4 v10, s[60:63], s33 offen offset:2048 lds
  buffer_load_dwordx4 v11, s[60:63], s33 offen offset:3072 lds
  s_waitcnt vmcnt(40)
  s_mov_b32 m0, 0x18000
  s_add_u32 s33, s83, 0x10000
  buffer_load_dwordx4 v8, s[60:63], s33 offen offset:0 lds
  buffer_load_dwordx4 v9, s[60:63], s33 offen offset:1024 lds
  buffer_load_dwordx4 v10, s[60:63], s33 offen offset:2048 lds
  buffer_load_dwordx4 v11, s[60:63], s33 offen offset:3072 lds
  s_waitcnt vmcnt(40)
  s_mov_b32 m0, 0x19000
  s_add_u32 s33, s83, 0x1c000
  buffer_load_dwordx4 v8, s[60:63], s33 offen offset:0 lds
  buffer_load_dwordx4 v9, s[60:63], s33 offen offset:1024 lds
  buffer_load_dwordx4 v10, s[60:63], s33 offen offset:2048 lds
  buffer_load_dwordx4 v11, s[60:63], s33 offen offset:3072 lds
  s_waitcnt vmcnt(40)
  s_mov_b32 m0, 0x1a000
  s_add_u32 s33, s83, 0x24000
  buffer_load_dwordx4 v8, s[60:63], s33 offen offset:0 lds
  buffer_load_dwordx4 v9, s[60:63], s33 offen offset:1024 lds
  buffer_load_dwordx4 v10, s[60:63], s33 offen offset:2048 lds
  buffer_load_dwordx4 v11, s[60:63], s33 offen offset:3072 lds
  s_waitcnt vmcnt(40)
  s_barrier
  s_mov_b32 m0, 0x1b000
  s_add_u32 s33, s83, 0x2c000
  buffer_load_dwordx4 v8, s[60:63], s33 offen offset:0 lds
  buffer_load_dwordx4 v9, s[60:63], s33 offen offset:1024 lds
  buffer_load_dwordx4 v10, s[60:63], s33 offen offset:2048 lds
  buffer_load_dwordx4 v11, s[60:63], s33 offen offset:3072 lds
  s_waitcnt vmcnt(40)
  s_mov_b32 m0, 0x1c000
  s_add_u32 s33, s83, 0x18000
  buffer_load_dwordx4 v8, s[60:63], s33 offen offset:0 lds
  buffer_load_dwordx4 v9, s[60:63], s33 offen offset:1024 lds
  s_mov_b32 m0, 0x1c800
  s_add_u32 s33, s83, 0x34000
  buffer_load_dwordx4 v8, s[60:63], s33 offen offset:0 lds
  buffer_load_dwordx4 v9, s[60:63], s33 offen offset:1024 lds
  s_waitcnt vmcnt(40)
  s_mov_b32 m0, 0x1d000
  s_add_u32 s33, s68, 0x0
  buffer_load_dwordx4 v12, s[40:43], s33 offen offset:0 lds
  buffer_load_dwordx4 v13, s[40:43], s33 offen offset:1024 lds
  buffer_load_dwordx4 v14, s[40:43], s33 offen offset:2048 lds
  buffer_load_dwordx4 v15, s[40:43], s33 offen offset:3072 lds
  s_waitcnt vmcnt(40)
  s_mov_b32 m0, 0x1e000
  s_add_u32 s33, s68, 0x18000
  buffer_load_dwordx4 v12, s[40:43], s33 offen offset:0 lds
  buffer_load_dwordx4 v13, s[40:43], s33 offen offset:1024 lds
  buffer_load_dwordx4 v14, s[40:43], s33 offen offset:2048 lds
  buffer_load_dwordx4 v15, s[40:43], s33 offen offset:3072 lds
  s_waitcnt vmcnt(40)
  s_barrier
  s_mov_b32 m0, 0x1f000
  s_add_u32 s33, s68, 0x30000
  buffer_load_dwordx4 v12, s[40:43], s33 offen offset:0 lds
  buffer_load_dwordx4 v13, s[40:43], s33 offen offset:1024 lds
  buffer_load_dwordx4 v14, s[40:43], s33 offen offset:2048 lds
  buffer_load_dwordx4 v15, s[40:43], s33 offen offset:3072 lds
  s_waitcnt vmcnt(40)
  s_mov_b32 m0, 0x20000
  s_add_u32 s33, s68, 0x48000
  buffer_load_dwordx4 v12, s[40:43], s33 offen offset:0 lds
  buffer_load_dwordx4 v13, s[40:43], s33 offen offset:1024 lds
  buffer_load_dwordx4 v14, s[40:43], s33 offen offset:2048 lds
  buffer_load_dwordx4 v15, s[40:43], s33 offen offset:3072 lds
  s_waitcnt vmcnt(40)
  s_mov_b32 m0, 0x21000
  s_add_u32 s33, s69, 0x0
  buffer_load_dwordx4 v12, s[40:43], s33 offen offset:0 lds
  buffer_load_dwordx4 v13, s[40:43], s33 offen offset:1024 lds
  buffer_load_dwordx4 v14, s[40:43], s33 offen offset:2048 lds
  buffer_load_dwordx4 v15, s[40:43], s33 offen offset:3072 lds
  s_waitcnt vmcnt(40)
  s_mov_b32 m0, 0x22000
  s_add_u32 s33, s69, 0x18000
  buffer_load_dwordx4 v12, s[40:43], s33 offen offset:0 lds
  buffer_load_dwordx4 v13, s[40:43], s33 offen offset:1024 lds
  buffer_load_dwordx4 v14, s[40:43], s33 offen offset:2048 lds
  buffer_load_dwordx4 v15, s[40:43], s33 offen offset:3072 lds
  s_waitcnt vmcnt(40)
  s_barrier
  s_mov_b32 m0, 0x23000
  s_add_u32 s33, s69, 0x30000
  buffer_load_dwordx4 v12, s[40:43], s33 offen offset:0 lds
  buffer_load_dwordx4 v13, s[40:43], s33 offen offset:1024 lds
  buffer_load_dwordx4 v14, s[40:43], s33 offen offset:2048 lds
  buffer_load_dwordx4 v15, s[40:43], s33 offen offset:3072 lds
  s_waitcnt vmcnt(40)
  s_mov_b32 m0, 0x24000
  s_add_u32 s33, s69, 0x48000
  buffer_load_dwordx4 v12, s[40:43], s33 offen offset:0 lds
  buffer_load_dwordx4 v13, s[40:43], s33 offen offset:1024 lds
  buffer_load_dwordx4 v14, s[40:43], s33 offen offset:2048 lds
  buffer_load_dwordx4 v15, s[40:43], s33 offen offset:3072 lds
  s_waitcnt vmcnt(40)
  s_mov_b32 m0, 0x25000
  s_add_u32 s33, s70, 0x0
  buffer_load_dwordx4 v12, s[40:43], s33 offen offset:0 lds
  buffer_load_dwordx4 v13, s[40:43], s33 offen offset:1024 lds
  buffer_load_dwordx4 v14, s[40:43], s33 offen offset:2048 lds
  buffer_load_dwordx4 v15, s[40:43], s33 offen offset:3072 lds
  s_waitcnt vmcnt(40)
  s_mov_b32 m0, 0x10000
  s_add_u32 s33, s70, 0x18000
  buffer_load_dwordx4 v12, s[40:43], s33 offen offset:0 lds
  buffer_load_dwordx4 v13, s[40:43], s33 offen offset:1024 lds
  buffer_load_dwordx4 v14, s[40:43], s33 offen offset:2048 lds
  buffer_load_dwordx4 v15, s[40:43], s33 offen offset:3072 lds
  s_waitcnt vmcnt(40)
  s_barrier
  s_mov_b32 m0, 0x11000
  s_add_u32 s33, s70, 0x30000
  buffer_load_dwordx4 v12, s[40:43], s33 offen offset:0 lds
  buffer_load_dwordx4 v13, s[40:43], s33 offen offset:1024 lds
  buffer_load_dwordx4 v14, s[40:43], s33 offen offset:2048 lds
  buffer_load_dwordx4 v15, s[40:43], s33 offen offset:3072 lds
  s_waitcnt vmcnt(40)
  s_mov_b32 m0, 0x12000
  s_add_u32 s33, s70, 0x48000
  buffer_load_dwordx4 v12, s[40:43], s33 offen offset:0 lds
  buffer_load_dwordx4 v13, s[40:43], s33 offen offset:1024 lds
  buffer_load_dwordx4 v14, s[40:43], s33 offen offset:2048 lds
  buffer_load_dwordx4 v15, s[40:43], s33 offen offset:3072 lds
  s_waitcnt vmcnt(40)
  s_mov_b32 m0, 0x13000
  s_add_u32 s33, s71, 0x0
  buffer_load_dwordx4 v12, s[40:43], s33 offen offset:0 lds
  buffer_load_dwordx4 v13, s[40:43], s33 offen offset:1024 lds
  buffer_load_dwordx4 v14, s[40:43], s33 offen offset:2048 lds
  buffer_load_dwordx4 v15, s[40:43], s33 offen offset:3072 lds
  s_waitcnt vmcnt(40)
  s_mov_b32 m0, 0x14000
  s_add_u32 s33, s71, 0x18000
  buffer_load_dwordx4 v12, s[40:43], s33 offen offset:0 lds
  buffer_load_dwordx4 v13, s[40:43], s33 offen offset:1024 lds
  buffer_load_dwordx4 v14, s[40:43], s33 offen offset:2048 lds
  buffer_load_dwordx4 v15, s[40:43], s33 offen offset:3072 lds
  s_waitcnt vmcnt(40)
  s_barrier
  s_mov_b32 m0, 0x15000
  s_add_u32 s33, s71, 0x30000
  buffer_load_dwordx4 v12, s[40:43], s33 offen offset:0 lds
  buffer_load_dwordx4 v13, s[40:43], s33 offen offset:1024 lds
  buffer_load_dwordx4 v14, s[40:43], s33 offen offset:2048 lds
  buffer_load_dwordx4 v15, s[40:43], s33 offen offset:3072 lds
  s_waitcnt vmcnt(40)
  s_mov_b32 m0, 0x16000
  s_add_u32 s33, s71, 0x48000
  buffer_load_dwordx4 v12, s[40:43], s33 offen offset:0 lds
  buffer_load_dwordx4 v13, s[40:43], s33 offen offset:1024 lds
  buffer_load_dwordx4 v14, s[40:43], s33 offen offset:2048 lds
  buffer_load_dwordx4 v15, s[40:43], s33 offen offset:3072 lds
  s_waitcnt vmcnt(40)
  s_mov_b32 m0, 0x17000
  s_add_u32 s33, s68, 0x0
  buffer_load_dwordx4 v16, s[40:43], s33 offen offset:0 lds
  buffer_load_dwordx4 v17, s[40:43], s33 offen offset:1024 lds
  buffer_load_dwordx4 v18, s[40:43], s33 offen offset:2048 lds
  buffer_load_dwordx4 v19, s[40:43], s33 offen offset:3072 lds
  s_waitcnt vmcnt(40)
  s_mov_b32 m0, 0x18000
  s_add_u32 s33, s68, 0x30000
  buffer_load_dwordx4 v16, s[40:43], s33 offen offset:0 lds
  buffer_load_dwordx4 v17, s[40:43], s33 offen offset:1024 lds
  buffer_load_dwordx4 v18, s[40:43], s33 offen offset:2048 lds
  buffer_load_dwordx4 v19, s[40:43], s33 offen offset:3072 lds
  s_waitcnt vmcnt(40)
  s_mov_b32 m0, 0x19000
  s_add_u32 s33, s69, 0x0
  buffer_load_dwordx4 v16, s[40:43], s33 offen offset:0 lds
  buffer_load_dwordx4 v17, s[40:43], s33 offen offset:1024 lds
  buffer_load_dwordx4 v18, s[40:43], s33 offen offset:2048 lds
  buffer_load_dwordx4 v19, s[40:43], s33 offen offset:3072 lds
  s_waitcnt vmcnt(40)
  s_mov_b32 m0, 0x1a000
  s_add_u32 s33, s69, 0x30000
  buffer_load_dwordx4 v16, s[40:43], s33 offen offset:0 lds
  buffer_load_dwordx4 v17, s[40:43], s33 offen offset:1024 lds
  buffer_load_dwordx4 v18, s[40:43], s33 offen offset:2048 lds
  buffer_load_dwordx4 v19, s[40:43], s33 offen offset:3072 lds
  s_waitcnt vmcnt(40)
  s_mov_b32 m0, 0x1b000
  s_add_u32 s33, s70, 0x0
  buffer_load_dwordx4 v16, s[40:43], s33 offen offset:0 lds
  buffer_load_dwordx4 v17, s[40:43], s33 offen offset:1024 lds
  buffer_load_dwordx4 v18, s[40:43], s33 offen offset:2048 lds
  buffer_load_dwordx4 v19, s[40:43], s33 offen offset:3072 lds
  s_waitcnt vmcnt(40)
  s_mov_b32 m0, 0x1c000
  s_add_u32 s33, s70, 0x30000
  buffer_load_dwordx4 v16, s[40:43], s33 offen offset:0 lds
  buffer_load_dwordx4 v17, s[40:43], s33 offen offset:1024 lds
  buffer_load_dwordx4 v18, s[40:43], s33 offen offset:2048 lds
  buffer_load_dwordx4 v19, s[40:43], s33 offen offset:3072 lds
  s_waitcnt vmcnt(40)
  s_barrier
  s_barrier
  s_barrier
  s_waitcnt vmcnt(24)
  s_barrier
  s_barrier
  s_mov_b32 m0, 0x1d000
  s_add_u32 s33, s71, 0x0
  buffer_load_dwordx4 v16, s[40:43], s33 offen offset:0 lds
  buffer_load_dwordx4 v17, s[40:43], s33 offen offset:1024 lds
  buffer_load_dwordx4 v18, s[40:43], s33 offen offset:2048 lds
  buffer_load_dwordx4 v19, s[40:43], s33 offen offset:3072 lds
  s_mov_b32 m0, 0x1e000
  s_add_u32 s33, s71, 0x30000
  buffer_load_dwordx4 v16, s[40:43], s33 offen offset:0 lds
  buffer_load_dwordx4 v17, s[40:43], s33 offen offset:1024 lds
  buffer_load_dwordx4 v18, s[40:43], s33 offen offset:2048 lds
  buffer_load_dwordx4 v19, s[40:43], s33 offen offset:3072 lds
  s_mov_b32 m0, 0x1f000
  s_add_u32 s33, s64, 0x0
  buffer_load_dwordx4 v8, s[44:47], s33 offen offset:0 lds
  buffer_load_dwordx4 v9, s[44:47], s33 offen offset:1024 lds
  buffer_load_dwordx4 v10, s[44:47], s33 offen offset:2048 lds
  buffer_load_dwordx4 v11, s[44:47], s33 offen offset:3072 lds
  s_mov_b32 m0, 0x20000
  s_add_u32 s33, s64, 0x8000
  buffer_load_dwordx4 v8, s[44:47], s33 offen offset:0 lds
  buffer_load_dwordx4 v9, s[44:47], s33 offen offset:1024 lds
  buffer_load_dwordx4 v10, s[44:47], s33 offen offset:2048 lds
  buffer_load_dwordx4 v11, s[44:47], s33 offen offset:3072 lds
  s_mov_b32 m0, 0x21000
  s_add_u32 s33, s64, 0x10000
  buffer_load_dwordx4 v8, s[44:47], s33 offen offset:0 lds
  buffer_load_dwordx4 v9, s[44:47], s33 offen offset:1024 lds
  buffer_load_dwordx4 v10, s[44:47], s33 offen offset:2048 lds
  buffer_load_dwordx4 v11, s[44:47], s33 offen offset:3072 lds
  s_waitcnt vmcnt(40)
  s_mov_b32 m0, 0x22000
  s_add_u32 s33, s64, 0x18000
  buffer_load_dwordx4 v8, s[44:47], s33 offen offset:0 lds
  buffer_load_dwordx4 v9, s[44:47], s33 offen offset:1024 lds
  buffer_load_dwordx4 v10, s[44:47], s33 offen offset:2048 lds
  buffer_load_dwordx4 v11, s[44:47], s33 offen offset:3072 lds
  s_waitcnt vmcnt(40)
  s_mov_b32 m0, 0x23000
  s_add_u32 s33, s65, 0x0
  buffer_load_dwordx4 v8, s[44:47], s33 offen offset:0 lds
  buffer_load_dwordx4 v9, s[44:47], s33 offen offset:1024 lds
  buffer_load_dwordx4 v10, s[44:47], s33 offen offset:2048 lds
  buffer_load_dwordx4 v11, s[44:47], s33 offen offset:3072 lds
  s_waitcnt vmcnt(40)
  s_mov_b32 m0, 0x24000
  s_add_u32 s33, s65, 0x8000
  buffer_load_dwordx4 v8, s[44:47], s33 offen offset:0 lds
  buffer_load_dwordx4 v9, s[44:47], s33 offen offset:1024 lds
  buffer_load_dwordx4 v10, s[44:47], s33 offen offset:2048 lds
  buffer_load_dwordx4 v11, s[44:47], s33 offen offset:3072 lds
  s_waitcnt vmcnt(40)
  s_mov_b32 m0, 0x25000
  s_add_u32 s33, s65, 0x10000
  buffer_load_dwordx4 v8, s[44:47], s33 offen offset:0 lds
  buffer_load_dwordx4 v9, s[44:47], s33 offen offset:1024 lds
  buffer_load_dwordx4 v10, s[44:47], s33 offen offset:2048 lds
  buffer_load_dwordx4 v11, s[44:47], s33 offen offset:3072 lds
  s_waitcnt vmcnt(40)
  s_mov_b32 m0, 0x10000
  s_add_u32 s33, s65, 0x18000
  buffer_load_dwordx4 v8, s[44:47], s33 offen offset:0 lds
  buffer_load_dwordx4 v9, s[44:47], s33 offen offset:1024 lds
  buffer_load_dwordx4 v10, s[44:47], s33 offen offset:2048 lds
  buffer_load_dwordx4 v11, s[44:47], s33 offen offset:3072 lds
  s_waitcnt vmcnt(40)
  s_mov_b32 m0, 0x11000
  s_add_u32 s33, s66, 0x0
  buffer_load_dwordx4 v8, s[44:47], s33 offen offset:0 lds
  buffer_load_dwordx4 v9, s[44:47], s33 offen offset:1024 lds
  buffer_load_dwordx4 v10, s[44:47], s33 offen offset:2048 lds
  buffer_load_dwordx4 v11, s[44:47], s33 offen offset:3072 lds
  s_waitcnt vmcnt(40)
  s_mov_b32 m0, 0x12000
  s_add_u32 s33, s66, 0x8000
  buffer_load_dwordx4 v8, s[44:47], s33 offen offset:0 lds
  buffer_load_dwordx4 v9, s[44:47], s33 offen offset:1024 lds
  buffer_load_dwordx4 v10, s[44:47], s33 offen offset:2048 lds
  buffer_load_dwordx4 v11, s[44:47], s33 offen offset:3072 lds
  s_waitcnt vmcnt(40)
  s_mov_b32 m0, 0x13000
  s_add_u32 s33, s66, 0x10000
  buffer_load_dwordx4 v8, s[44:47], s33 offen offset:0 lds
  buffer_load_dwordx4 v9, s[44:47], s33 offen offset:1024 lds
  buffer_load_dwordx4 v10, s[44:47], s33 offen offset:2048 lds
  buffer_load_dwordx4 v11, s[44:47], s33 offen offset:3072 lds
  s_waitcnt vmcnt(40)
  s_mov_b32 m0, 0x14000
  s_add_u32 s33, s66, 0x18000
  buffer_load_dwordx4 v8, s[44:47], s33 offen offset:0 lds
  buffer_load_dwordx4 v9, s[44:47], s33 offen offset:1024 lds
  buffer_load_dwordx4 v10, s[44:47], s33 offen offset:2048 lds
  buffer_load_dwordx4 v11, s[44:47], s33 offen offset:3072 lds
  s_waitcnt vmcnt(40)
  s_mov_b32 m0, 0x15000
  s_add_u32 s33, s67, 0x0
  buffer_load_dwordx4 v8, s[44:47], s33 offen offset:0 lds
  buffer_load_dwordx4 v9, s[44:47], s33 offen offset:1024 lds
  buffer_load_dwordx4 v10, s[44:47], s33 offen offset:2048 lds
  buffer_load_dwordx4 v11, s[44:47], s33 offen offset:3072 lds
  s_waitcnt vmcnt(40)
  s_mov_b32 m0, 0x16000
  s_add_u32 s33, s67, 0x8000
  buffer_load_dwordx4 v8, s[44:47], s33 offen offset:0 lds
  buffer_load_dwordx4 v9, s[44:47], s33 offen offset:1024 lds
  buffer_load_dwordx4 v10, s[44:47], s33 offen offset:2048 lds
  buffer_load_dwordx4 v11, s[44:47], s33 offen offset:3072 lds
  s_waitcnt vmcnt(40)
  s_barrier
  s_barrier
  s_barrier
  s_barrier
  s_mov_b32 m0, 0x17000
  s_add_u32 s33, s67, 0x10000
  buffer_load_dwordx4 v8, s[44:47], s33 offen offset:0 lds
  buffer_load_dwordx4 v9, s[44:47], s33 offen offset:1024 lds
  buffer_load_dwordx4 v10, s[44:47], s33 offen offset:2048 lds
  buffer_load_dwordx4 v11, s[44:47], s33 offen offset:3072 lds
  s_waitcnt vmcnt(40)
  s_mov_b32 m0, 0x18000
  s_add_u32 s33, s67, 0x18000
  buffer_load_dwordx4 v8, s[44:47], s33 offen offset:0 lds
  buffer_load_dwordx4 v9, s[44:47], s33 offen offset:1024 lds
  buffer_load_dwordx4 v10, s[44:47], s33 offen offset:2048 lds
  buffer_load_dwordx4 v11, s[44:47], s33 offen offset:3072 lds
  s_waitcnt vmcnt(40)
  s_mov_b32 m0, 0x19000
  s_add_u32 s33, s64, 0x0
  buffer_load_dwordx4 v8, s[48:51], s33 offen offset:0 lds
  buffer_load_dwordx4 v9, s[48:51], s33 offen offset:1024 lds
  buffer_load_dwordx4 v10, s[48:51], s33 offen offset:2048 lds
  buffer_load_dwordx4 v11, s[48:51], s33 offen offset:3072 lds
  s_waitcnt vmcnt(40)
  s_mov_b32 m0, 0x1a000
  s_add_u32 s33, s64, 0x8000
  buffer_load_dwordx4 v8, s[48:51], s33 offen offset:0 lds
  buffer_load_dwordx4 v9, s[48:51], s33 offen offset:1024 lds
  buffer_load_dwordx4 v10, s[48:51], s33 offen offset:2048 lds
  buffer_load_dwordx4 v11, s[48:51], s33 offen offset:3072 lds
  s_waitcnt vmcnt(40)
  s_mov_b32 m0, 0x1b000
  s_add_u32 s33, s64, 0x10000
  buffer_load_dwordx4 v8, s[48:51], s33 offen offset:0 lds
  buffer_load_dwordx4 v9, s[48:51], s33 offen offset:1024 lds
  buffer_load_dwordx4 v10, s[48:51], s33 offen offset:2048 lds
  buffer_load_dwordx4 v11, s[48:51], s33 offen offset:3072 lds
  s_waitcnt vmcnt(40)
  s_mov_b32 m0, 0x1c000
  s_add_u32 s33, s64, 0x18000
  buffer_load_dwordx4 v8, s[48:51], s33 offen offset:0 lds
  buffer_load_dwordx4 v9, s[48:51], s33 offen offset:1024 lds
  buffer_load_dwordx4 v10, s[48:51], s33 offen offset:2048 lds
  buffer_load_dwordx4 v11, s[48:51], s33 offen offset:3072 lds
  s_waitcnt vmcnt(40)
  s_mov_b32 m0, 0x1d000
  s_add_u32 s33, s65, 0x0
  buffer_load_dwordx4 v8, s[48:51], s33 offen offset:0 lds
  buffer_load_dwordx4 v9, s[48:51], s33 offen offset:1024 lds
  buffer_load_dwordx4 v10, s[48:51], s33 offen offset:2048 lds
  buffer_load_dwordx4 v11, s[48:51], s33 offen offset:3072 lds
  s_waitcnt vmcnt(40)
  s_mov_b32 m0, 0x1e000
  s_add_u32 s33, s65, 0x8000
  buffer_load_dwordx4 v8, s[48:51], s33 offen offset:0 lds
  buffer_load_dwordx4 v9, s[48:51], s33 offen offset:1024 lds
  buffer_load_dwordx4 v10, s[48:51], s33 offen offset:2048 lds
  buffer_load_dwordx4 v11, s[48:51], s33 offen offset:3072 lds
  s_waitcnt vmcnt(40)
  s_barrier
  s_barrier
  s_barrier
  s_mov_b32 m0, 0x1f000
  s_add_u32 s33, s65, 0x10000
  buffer_load_dwordx4 v8, s[48:51], s33 offen offset:0 lds
  buffer_load_dwordx4 v9, s[48:51], s33 offen offset:1024 lds
  buffer_load_dwordx4 v10, s[48:51], s33 offen offset:2048 lds
  buffer_load_dwordx4 v11, s[48:51], s33 offen offset:3072 lds
  s_waitcnt vmcnt(40)
  s_mov_b32 m0, 0x20000
  s_add_u32 s33, s65, 0x18000
  buffer_load_dwordx4 v8, s[48:51], s33 offen offset:0 lds
  buffer_load_dwordx4 v9, s[48:51], s33 offen offset:1024 lds
  buffer_load_dwordx4 v10, s[48:51], s33 offen offset:2048 lds
  buffer_load_dwordx4 v11, s[48:51], s33 offen offset:3072 lds
  s_waitcnt vmcnt(40)
  s_mov_b32 m0, 0x21000
  s_add_u32 s33, s66, 0x0
  buffer_load_dwordx4 v8, s[48:51], s33 offen offset:0 lds
  buffer_load_dwordx4 v9, s[48:51], s33 offen offset:1024 lds
  buffer_load_dwordx4 v10, s[48:51], s33 offen offset:2048 lds
  buffer_load_dwordx4 v11, s[48:51], s33 offen offset:3072 lds
  s_waitcnt vmcnt(40)
  s_mov_b32 m0, 0x22000
  s_add_u32 s33, s66, 0x8000
  buffer_load_dwordx4 v8, s[48:51], s33 offen offset:0 lds
  buffer_load_dwordx4 v9, s[48:51], s33 offen offset:1024 lds
  buffer_load_dwordx4 v10, s[48:51], s33 offen offset:2048 lds
  buffer_load_dwordx4 v11, s[48:51], s33 offen offset:3072 lds
  s_waitcnt vmcnt(40)
  s_barrier
  s_mov_b32 m0, 0x23000
  s_add_u32 s33, s66, 0x10000
  buffer_load_dwordx4 v8, s[48:51], s33 offen offset:0 lds
  buffer_load_dwordx4 v9, s[48:51], s33 offen offset:1024 lds
  buffer_load_dwordx4 v10, s[48:51], s33 offen offset:2048 lds
  buffer_load_dwordx4 v11, s[48:51], s33 offen offset:3072 lds
  s_waitcnt vmcnt(40)
  s_mov_b32 m0, 0x24000
  s_add_u32 s33, s66, 0x18000
  buffer_load_dwordx4 v8, s[48:51], s33 offen offset:0 lds
  buffer_load_dwordx4 v9, s[48:51], s33 offen offset:1024 lds
  buffer_load_dwordx4 v10, s[48:51], s33 offen offset:2048 lds
  buffer_load_dwordx4 v11, s[48:51], s33 offen offset:3072 lds
  s_waitcnt vmcnt(40)
  s_mov_b32 m0, 0x25000
  s_add_u32 s33, s67, 0x0
  buffer_load_dwordx4 v8, s[48:51], s33 offen offset:0 lds
  buffer_load_dwordx4 v9, s[48:51], s33 offen offset:1024 lds
  buffer_load_dwordx4 v10, s[48:51], s33 offen offset:2048 lds
  buffer_load_dwordx4 v11, s[48:51], s33 offen offset:3072 lds
  s_waitcnt vmcnt(40)
  s_mov_b32 m0, 0x10000
  s_add_u32 s33, s67, 0x8000
  buffer_load_dwordx4 v8, s[48:51], s33 offen offset:0 lds
  buffer_load_dwordx4 v9, s[48:51], s33 offen offset:1024 lds
  buffer_load_dwordx4 v10, s[48:51], s33 offen offset:2048 lds
  buffer_load_dwordx4 v11, s[48:51], s33 offen offset:3072 lds
  s_waitcnt vmcnt(40)
  s_barrier
  s_waitcnt vmcnt(24)
  s_barrier
  s_mov_b32 m0, 0x11000
  s_add_u32 s33, s67, 0x10000
  buffer_load_dwordx4 v8, s[48:51], s33 offen offset:0 lds
  buffer_load_dwordx4 v9, s[48:51], s33 offen offset:1024 lds
  buffer_load_dwordx4 v10, s[48:51], s33 offen offset:2048 lds
  buffer_load_dwordx4 v11, s[48:51], s33 offen offset:3072 lds
  s_mov_b32 m0, 0x12000
  s_add_u32 s33, s67, 0x18000
  buffer_load_dwordx4 v8, s[48:51], s33 offen offset:0 lds
  buffer_load_dwordx4 v9, s[48:51], s33 offen offset:1024 lds
  buffer_load_dwordx4 v10, s[48:51], s33 offen offset:2048 lds
  buffer_load_dwordx4 v11, s[48:51], s33 offen offset:3072 lds
  s_mov_b32 m0, 0x13000
  s_add_u32 s33, s64, 0x0
  buffer_load_dwordx4 v8, s[52:55], s33 offen offset:0 lds
  buffer_load_dwordx4 v9, s[52:55], s33 offen offset:1024 lds
  buffer_load_dwordx4 v10, s[52:55], s33 offen offset:2048 lds
  buffer_load_dwordx4 v11, s[52:55], s33 offen offset:3072 lds
  s_mov_b32 m0, 0x14000
  s_add_u32 s33, s64, 0x8000
  buffer_load_dwordx4 v8, s[52:55], s33 offen offset:0 lds
  buffer_load_dwordx4 v9, s[52:55], s33 offen offset:1024 lds
  buffer_load_dwordx4 v10, s[52:55], s33 offen offset:2048 lds
  buffer_load_dwordx4 v11, s[52:55], s33 offen offset:3072 lds
  s_mov_b32 m0, 0x15000
  s_add_u32 s33, s64, 0x10000
  buffer_load_dwordx4 v8, s[52:55], s33 offen offset:0 lds
  buffer_load_dwordx4 v9, s[52:55], s33 offen offset:1024 lds
  buffer_load_dwordx4 v10, s[52:55], s33 offen offset:2048 lds
  buffer_load_dwordx4 v11, s[52:55], s33 offen offset:3072 lds
  s_waitcnt vmcnt(40)
  s_mov_b32 m0, 0x16000
  s_add_u32 s33, s64, 0x18000
  buffer_load_dwordx4 v8, s[52:55], s33 offen offset:0 lds
  buffer_load_dwordx4 v9, s[52:55], s33 offen offset:1024 lds
  buffer_load_dwordx4 v10, s[52:55], s33 offen offset:2048 lds
  buffer_load_dwordx4 v11, s[52:55], s33 offen offset:3072 lds
  s_waitcnt vmcnt(40)
  s_mov_b32 m0, 0x17000
  s_add_u32 s33, s65, 0x0
  buffer_load_dwordx4 v8, s[52:55], s33 offen offset:0 lds
  buffer_load_dwordx4 v9, s[52:55], s33 offen offset:1024 lds
  buffer_load_dwordx4 v10, s[52:55], s33 offen offset:2048 lds
  buffer_load_dwordx4 v11, s[52:55], s33 offen offset:3072 lds
  s_waitcnt vmcnt(40)
  s_mov_b32 m0, 0x18000
  s_add_u32 s33, s65, 0x8000
  buffer_load_dwordx4 v8, s[52:55], s33 offen offset:0 lds
  buffer_load_dwordx4 v9, s[52:55], s33 offen offset:1024 lds
  buffer_load_dwordx4 v10, s[52:55], s33 offen offset:2048 lds
  buffer_load_dwordx4 v11, s[52:55], s33 offen offset:3072 lds
  s_waitcnt vmcnt(40)
  s_barrier
  s_mov_b32 m0, 0x19000
  s_add_u32 s33, s65, 0x10000
  buffer_load_dwordx4 v8, s[52:55], s33 offen offset:0 lds
  buffer_load_dwordx4 v9, s[52:55], s33 offen offset:1024 lds
  buffer_load_dwordx4 v10, s[52:55], s33 offen offset:2048 lds
  buffer_load_dwordx4 v11, s[52:55], s33 offen offset:3072 lds
  s_waitcnt vmcnt(40)
  s_mov_b32 m0, 0x1a000
  s_add_u32 s33, s65, 0x18000
  buffer_load_dwordx4 v8, s[52:55], s33 offen offset:0 lds
  buffer_load_dwordx4 v9, s[52:55], s33 offen offset:1024 lds
  buffer_load_dwordx4 v10, s[52:55], s33 offen offset:2048 lds
  buffer_load_dwordx4 v11, s[52:55], s33 offen offset:3072 lds
  s_waitcnt vmcnt(40)
  s_mov_b32 m0, 0x1b000
  s_add_u32 s33, s66, 0x0
  buffer_load_dwordx4 v8, s[52:55], s33 offen offset:0 lds
  buffer_load_dwordx4 v9, s[52:55], s33 offen offset:1024 lds
  buffer_load_dwordx4 v10, s[52:55], s33 offen offset:2048 lds
  buffer_load_dwordx4 v11, s[52:55], s33 offen offset:3072 lds
  s_waitcnt vmcnt(40)
  s_mov_b32 m0, 0x1c000
  s_add_u32 s33, s66, 0x8000
  buffer_load_dwordx4 v8, s[52:55], s33 offen offset:0 lds
  buffer_load_dwordx4 v9, s[52:55], s33 offen offset:1024 lds
  buffer_load_dwordx4 v10, s[52:55], s33 offen offset:2048 lds
  buffer_load_dwordx4 v11, s[52:55], s33 offen offset:3072 lds
  s_waitcnt vmcnt(40)
  s_barrier
  s_mov_b32 m0, 0x1d000
  s_add_u32 s33, s66, 0x10000
  buffer_load_dwordx4 v8, s[52:55], s33 offen offset:0 lds
  buffer_load_dwordx4 v9, s[52:55], s33 offen offset:1024 lds
  buffer_load_dwordx4 v10, s[52:55], s33 offen offset:2048 lds
  buffer_load_dwordx4 v11, s[52:55], s33 offen offset:3072 lds
  s_waitcnt vmcnt(40)
  s_mov_b32 m0, 0x1e000
  s_add_u32 s33, s66, 0x18000
  buffer_load_dwordx4 v8, s[52:55], s33 offen offset:0 lds
  buffer_load_dwordx4 v9, s[52:55], s33 offen offset:1024 lds
  buffer_load_dwordx4 v10, s[52:55], s33 offen offset:2048 lds
  buffer_load_dwordx4 v11, s[52:55], s33 offen offset:3072 lds
  s_waitcnt vmcnt(40)
  s_mov_b32 m0, 0x1f000
  s_add_u32 s33, s67, 0x0
  buffer_load_dwordx4 v8, s[52:55], s33 offen offset:0 lds
  buffer_load_dwordx4 v9, s[52:55], s33 offen offset:1024 lds
  buffer_load_dwordx4 v10, s[52:55], s33 offen offset:2048 lds
  buffer_load_dwordx4 v11, s[52:55], s33 offen offset:3072 lds
  s_waitcnt vmcnt(40)
  s_mov_b32 m0, 0x20000
  s_add_u32 s33, s67, 0x8000
  buffer_load_dwordx4 v8, s[52:55], s33 offen offset:0 lds
  buffer_load_dwordx4 v9, s[52:55], s33 offen offset:1024 lds
  buffer_load_dwordx4 v10, s[52:55], s33 offen offset:2048 lds
  buffer_load_dwordx4 v11, s[52:55], s33 offen offset:3072 lds
  s_waitcnt vmcnt(40)
  s_barrier
  s_waitcnt vmcnt(24)
  s_barrier
  s_mov_b32 m0, 0x21000
  s_add_u32 s33, s67, 0x10000
  buffer_load_dwordx4 v8, s[52:55], s33 offen offset:0 lds
  buffer_load_dwordx4 v9, s[52:55], s33 offen offset:1024 lds
  buffer_load_dwordx4 v10, s[52:55], s33 offen offset:2048 lds
  buffer_load_dwordx4 v11, s[52:55], s33 offen offset:3072 lds
  s_mov_b32 m0, 0x22000
  s_add_u32 s33, s67, 0x18000
  buffer_load_dwordx4 v8, s[52:55], s33 offen offset:0 lds
  buffer_load_dwordx4 v9, s[52:55], s33 offen offset:1024 lds
  buffer_load_dwordx4 v10, s[52:55], s33 offen offset:2048 lds
  buffer_load_dwordx4 v11, s[52:55], s33 offen offset:3072 lds
  s_mov_b32 m0, 0x23000
  s_add_u32 s33, s72, 0x0
  buffer_load_dwordx4 v20, s[56:59], s33 offen offset:0 lds
  buffer_load_dwordx4 v21, s[56:59], s33 offen offset:1024 lds
  buffer_load_dwordx4 v22, s[56:59], s33 offen offset:2048 lds
  buffer_load_dwordx4 v23, s[56:59], s33 offen offset:3072 lds
  s_mov_b32 m0, 0x24000
  s_add_u32 s33, s72, 0x0
  buffer_load_dwordx4 v24, s[56:59], s33 offen offset:0 lds
  buffer_load_dwordx4 v25, s[56:59], s33 offen offset:1024 lds
  buffer_load_dwordx4 v26, s[56:59], s33 offen offset:2048 lds
  s_mov_b32 m0, 0x24c00
  s_add_u32 s33, s72, 0x1c000
  buffer_load_dwordx4 v20, s[56:59], s33 offen offset:0 lds
  buffer_load_dwordx4 v21, s[56:59], s33 offen offset:1024 lds
  buffer_load_dwordx4 v22, s[56:59], s33 offen offset:2048 lds
  buffer_load_dwordx4 v23, s[56:59], s33 offen offset:3072 lds
  s_mov_b32 m0, 0x25c00
  s_add_u32 s33, s72, 0x1c000
  buffer_load_dwordx4 v24, s[56:59], s33 offen offset:0 lds
  buffer_load_dwordx4 v25, s[56:59], s33 offen offset:1024 lds
  buffer_load_dwordx4 v26, s[56:59], s33 offen offset:2048 lds
  s_waitcnt vmcnt(40)
  s_mov_b32 m0, 0x10000
  s_add_u32 s33, s72, 0x38000
  buffer_load_dwordx4 v20, s[56:59], s33 offen offset:0 lds
  buffer_load_dwordx4 v21, s[56:59], s33 offen offset:1024 lds
  buffer_load_dwordx4 v22, s[56:59], s33 offen offset:2048 lds
  buffer_load_dwordx4 v23, s[56:59], s33 offen offset:3072 lds
  s_mov_b32 m0, 0x11000
  s_add_u32 s33, s72, 0x38000
  buffer_load_dwordx4 v24, s[56:59], s33 offen offset:0 lds
  buffer_load_dwordx4 v25, s[56:59], s33 offen offset:1024 lds
  buffer_load_dwordx4 v26, s[56:59], s33 offen offset:2048 lds
  s_waitcnt vmcnt(40)
  s_waitcnt vmcnt(37)
  s_barrier
  s_mov_b32 m0, 0x11c00
  s_add_u32 s33, s72, 0x54000
  buffer_load_dwordx4 v20, s[56:59], s33 offen offset:0 lds
  buffer_load_dwordx4 v21, s[56:59], s33 offen offset:1024 lds
  buffer_load_dwordx4 v22, s[56:59], s33 offen offset:2048 lds
  buffer_load_dwordx4 v23, s[56:59], s33 offen offset:3072 lds
  s_mov_b32 m0, 0x12c00
  s_add_u32 s33, s72, 0x54000
  buffer_load_dwordx4 v24, s[56:59], s33 offen offset:0 lds
  buffer_load_dwordx4 v25, s[56:59], s33 offen offset:1024 lds
  buffer_load_dwordx4 v26, s[56:59], s33 offen offset:2048 lds
  s_waitcnt vmcnt(40)
  s_waitcnt vmcnt(28)
  s_barrier
  s_waitcnt vmcnt(0)
  s_barrier
  s_barrier
  s_barrier
  s_mov_b32 m0, 0x11c00
  s_add_u32 s33, s76, 0x0
  buffer_load_dwordx4 v8, s[60:63], s33 offen offset:0 lds
  buffer_load_dwordx4 v9, s[60:63], s33 offen offset:1024 lds
  buffer_load_dwordx4 v10, s[60:63], s33 offen offset:2048 lds
  buffer_load_dwordx4 v11, s[60:63], s33 offen offset:3072 lds
  s_barrier
  s_mov_b32 m0, 0x12c00
  s_add_u32 s33, s76, 0x8000
  buffer_load_dwordx4 v8, s[60:63], s33 offen offset:0 lds
  buffer_load_dwordx4 v9, s[60:63], s33 offen offset:1024 lds
  buffer_load_dwordx4 v10, s[60:63], s33 offen offset:2048 lds
  buffer_load_dwordx4 v11, s[60:63], s33 offen offset:3072 lds
  s_mov_b32 m0, 0x13c00
  s_add_u32 s33, s76, 0x10000
  buffer_load_dwordx4 v8, s[60:63], s33 offen offset:0 lds
  buffer_load_dwordx4 v9, s[60:63], s33 offen offset:1024 lds
  buffer_load_dwordx4 v10, s[60:63], s33 offen offset:2048 lds
  buffer_load_dwordx4 v11, s[60:63], s33 offen offset:3072 lds
  s_mov_b32 m0, 0x14c00
  s_add_u32 s33, s76, 0x1c000
  buffer_load_dwordx4 v8, s[60:63], s33 offen offset:0 lds
  buffer_load_dwordx4 v9, s[60:63], s33 offen offset:1024 lds
  buffer_load_dwordx4 v10, s[60:63], s33 offen offset:2048 lds
  buffer_load_dwordx4 v11, s[60:63], s33 offen offset:3072 lds
  s_mov_b32 m0, 0x15c00
  s_add_u32 s33, s76, 0x24000
  buffer_load_dwordx4 v8, s[60:63], s33 offen offset:0 lds
  buffer_load_dwordx4 v9, s[60:63], s33 offen offset:1024 lds
  buffer_load_dwordx4 v10, s[60:63], s33 offen offset:2048 lds
  buffer_load_dwordx4 v11, s[60:63], s33 offen offset:3072 lds
  s_barrier
  s_mov_b32 m0, 0x16c00
  s_add_u32 s33, s76, 0x2c000
  buffer_load_dwordx4 v8, s[60:63], s33 offen offset:0 lds
  buffer_load_dwordx4 v9, s[60:63], s33 offen offset:1024 lds
  buffer_load_dwordx4 v10, s[60:63], s33 offen offset:2048 lds
  buffer_load_dwordx4 v11, s[60:63], s33 offen offset:3072 lds
  s_mov_b32 m0, 0x17c00
  s_add_u32 s33, s76, 0x18000
  buffer_load_dwordx4 v8, s[60:63], s33 offen offset:0 lds
  buffer_load_dwordx4 v9, s[60:63], s33 offen offset:1024 lds
  s_mov_b32 m0, 0x18400
  s_add_u32 s33, s76, 0x34000
  buffer_load_dwordx4 v8, s[60:63], s33 offen offset:0 lds
  buffer_load_dwordx4 v9, s[60:63], s33 offen offset:1024 lds
  s_mov_b32 m0, 0x18c00
  s_add_u32 s33, s77, 0x0
  buffer_load_dwordx4 v8, s[60:63], s33 offen offset:0 lds
  buffer_load_dwordx4 v9, s[60:63], s33 offen offset:1024 lds
  buffer_load_dwordx4 v10, s[60:63], s33 offen offset:2048 lds
  buffer_load_dwordx4 v11, s[60:63], s33 offen offset:3072 lds
  s_mov_b32 m0, 0x19c00
  s_add_u32 s33, s77, 0x8000
  buffer_load_dwordx4 v8, s[60:63], s33 offen offset:0 lds
  buffer_load_dwordx4 v9, s[60:63], s33 offen offset:1024 lds
  buffer_load_dwordx4 v10, s[60:63], s33 offen offset:2048 lds
  buffer_load_dwordx4 v11, s[60:63], s33 offen offset:3072 lds
  s_mov_b32 m0, 0x1ac00
  s_add_u32 s33, s77, 0x10000
  buffer_load_dwordx4 v8, s[60:63], s33 offen offset:0 lds
  buffer_load_dwordx4 v9, s[60:63], s33 offen offset:1024 lds
  buffer_load_dwordx4 v10, s[60:63], s33 offen offset:2048 lds
  buffer_load_dwordx4 v11, s[60:63], s33 offen offset:3072 lds
  s_mov_b32 m0, 0x1bc00
  s_add_u32 s33, s77, 0x1c000
  buffer_load_dwordx4 v8, s[60:63], s33 offen offset:0 lds
  buffer_load_dwordx4 v9, s[60:63], s33 offen offset:1024 lds
  buffer_load_dwordx4 v10, s[60:63], s33 offen offset:2048 lds
  buffer_load_dwordx4 v11, s[60:63], s33 offen offset:3072 lds
  s_waitcnt vmcnt(40)
  s_mov_b32 m0, 0x1cc00
  s_add_u32 s33, s77, 0x24000
  buffer_load_dwordx4 v8, s[60:63], s33 offen offset:0 lds
  buffer_load_dwordx4 v9, s[60:63], s33 offen offset:1024 lds
  buffer_load_dwordx4 v10, s[60:63], s33 offen offset:2048 lds
  buffer_load_dwordx4 v11, s[60:63], s33 offen offset:3072 lds
  s_waitcnt vmcnt(40)
  s_mov_b32 m0, 0x1dc00
  s_add_u32 s33, s77, 0x2c000
  buffer_load_dwordx4 v8, s[60:63], s33 offen offset:0 lds
  buffer_load_dwordx4 v9, s[60:63], s33 offen offset:1024 lds
  buffer_load_dwordx4 v10, s[60:63], s33 offen offset:2048 lds
  buffer_load_dwordx4 v11, s[60:63], s33 offen offset:3072 lds
  s_waitcnt vmcnt(40)
  s_mov_b32 m0, 0x1ec00
  s_add_u32 s33, s77, 0x18000
  buffer_load_dwordx4 v8, s[60:63], s33 offen offset:0 lds
  buffer_load_dwordx4 v9, s[60:63], s33 offen offset:1024 lds
  s_mov_b32 m0, 0x1f400
  s_add_u32 s33, s77, 0x34000
  buffer_load_dwordx4 v8, s[60:63], s33 offen offset:0 lds
  buffer_load_dwordx4 v9, s[60:63], s33 offen offset:1024 lds
  s_waitcnt vmcnt(40)
  s_mov_b32 m0, 0x1fc00
  s_add_u32 s33, s78, 0x0
  buffer_load_dwordx4 v8, s[60:63], s33 offen offset:0 lds
  buffer_load_dwordx4 v9, s[60:63], s33 offen offset:1024 lds
  buffer_load_dwordx4 v10, s[60:63], s33 offen offset:2048 lds
  buffer_load_dwordx4 v11, s[60:63], s33 offen offset:3072 lds
  s_waitcnt vmcnt(40)
  s_mov_b32 m0, 0x20c00
  s_add_u32 s33, s78, 0x8000
  buffer_load_dwordx4 v8, s[60:63], s33 offen offset:0 lds
  buffer_load_dwordx4 v9, s[60:63], s33 offen offset:1024 lds
  buffer_load_dwordx4 v10, s[60:63], s33 offen offset:2048 lds
  buffer_load_dwordx4 v11, s[60:63], s33 offen offset:3072 lds
  s_waitcnt vmcnt(40)
  s_mov_b32 m0, 0x21c00
  s_add_u32 s33, s78, 0x10000
  buffer_load_dwordx4 v8, s[60:63], s33 offen offset:0 lds
  buffer_load_dwordx4 v9, s[60:63], s33 offen offset:1024 lds
  buffer_load_dwordx4 v10, s[60:63], s33 offen offset:2048 lds
  buffer_load_dwordx4 v11, s[60:63], s33 offen offset:3072 lds
  s_waitcnt vmcnt(40)
  s_mov_b32 m0, 0x22c00
  s_add_u32 s33, s78, 0x1c000
  buffer_load_dwordx4 v8, s[60:63], s33 offen offset:0 lds
  buffer_load_dwordx4 v9, s[60:63], s33 offen offset:1024 lds
  buffer_load_dwordx4 v10, s[60:63], s33 offen offset:2048 lds
  buffer_load_dwordx4 v11, s[60:63], s33 offen offset:3072 lds
  s_waitcnt vmcnt(40)
  s_mov_b32 m0, 0x23c00
  s_add_u32 s33, s78, 0x24000
  buffer_load_dwordx4 v8, s[60:63], s33 offen offset:0 lds
  buffer_load_dwordx4 v9, s[60:63], s33 offen offset:1024 lds
  buffer_load_dwordx4 v10, s[60:63], s33 offen offset:2048 lds
  buffer_load_dwordx4 v11, s[60:63], s33 offen offset:3072 lds
  s_waitcnt vmcnt(40)
  s_mov_b32 m0, 0x24c00
  s_add_u32 s33, s78, 0x2c000
  buffer_load_dwordx4 v8, s[60:63], s33 offen offset:0 lds
  buffer_load_dwordx4 v9, s[60:63], s33 offen offset:1024 lds
  buffer_load_dwordx4 v10, s[60:63], s33 offen offset:2048 lds
  buffer_load_dwordx4 v11, s[60:63], s33 offen offset:3072 lds
  s_waitcnt vmcnt(40)
  s_mov_b32 m0, 0x25c00
  s_add_u32 s33, s78, 0x18000
  buffer_load_dwordx4 v8, s[60:63], s33 offen offset:0 lds
  buffer_load_dwordx4 v9, s[60:63], s33 offen offset:1024 lds
  s_mov_b32 m0, 0x26400
  s_add_u32 s33, s78, 0x34000
  buffer_load_dwordx4 v8, s[60:63], s33 offen offset:0 lds
  buffer_load_dwordx4 v9, s[60:63], s33 offen offset:1024 lds
  s_waitcnt vmcnt(40)
  s_barrier
  s_mov_b32 m0, 0x10000
  s_add_u32 s33, s79, 0x0
  buffer_load_dwordx4 v8, s[60:63], s33 offen offset:0 lds
  buffer_load_dwordx4 v9, s[60:63], s33 offen offset:1024 lds
  buffer_load_dwordx4 v10, s[60:63], s33 offen offset:2048 lds
  buffer_load_dwordx4 v11, s[60:63], s33 offen offset:3072 lds
  s_waitcnt vmcnt(40)
  s_barrier
  s_barrier
  s_mov_b32 m0, 0x11000
  s_add_u32 s33, s79, 0x8000
  buffer_load_dwordx4 v8, s[60:63], s33 offen offset:0 lds
  buffer_load_dwordx4 v9, s[60:63], s33 offen offset:1024 lds
  buffer_load_dwordx4 v10, s[60:63], s33 offen offset:2048 lds
  buffer_load_dwordx4 v11, s[60:63], s33 offen offset:3072 lds
  s_waitcnt vmcnt(40)
  s_mov_b32 m0, 0x12000
  s_add_u32 s33, s79, 0x10000
  buffer_load_dwordx4 v8, s[60:63], s33 offen offset:0 lds
  buffer_load_dwordx4 v9, s[60:63], s33 offen offset:1024 lds
  buffer_load_dwordx4 v10, s[60:63], s33 offen offset:2048 lds
  buffer_load_dwordx4 v11, s[60:63], s33 offen offset:3072 lds
  s_waitcnt vmcnt(40)
  s_mov_b32 m0, 0x13000
  s_add_u32 s33, s79, 0x1c000
  buffer_load_dwordx4 v8, s[60:63], s33 offen offset:0 lds
  buffer_load_dwordx4 v9, s[60:63], s33 offen offset:1024 lds
  buffer_load_dwordx4 v10, s[60:63], s33 offen offset:2048 lds
  buffer_load_dwordx4 v11, s[60:63], s33 offen offset:3072 lds
  s_waitcnt vmcnt(40)
  s_mov_b32 m0, 0x14000
  s_add_u32 s33, s79, 0x24000
  buffer_load_dwordx4 v8, s[60:63], s33 offen offset:0 lds
  buffer_load_dwordx4 v9, s[60:63], s33 offen offset:1024 lds
  buffer_load_dwordx4 v10, s[60:63], s33 offen offset:2048 lds
  buffer_load_dwordx4 v11, s[60:63], s33 offen offset:3072 lds
  s_waitcnt vmcnt(40)
  s_barrier
  s_mov_b32 m0, 0x15000
  s_add_u32 s33, s79, 0x2c000
  buffer_load_dwordx4 v8, s[60:63], s33 offen offset:0 lds
  buffer_load_dwordx4 v9, s[60:63], s33 offen offset:1024 lds
  buffer_load_dwordx4 v10, s[60:63], s33 offen offset:2048 lds
  buffer_load_dwordx4 v11, s[60:63], s33 offen offset:3072 lds
  s_waitcnt vmcnt(40)
  s_mov_b32 m0, 0x16000
  s_add_u32 s33, s79, 0x18000
  buffer_load_dwordx4 v8, s[60:63], s33 offen offset:0 lds
  buffer_load_dwordx4 v9, s[60:63], s33 offen offset:1024 lds
  s_mov_b32 m0, 0x16800
  s_add_u32 s33, s79, 0x34000
  buffer_load_dwordx4 v8, s[60:63], s33 offen offset:0 lds
  buffer_load_dwordx4 v9, s[60:63], s33 offen offset:1024 lds
  s_waitcnt vmcnt(40)
  s_mov_b32 m0, 0x17000
  s_add_u32 s33, s80, 0x0
  buffer_load_dwordx4 v8, s[60:63], s33 offen offset:0 lds
  buffer_load_dwordx4 v9, s[60:63], s33 offen offset:1024 lds
  buffer_load_dwordx4 v10, s[60:63], s33 offen offset:2048 lds
  buffer_load_dwordx4 v11, s[60:63], s33 offen offset:3072 lds
  s_waitcnt vmcnt(40)
  s_mov_b32 m0, 0x18000
  s_add_u32 s33, s80, 0x8000
  buffer_load_dwordx4 v8, s[60:63], s33 offen offset:0 lds
  buffer_load_dwordx4 v9, s[60:63], s33 offen offset:1024 lds
  buffer_load_dwordx4 v10, s[60:63], s33 offen offset:2048 lds
  buffer_load_dwordx4 v11, s[60:63], s33 offen offset:3072 lds
  s_waitcnt vmcnt(40)
  s_barrier
  s_mov_b32 m0, 0x19000
  s_add_u32 s33, s80, 0x10000
  buffer_load_dwordx4 v8, s[60:63], s33 offen offset:0 lds
  buffer_load_dwordx4 v9, s[60:63], s33 offen offset:1024 lds
  buffer_load_dwordx4 v10, s[60:63], s33 offen offset:2048 lds
  buffer_load_dwordx4 v11, s[60:63], s33 offen offset:3072 lds
  s_waitcnt vmcnt(40)
  s_mov_b32 m0, 0x1a000
  s_add_u32 s33, s80, 0x1c000
  buffer_load_dwordx4 v8, s[60:63], s33 offen offset:0 lds
  buffer_load_dwordx4 v9, s[60:63], s33 offen offset:1024 lds
  buffer_load_dwordx4 v10, s[60:63], s33 offen offset:2048 lds
  buffer_load_dwordx4 v11, s[60:63], s33 offen offset:3072 lds
  s_waitcnt vmcnt(40)
  s_mov_b32 m0, 0x1b000
  s_add_u32 s33, s80, 0x24000
  buffer_load_dwordx4 v8, s[60:63], s33 offen offset:0 lds
  buffer_load_dwordx4 v9, s[60:63], s33 offen offset:1024 lds
  buffer_load_dwordx4 v10, s[60:63], s33 offen offset:2048 lds
  buffer_load_dwordx4 v11, s[60:63], s33 offen offset:3072 lds
  s_waitcnt vmcnt(40)
  s_mov_b32 m0, 0x1c000
  s_add_u32 s33, s80, 0x2c000
  buffer_load_dwordx4 v8, s[60:63], s33 offen offset:0 lds
  buffer_load_dwordx4 v9, s[60:63], s33 offen offset:1024 lds
  buffer_load_dwordx4 v10, s[60:63], s33 offen offset:2048 lds
  buffer_load_dwordx4 v11, s[60:63], s33 offen offset:3072 lds
  s_waitcnt vmcnt(40)
  s_barrier
  s_mov_b32 m0, 0x1d000
  s_add_u32 s33, s80, 0x18000
  buffer_load_dwordx4 v8, s[60:63], s33 offen offset:0 lds
  buffer_load_dwordx4 v9, s[60:63], s33 offen offset:1024 lds
  s_mov_b32 m0, 0x1d800
  s_add_u32 s33, s80, 0x34000
  buffer_load_dwordx4 v8, s[60:63], s33 offen offset:0 lds
  buffer_load_dwordx4 v9, s[60:63], s33 offen offset:1024 lds
  s_waitcnt vmcnt(40)
  s_mov_b32 m0, 0x1e000
  s_add_u32 s33, s81, 0x0
  buffer_load_dwordx4 v8, s[60:63], s33 offen offset:0 lds
  buffer_load_dwordx4 v9, s[60:63], s33 offen offset:1024 lds
  buffer_load_dwordx4 v10, s[60:63], s33 offen offset:2048 lds
  buffer_load_dwordx4 v11, s[60:63], s33 offen offset:3072 lds
  s_waitcnt vmcnt(40)
  s_mov_b32 m0, 0x1f000
  s_add_u32 s33, s81, 0x8000
  buffer_load_dwordx4 v8, s[60:63], s33 offen offset:0 lds
  buffer_load_dwordx4 v9, s[60:63], s33 offen offset:1024 lds
  buffer_load_dwordx4 v10, s[60:63], s33 offen offset:2048 lds
  buffer_load_dwordx4 v11, s[60:63], s33 offen offset:3072 lds
  s_waitcnt vmcnt(40)
  s_mov_b32 m0, 0x20000
  s_add_u32 s33, s81, 0x10000
  buffer_load_dwordx4 v8, s[60:63], s33 offen offset:0 lds
  buffer_load_dwordx4 v9, s[60:63], s33 offen offset:1024 lds
  buffer_load_dwordx4 v10, s[60:63], s33 offen offset:2048 lds
  buffer_load_dwordx4 v11, s[60:63], s33 offen offset:3072 lds
  s_waitcnt vmcnt(40)
  s_barrier
  s_mov_b32 m0, 0x21000
  s_add_u32 s33, s81, 0x1c000
  buffer_load_dwordx4 v8, s[60:63], s33 offen offset:0 lds
  buffer_load_dwordx4 v9, s[60:63], s33 offen offset:1024 lds
  buffer_load_dwordx4 v10, s[60:63], s33 offen offset:2048 lds
  buffer_load_dwordx4 v11, s[60:63], s33 offen offset:3072 lds
  s_waitcnt vmcnt(40)
  s_mov_b32 m0, 0x22000
  s_add_u32 s33, s81, 0x24000
  buffer_load_dwordx4 v8, s[60:63], s33 offen offset:0 lds
  buffer_load_dwordx4 v9, s[60:63], s33 offen offset:1024 lds
  buffer_load_dwordx4 v10, s[60:63], s33 offen offset:2048 lds
  buffer_load_dwordx4 v11, s[60:63], s33 offen offset:3072 lds
  s_waitcnt vmcnt(40)
  s_mov_b32 m0, 0x23000
  s_add_u32 s33, s81, 0x2c000
  buffer_load_dwordx4 v8, s[60:63], s33 offen offset:0 lds
  buffer_load_dwordx4 v9, s[60:63], s33 offen offset:1024 lds
  buffer_load_dwordx4 v10, s[60:63], s33 offen offset:2048 lds
  buffer_load_dwordx4 v11, s[60:63], s33 offen offset:3072 lds
  s_waitcnt vmcnt(40)
  s_mov_b32 m0, 0x24000
  s_add_u32 s33, s81, 0x18000
  buffer_load_dwordx4 v8, s[60:63], s33 offen offset:0 lds
  buffer_load_dwordx4 v9, s[60:63], s33 offen offset:1024 lds
  s_mov_b32 m0, 0x24800
  s_add_u32 s33, s81, 0x34000
  buffer_load_dwordx4 v8, s[60:63], s33 offen offset:0 lds
  buffer_load_dwordx4 v9, s[60:63], s33 offen offset:1024 lds
  s_waitcnt vmcnt(40)
  s_barrier
  s_mov_b32 m0, 0x25000
  s_add_u32 s33, s82, 0x0
  buffer_load_dwordx4 v8, s[60:63], s33 offen offset:0 lds
  buffer_load_dwordx4 v9, s[60:63], s33 offen offset:1024 lds
  buffer_load_dwordx4 v10, s[60:63], s33 offen offset:2048 lds
  buffer_load_dwordx4 v11, s[60:63], s33 offen offset:3072 lds
  s_waitcnt vmcnt(40)
  s_mov_b32 m0, 0x10000
  s_add_u32 s33, s82, 0x8000
  buffer_load_dwordx4 v8, s[60:63], s33 offen offset:0 lds
  buffer_load_dwordx4 v9, s[60:63], s33 offen offset:1024 lds
  buffer_load_dwordx4 v10, s[60:63], s33 offen offset:2048 lds
  buffer_load_dwordx4 v11, s[60:63], s33 offen offset:3072 lds
  s_waitcnt vmcnt(40)
  s_mov_b32 m0, 0x11000
  s_add_u32 s33, s82, 0x10000
  buffer_load_dwordx4 v8, s[60:63], s33 offen offset:0 lds
  buffer_load_dwordx4 v9, s[60:63], s33 offen offset:1024 lds
  buffer_load_dwordx4 v10, s[60:63], s33 offen offset:2048 lds
  buffer_load_dwordx4 v11, s[60:63], s33 offen offset:3072 lds
  s_waitcnt vmcnt(40)
  s_mov_b32 m0, 0x12000
  s_add_u32 s33, s82, 0x1c000
  buffer_load_dwordx4 v8, s[60:63], s33 offen offset:0 lds
  buffer_load_dwordx4 v9, s[60:63], s33 offen offset:1024 lds
  buffer_load_dwordx4 v10, s[60:63], s33 offen offset:2048 lds
  buffer_load_dwordx4 v11, s[60:63], s33 offen offset:3072 lds
  s_waitcnt vmcnt(40)
  s_barrier
  s_mov_b32 m0, 0x13000
  s_add_u32 s33, s82, 0x24000
  buffer_load_dwordx4 v8, s[60:63], s33 offen offset:0 lds
  buffer_load_dwordx4 v9, s[60:63], s33 offen offset:1024 lds
  buffer_load_dwordx4 v10, s[60:63], s33 offen offset:2048 lds
  buffer_load_dwordx4 v11, s[60:63], s33 offen offset:3072 lds
  s_waitcnt vmcnt(40)
  s_mov_b32 m0, 0x14000
  s_add_u32 s33, s82, 0x2c000
  buffer_load_dwordx4 v8, s[60:63], s33 offen offset:0 lds
  buffer_load_dwordx4 v9, s[60:63], s33 offen offset:1024 lds
  buffer_load_dwordx4 v10, s[60:63], s33 offen offset:2048 lds
  buffer_load_dwordx4 v11, s[60:63], s33 offen offset:3072 lds
  s_waitcnt vmcnt(40)
  s_mov_b32 m0, 0x15000
  s_add_u32 s33, s82, 0x18000
  buffer_load_dwordx4 v8, s[60:63], s33 offen offset:0 lds
  buffer_load_dwordx4 v9, s[60:63], s33 offen offset:1024 lds
  s_mov_b32 m0, 0x15800
  s_add_u32 s33, s82, 0x34000
  buffer_load_dwordx4 v8, s[60:63], s33 offen offset:0 lds
  buffer_load_dwordx4 v9, s[60:63], s33 offen offset:1024 lds
  s_waitcnt vmcnt(40)
  s_mov_b32 m0, 0x16000
  s_add_u32 s33, s83, 0x0
  buffer_load_dwordx4 v8, s[60:63], s33 offen offset:0 lds
  buffer_load_dwordx4 v9, s[60:63], s33 offen offset:1024 lds
  buffer_load_dwordx4 v10, s[60:63], s33 offen offset:2048 lds
  buffer_load_dwordx4 v11, s[60:63], s33 offen offset:3072 lds
  s_waitcnt vmcnt(40)
  s_barrier
  s_mov_b32 m0, 0x17000
  s_add_u32 s33, s83, 0x8000
  buffer_load_dwordx4 v8, s[60:63], s33 offen offset:0 lds
  buffer_load_dwordx4 v9, s[60:63], s33 offen offset:1024 lds
  buffer_load_dwordx4 v10, s[60:63], s33 offen offset:2048 lds
  buffer_load_dwordx4 v11, s[60:63], s33 offen offset:3072 lds
  s_waitcnt vmcnt(40)
  s_mov_b32 m0, 0x18000
  s_add_u32 s33, s83, 0x10000
  buffer_load_dwordx4 v8, s[60:63], s33 offen offset:0 lds
  buffer_load_dwordx4 v9, s[60:63], s33 offen offset:1024 lds
  buffer_load_dwordx4 v10, s[60:63], s33 offen offset:2048 lds
  buffer_load_dwordx4 v11, s[60:63], s33 offen offset:3072 lds
  s_waitcnt vmcnt(40)
  s_mov_b32 m0, 0x19000
  s_add_u32 s33, s83, 0x1c000
  buffer_load_dwordx4 v8, s[60:63], s33 offen offset:0 lds
  buffer_load_dwordx4 v9, s[60:63], s33 offen offset:1024 lds
  buffer_load_dwordx4 v10, s[60:63], s33 offen offset:2048 lds
  buffer_load_dwordx4 v11, s[60:63], s33 offen offset:3072 lds
  s_waitcnt vmcnt(40)
  s_mov_b32 m0, 0x1a000
  s_add_u32 s33, s83, 0x24000
  buffer_load_dwordx4 v8, s[60:63], s33 offen offset:0 lds
  buffer_load_dwordx4 v9, s[60:63], s33 offen offset:1024 lds
  buffer_load_dwordx4 v10, s[60:63], s33 offen offset:2048 lds
  buffer_load_dwordx4 v11, s[60:63], s33 offen offset:3072 lds
  s_waitcnt vmcnt(40)
  s_barrier
  s_mov_b32 m0, 0x1b000
  s_add_u32 s33, s83, 0x2c000
  buffer_load_dwordx4 v8, s[60:63], s33 offen offset:0 lds
  buffer_load_dwordx4 v9, s[60:63], s33 offen offset:1024 lds
  buffer_load_dwordx4 v10, s[60:63], s33 offen offset:2048 lds
  buffer_load_dwordx4 v11, s[60:63], s33 offen offset:3072 lds
  s_waitcnt vmcnt(40)
  s_mov_b32 m0, 0x1c000
  s_add_u32 s33, s83, 0x18000
  buffer_load_dwordx4 v8, s[60:63], s33 offen offset:0 lds
  buffer_load_dwordx4 v9, s[60:63], s33 offen offset:1024 lds
  s_mov_b32 m0, 0x1c800
  s_add_u32 s33, s83, 0x34000
  buffer_load_dwordx4 v8, s[60:63], s33 offen offset:0 lds
  buffer_load_dwordx4 v9, s[60:63], s33 offen offset:1024 lds
  s_waitcnt vmcnt(40)
  s_waitcnt vmcnt(32)
  s_barrier
  s_waitcnt vmcnt(16)
  s_barrier
  s_waitcnt vmcnt(0)
  s_barrier
  s_barrier
  s_waitcnt vmcnt(0)
  s_endpgm
L_TOUCHER:
  s_mov_b32 s40, s68
  s_mov_b32 s41, s69
  s_mov_b32 s42, 0x80000
  s_mov_b32 s43, 0x20000
  s_mov_b32 s44, s72
  s_mov_b32 s45, s73
  s_mov_b32 s46, 0x80000
  s_mov_b32 s47, 0x20000
  s_mov_b32 s48, s74
  s_mov_b32 s49, s75
  s_mov_b32 s50, 0x80000
  s_mov_b32 s51, 0x20000
  s_mov_b32 s52, s76
  s_mov_b32 s53, s77
  s_mov_b32 s54, 0x1c0000
  s_mov_b32 s55, 0x20000
  s_mov_b32 s56, s78
  s_mov_b32 s57, s79
  s_mov_b32 s58, 0x1c0000
  s_mov_b32 s59, 0x20000
  v_lshrrev_b32 v2, 4, v0
  v_and_b32 v3, 15, v0
  v_add_u32 v40, 0, v2
  v_xor_b32 v40, v40, v3
  v_lshlrev_b32 v40, 4, v40
  v_lshl_add_u32 v40, v2, 10, v40
  v_add_u32 v41, 4, v2
  v_xor_b32 v41, v41, v3
  v_lshlrev_b32 v41, 4, v41
  v_lshl_add_u32 v41, v2, 10, v41
  v_add_u32 v42, 8, v2
  v_xor_b32 v42, v42, v3
  v_lshlrev_b32 v42, 4, v42
  v_lshl_add_u32 v42, v2, 10, v42
  v_add_u32 v43, 12, v2
  v_xor_b32 v43, v43, v3
  v_lshlrev_b32 v43, 4, v43
  v_lshl_add_u32 v43, v2, 10, v43
  s_lshl_b32 s33, s20, 8
  s_lshl_b32 s34, s25, 7
  s_add_u32 s33, s33, s34
  s_lshl_b32 s82, s33, 10
  s_lshl_b32 s83, s25, 1
  s_add_u32 s83, s83, s26
  s_and_b32 s83, s83, 3
  s_lshr_b32 s81, s26, 2
  s_lshl_b32 s81, s81, 13
  s_xor_b32 s33, s83, 0
  s_lshl_b32 s33, s33, 8
  s_add_u32 s33, s33, s82
  s_mov_b32 s34, s81
  s_mov_b32 s36, 8
XC_60:
  s_add_u32 m0, s34, 0x0
  s_lshl_b32 s35, s34, 2
  s_add_u32 s35, s35, s33
  buffer_load_dwordx4 v40, s[8:11], s35 offen lds
  s_add_u32 s34, s34, 1024
  s_add_u32 m0, s34, 0x0
  s_lshl_b32 s35, s34, 2
  s_add_u32 s35, s35, s33
  buffer_load_dwordx4 v41, s[8:11], s35 offen lds
  s_add_u32 s34, s34, 1024
  s_add_u32 m0, s34, 0x0
  s_lshl_b32 s35, s34, 2
  s_add_u32 s35, s35, s33
  buffer_load_dwordx4 v42, s[8:11], s35 offen lds
  s_add_u32 s34, s34, 1024
  s_add_u32 m0, s34, 0x0
  s_lshl_b32 s35, s34, 2
  s_add_u32 s35, s35, s33
  buffer_load_dwordx4 v43, s[8:11], s35 offen lds
  s_add_u32 s34, s34, 1024
  s_and_b32 s34, s34, 0x7fff
  s_sub_u32 s36, s36, 1
  s_cmp_lg_u32 s36, 0
  s_cbranch_scc1 XC_60
  s_xor_b32 s33, s83, 1
  s_lshl_b32 s33, s33, 8
  s_add_u32 s33, s33, s82
  s_mov_b32 s34, s81
  s_mov_b32 s36, 4
XC_61:
  s_add_u32 m0, s34, 0x8000
  s_lshl_b32 s35, s34, 2
  s_add_u32 s35, s35, s33
  buffer_load_dwordx4 v40, s[8:11], s35 offen lds
  s_add_u32 s34, s34, 1024
  s_add_u32 m0, s34, 0x8000
  s_lshl_b32 s35, s34, 2
  s_add_u32 s35, s35, s33
  buffer_load_dwordx4 v41, s[8:11], s35 offen lds
  s_add_u32 s34, s34, 1024
  s_add_u32 m0, s34, 0x8000
  s_lshl_b32 s35, s34, 2
  s_add_u32 s35, s35, s33
  buffer_load_dwordx4 v42, s[8:11], s35 offen lds
  s_add_u32 s34, s34, 1024
  s_add_u32 m0, s34, 0x8000
  s_lshl_b32 s35, s34, 2
  s_add_u32 s35, s35, s33
  buffer_load_dwordx4 v43, s[8:11], s35 offen lds
  s_add_u32 s34, s34, 1024
  s_and_b32 s34, s34, 0x7fff
  s_sub_u32 s36, s36, 1
  s_cmp_lg_u32 s36, 0
  s_cbranch_scc1 XC_61
  v_lshlrev_b32 v1, 7, v0
  v_lshlrev_b32 v24, 4, v0
  v_lshlrev_b32 v31, 4, v0
  s_lshl_b32 s33, s20, 4
  s_lshl_b32 s34, s23, 2
  s_add_u32 s33, s33, s34
  s_lshl_b32 s34, s33, 14
  v_add_u32 v3, s34, v24
  s_mul_i32 s34, s33, 57344
  v_add_u32 v4, s34, v24
  s_and_b32 s64, s23, 3
  s_xor_b32 s64, s64, 0
  s_lshl_b32 s64, s64, 12
  s_and_b32 s65, s23, 3
  s_xor_b32 s65, s65, 1
  s_lshl_b32 s65, s65, 12
  s_and_b32 s66, s23, 3
  s_xor_b32 s66, s66, 2
  s_lshl_b32 s66, s66, 12
  s_and_b32 s67, s23, 3
  s_xor_b32 s67, s67, 3
  s_lshl_b32 s67, s67, 12
  s_and_b32 s68, s23, 3
  s_lshl_b32 s68, s68, 1
  s_xor_b32 s68, s68, 0
  s_mul_i32 s68, s68, 7168
  s_and_b32 s69, s23, 3
  s_lshl_b32 s69, s69, 1
  s_xor_b32 s69, s69, 1
  s_mul_i32 s69, s69, 7168
  s_and_b32 s70, s23, 3
  s_lshl_b32 s70, s70, 1
  s_xor_b32 s70, s70, 2
  s_mul_i32 s70, s70, 7168
  s_and_b32 s71, s23, 3
  s_lshl_b32 s71, s71, 1
  s_xor_b32 s71, s71, 3
  s_mul_i32 s71, s71, 7168
  s_and_b32 s72, s23, 3
  s_lshl_b32 s72, s72, 1
  s_xor_b32 s72, s72, 4
  s_mul_i32 s72, s72, 7168
  s_and_b32 s73, s23, 3
  s_lshl_b32 s73, s73, 1
  s_xor_b32 s73, s73, 5
  s_mul_i32 s73, s73, 7168
  s_and_b32 s74, s23, 3
  s_lshl_b32 s74, s74, 1
  s_xor_b32 s74, s74, 6
  s_mul_i32 s74, s74, 7168
  s_and_b32 s75, s23, 3
  s_lshl_b32 s75, s75, 1
  s_xor_b32 s75, s75, 7
  s_mul_i32 s75, s75, 7168
  v_and_b32 v25, 15, v0
  v_and_b32 v26, 0x30, v0
  s_mul_i32 s36, s20, 18
  s_lshl_b32 s37, s20, 8
  s_lshr_b32 s38, s64, 12
  s_lshr_b32 s79, s38, 1
  s_add_u32 s79, s79, 1
  s_sub_u32 s80, 0, s79
  s_bitcmp1_b32 s38, 0
  s_cselect_b32 s79, s79, s80
  s_lshl_b32 s35, s23, 6
  s_add_u32 s35, s35, s79
  s_add_u32 s35, s35, 16
  s_add_u32 s38, s35, 0
  v_add_u32 v8, s38, v25
  v_lshrrev_b32 v27, 4, v8
  v_add_u32 v27, s36, v27
  v_lshlrev_b32 v27, 14, v27
  v_and_b32 v28, 15, v8
  v_add_u32 v28, v26, v28
  v_lshl_add_u32 v27, v28, 4, v27
  v_add_u32 v28, s37, v8
  v_subrev_u32 v28, 16, v28
  v_cmp_gt_u32 vcc, 0x800, v28
  v_mov_b32 v8, 0x80000000
  s_nop 0
  v_cndmask_b32 v8, v8, v27, vcc
  s_add_u32 s38, s35, 16
  v_add_u32 v9, s38, v25
  v_lshrrev_b32 v27, 4, v9
  v_add_u32 v27, s36, v27
  v_lshlrev_b32 v27, 14, v27
  v_and_b32 v28, 15, v9
  v_add_u32 v28, v26, v28
  v_lshl_add_u32 v27, v28, 4, v27
  v_add_u32 v28, s37, v9
  v_subrev_u32 v28, 16, v28
  v_cmp_gt_u32 vcc, 0x800, v28
  v_mov_b32 v9, 0x80000000
  s_nop 0
  v_cndmask_b32 v9, v9, v27, vcc
  s_add_u32 s38, s35, 32
  v_add_u32 v10, s38, v25
  v_lshrrev_b32 v27, 4, v10
  v_add_u32 v27, s36, v27
  v_lshlrev_b32 v27, 14, v27
  v_and_b32 v28, 15, v10
  v_add_u32 v28, v26, v28
  v_lshl_add_u32 v27, v28, 4, v27
  v_add_u32 v28, s37, v10
  v_subrev_u32 v28, 16, v28
  v_cmp_gt_u32 vcc, 0x800, v28
  v_mov_b32 v10, 0x80000000
  s_nop 0
  v_cndmask_b32 v10, v10, v27, vcc
  s_add_u32 s38, s35, 48
  v_add_u32 v11, s38, v25
  v_lshrrev_b32 v27, 4, v11
  v_add_u32 v27, s36, v27
  v_lshlrev_b32 v27, 14, v27
  v_and_b32 v28, 15, v11
  v_add_u32 v28, v26, v28
  v_lshl_add_u32 v27, v28, 4, v27
  v_add_u32 v28, s37, v11
  v_subrev_u32 v28, 16, v28
  v_cmp_gt_u32 vcc, 0x800, v28
  v_mov_b32 v11, 0x80000000
  s_nop 0
  v_cndmask_b32 v11, v11, v27, vcc
  s_lshr_b32 s38, s65, 12
  s_lshr_b32 s79, s38, 1
  s_add_u32 s79, s79, 1
  s_sub_u32 s80, 0, s79
  s_bitcmp1_b32 s38, 0
  s_cselect_b32 s79, s79, s80
  s_lshl_b32 s35, s23, 6
  s_add_u32 s35, s35, s79
  s_add_u32 s35, s35, 16
  s_add_u32 s38, s35, 0
  v_add_u32 v12, s38, v25
  v_lshrrev_b32 v27, 4, v12
  v_add_u32 v27, s36, v27
  v_lshlrev_b32 v27, 14, v27
  v_and_b32 v28, 15, v12
  v_add_u32 v28, v26, v28
  v_lshl_add_u32 v27, v28, 4, v27
  v_add_u32 v28, s37, v12
  v_subrev_u32 v28, 16, v28
  v_cmp_gt_u32 vcc, 0x800, v28
  v_mov_b32 v12, 0x80000000
  s_nop 0
  v_cndmask_b32 v12, v12, v27, vcc
  s_add_u32 s38, s35, 16
  v_add_u32 v13, s38, v25
  v_lshrrev_b32 v27, 4, v13
  v_add_u32 v27, s36, v27
  v_lshlrev_b32 v27, 14, v27
  v_and_b32 v28, 15, v13
  v_add_u32 v28, v26, v28
  v_lshl_add_u32 v27, v28, 4, v27
  v_add_u32 v28, s37, v13
  v_subrev_u32 v28, 16, v28
  v_cmp_gt_u32 vcc, 0x800, v28
  v_mov_b32 v13, 0x80000000
  s_nop 0
  v_cndmask_b32 v13, v13, v27, vcc
  s_add_u32 s38, s35, 32
  v_add_u32 v14, s38, v25
  v_lshrrev_b32 v27, 4, v14
  v_add_u32 v27, s36, v27
  v_lshlrev_b32 v27, 14, v27
  v_and_b32 v28, 15, v14
  v_add_u32 v28, v26, v28
  v_lshl_add_u32 v27, v28, 4, v27
  v_add_u32 v28, s37, v14
  v_subrev_u32 v28, 16, v28
  v_cmp_gt_u32 vcc, 0x800, v28
  v_mov_b32 v14, 0x80000000
  s_nop 0
  v_cndmask_b32 v14, v14, v27, vcc
  s_add_u32 s38, s35, 48
  v_add_u32 v15, s38, v25
  v_lshrrev_b32 v27, 4, v15
  v_add_u32 v27, s36, v27
  v_lshlrev_b32 v27, 14, v27
  v_and_b32 v28, 15, v15
  v_add_u32 v28, v26, v28
  v_lshl_add_u32 v27, v28, 4, v27
  v_add_u32 v28, s37, v15
  v_subrev_u32 v28, 16, v28
  v_cmp_gt_u32 vcc, 0x800, v28
  v_mov_b32 v15, 0x80000000
  s_nop 0
  v_cndmask_b32 v15, v15, v27, vcc
  s_lshr_b32 s38, s66, 12
  s_lshr_b32 s79, s38, 1
  s_add_u32 s79, s79, 1
  s_sub_u32 s80, 0, s79
  s_bitcmp1_b32 s38, 0
  s_cselect_b32 s79, s79, s80
  s_lshl_b32 s35, s23, 6
  s_add_u32 s35, s35, s79
  s_add_u32 s35, s35, 16
  s_add_u32 s38, s35, 0
  v_add_u32 v16, s38, v25
  v_lshrrev_b32 v27, 4, v16
  v_add_u32 v27, s36, v27
  v_lshlrev_b32 v27, 14, v27
  v_and_b32 v28, 15, v16
  v_add_u32 v28, v26, v28
  v_lshl_add_u32 v27, v28, 4, v27
  v_add_u32 v28, s37, v16
  v_subrev_u32 v28, 16, v28
  v_cmp_gt_u32 vcc, 0x800, v28
  v_mov_b32 v16, 0x80000000
  s_nop 0
  v_cndmask_b32 v16, v16, v27, vcc
  s_add_u32 s38, s35, 16
  v_add_u32 v17, s38, v25
  v_lshrrev_b32 v27, 4, v17
  v_add_u32 v27, s36, v27
  v_lshlrev_b32 v27, 14, v27
  v_and_b32 v28, 15, v17
  v_add_u32 v28, v26, v28
  v_lshl_add_u32 v27, v28, 4, v27
  v_add_u32 v28, s37, v17
  v_subrev_u32 v28, 16, v28
  v_cmp_gt_u32 vcc, 0x800, v28
  v_mov_b32 v17, 0x80000000
  s_nop 0
  v_cndmask_b32 v17, v17, v27, vcc
  s_add_u32 s38, s35, 32
  v_add_u32 v18, s38, v25
  v_lshrrev_b32 v27, 4, v18
  v_add_u32 v27, s36, v27
  v_lshlrev_b32 v27, 14, v27
  v_and_b32 v28, 15, v18
  v_add_u32 v28, v26, v28
  v_lshl_add_u32 v27, v28, 4, v27
  v_add_u32 v28, s37, v18
  v_subrev_u32 v28, 16, v28
  v_cmp_gt_u32 vcc, 0x800, v28
  v_mov_b32 v18, 0x80000000
  s_nop 0
  v_cndmask_b32 v18, v18, v27, vcc
  s_add_u32 s38, s35, 48
  v_add_u32 v19, s38, v25
  v_lshrrev_b32 v27, 4, v19
  v_add_u32 v27, s36, v27
  v_lshlrev_b32 v27, 14, v27
  v_and_b32 v28, 15, v19
  v_add_u32 v28, v26, v28
  v_lshl_add_u32 v27, v28, 4, v27
  v_add_u32 v28, s37, v19
  v_subrev_u32 v28, 16, v28
  v_cmp_gt_u32 vcc, 0x800, v28
  v_mov_b32 v19, 0x80000000
  s_nop 0
  v_cndmask_b32 v19, v19, v27, vcc
  s_lshr_b32 s38, s67, 12
  s_lshr_b32 s79, s38, 1
  s_add_u32 s79, s79, 1
  s_sub_u32 s80, 0, s79
  s_bitcmp1_b32 s38, 0
  s_cselect_b32 s79, s79, s80
  s_lshl_b32 s35, s23, 6
  s_add_u32 s35, s35, s79
  s_add_u32 s35, s35, 16
  s_add_u32 s38, s35, 0
  v_add_u32 v20, s38, v25
  v_lshrrev_b32 v27, 4, v20
  v_add_u32 v27, s36, v27
  v_lshlrev_b32 v27, 14, v27
  v_and_b32 v28, 15, v20
  v_add_u32 v28, v26, v28
  v_lshl_add_u32 v27, v28, 4, v27
  v_add_u32 v28, s37, v20
  v_subrev_u32 v28, 16, v28
  v_cmp_gt_u32 vcc, 0x800, v28
  v_mov_b32 v20, 0x80000000
  s_nop 0
  v_cndmask_b32 v20, v20, v27, vcc
  s_add_u32 s38, s35, 16
  v_add_u32 v21, s38, v25
  v_lshrrev_b32 v27, 4, v21
  v_add_u32 v27, s36, v27
  v_lshlrev_b32 v27, 14, v27
  v_and_b32 v28, 15, v21
  v_add_u32 v28, v26, v28
  v_lshl_add_u32 v27, v28, 4, v27
  v_add_u32 v28, s37, v21
  v_subrev_u32 v28, 16, v28
  v_cmp_gt_u32 vcc, 0x800, v28
  v_mov_b32 v21, 0x80000000
  s_nop 0
  v_cndmask_b32 v21, v21, v27, vcc
  s_add_u32 s38, s35, 32
  v_add_u32 v22, s38, v25
  v_lshrrev_b32 v27, 4, v22
  v_add_u32 v27, s36, v27
  v_lshlrev_b32 v27, 14, v27
  v_and_b32 v28, 15, v22
  v_add_u32 v28, v26, v28
  v_lshl_add_u32 v27, v28, 4, v27
  v_add_u32 v28, s37, v22
  v_subrev_u32 v28, 16, v28
  v_cmp_gt_u32 vcc, 0x800, v28
  v_mov_b32 v22, 0x80000000
  s_nop 0
  v_cndmask_b32 v22, v22, v27, vcc
  s_add_u32 s38, s35, 48
  v_add_u32 v23, s38, v25
  v_lshrrev_b32 v27, 4, v23
  v_add_u32 v27, s36, v27
  v_lshlrev_b32 v27, 14, v27
  v_and_b32 v28, 15, v23
  v_add_u32 v28, v26, v28
  v_lshl_add_u32 v27, v28, 4, v27
  v_add_u32 v28, s37, v23
  v_subrev_u32 v28, 16, v28
  v_cmp_gt_u32 vcc, 0x800, v28
  v_mov_b32 v23, 0x80000000
  s_nop 0
  v_cndmask_b32 v23, v23, v27, vcc
  s_lshl_b32 s35, s20, 9
  s_add_u32 s35, s35, 0xf00000
  v_bfe_u32 v25, v0, 3, 2
  v_lshlrev_b32 v25, 7, v25
  v_and_b32 v26, 7, v0
  v_lshl_add_u32 v25, v26, 2, v25
  s_lshl_b32 s36, s23, 5
  s_add_u32 s36, s36, s35
  v_add_u32 v5, s36, v25
  s_and_b32 s36, s23, 1
  s_lshl_b32 s36, s36, 8
  s_add_u32 s36, s36, s35
  s_lshr_b32 s37, s23, 1
  s_lshl_b32 s37, s37, 6
  s_add_u32 s36, s36, s37
  v_bfe_u32 v26, v0, 4, 1
  v_lshlrev_b32 v26, 7, v26
  v_and_b32 v27, 15, v0
  v_lshl_add_u32 v26, v27, 2, v26
  v_add_u32 v6, s36, v26
  s_lshl_b32 s36, s21, 2
  s_add_u32 s36, s36, s35
  v_and_b32 v26, 3, v0
  v_lshlrev_b32 v26, 7, v26
  v_add_u32 v26, s36, v26
  v_cmp_lt_u32 vcc, 31, v0
  s_nop 1
  v_cndmask_b32 v6, v6, v26, vcc
  s_waitcnt lgkmcnt(0)
  s_mul_i32 s31, s3, 0x9e3779b1
  s_add_u32 s31, s31, 0x7f4a7c15
  s_and_b32 s31, s31, 0xffffff00
  s_lshl_b32 s76, s20, 1
  s_add_u32 s76, s76, 1
  s_lshl_b32 s76, s76, 14
  s_waitcnt vmcnt(16)
  s_barrier
  s_xor_b32 s33, s83, 1
  s_lshl_b32 s33, s33, 8
  s_add_u32 s33, s33, s82
  s_add_u32 s34, s81, 16384
  s_and_b32 s34, s34, 0x7fff
  s_mov_b32 s36, 4
XC_62:
  s_add_u32 m0, s34, 0x8000
  s_lshl_b32 s35, s34, 2
  s_add_u32 s35, s35, s33
  buffer_load_dwordx4 v40, s[8:11], s35 offen lds
  s_add_u32 s34, s34, 1024
  s_add_u32 m0, s34, 0x8000
  s_lshl_b32 s35, s34, 2
  s_add_u32 s35, s35, s33
  buffer_load_dwordx4 v41, s[8:11], s35 offen lds
  s_add_u32 s34, s34, 1024
  s_add_u32 m0, s34, 0x8000
  s_lshl_b32 s35, s34, 2
  s_add_u32 s35, s35, s33
  buffer_load_dwordx4 v42, s[8:11], s35 offen lds
  s_add_u32 s34, s34, 1024
  s_add_u32 m0, s34, 0x8000
  s_lshl_b32 s35, s34, 2
  s_add_u32 s35, s35, s33
  buffer_load_dwordx4 v43, s[8:11], s35 offen lds
  s_add_u32 s34, s34, 1024
  s_and_b32 s34, s34, 0x7fff
  s_sub_u32 s36, s36, 1
  s_cmp_lg_u32 s36, 0
  s_cbranch_scc1 XC_62
  s_waitcnt vmcnt(0)
  s_barrier
  s_xor_b32 s33, s83, 2
  s_lshl_b32 s33, s33, 8
  s_add_u32 s33, s33, s82
  s_mov_b32 s34, s81
  s_mov_b32 s36, 8
XC_63:
  s_add_u32 m0, s34, 0x0
  s_lshl_b32 s35, s34, 2
  s_add_u32 s35, s35, s33
  buffer_load_dwordx4 v40, s[8:11], s35 offen lds
  s_add_u32 s34, s34, 1024
  s_add_u32 m0, s34, 0x0
  s_lshl_b32 s35, s34, 2
  s_add_u32 s35, s35, s33
  buffer_load_dwordx4 v41, s[8:11], s35 offen lds
  s_add_u32 s34, s34, 1024
  s_add_u32 m0, s34, 0x0
  s_lshl_b32 s35, s34, 2
  s_add_u32 s35, s35, s33
  buffer_load_dwordx4 v42, s[8:11], s35 offen lds
  s_add_u32 s34, s34, 1024
  s_add_u32 m0, s34, 0x0
  s_lshl_b32 s35, s34, 2
  s_add_u32 s35, s35, s33
  buffer_load_dwordx4 v43, s[8:11], s35 offen lds
  s_add_u32 s34, s34, 1024
  s_and_b32 s34, s34, 0x7fff
  s_sub_u32 s36, s36, 1
  s_cmp_lg_u32 s36, 0
  s_cbranch_scc1 XC_63
  s_waitcnt vmcnt(0)
  s_barrier
  s_xor_b32 s33, s83, 3
  s_lshl_b32 s33, s33, 8
  s_add_u32 s33, s33, s82
  s_mov_b32 s34, s81
  s_mov_b32 s36, 8
XC_64:
  s_add_u32 m0, s34, 0x8000
  s_lshl_b32 s35, s34, 2
  s_add_u32 s35, s35, s33
  buffer_load_dwordx4 v40, s[8:11], s35 offen lds
  s_add_u32 s34, s34, 1024
  s_add_u32 m0, s34, 0x8000
  s_lshl_b32 s35, s34, 2
  s_add_u32 s35, s35, s33
  buffer_load_dwordx4 v41, s[8:11], s35 offen lds
  s_add_u32 s34, s34, 1024
  s_add_u32 m0, s34, 0x8000
  s_lshl_b32 s35, s34, 2
  s_add_u32 s35, s35, s33
  buffer_load_dwordx4 v42, s[8:11], s35 offen lds
  s_add_u32 s34, s34, 1024
  s_add_u32 m0, s34, 0x8000
  s_lshl_b32 s35, s34, 2
  s_add_u32 s35, s35, s33
  buffer_load_dwordx4 v43, s[8:11], s35 offen lds
  s_add_u32 s34, s34, 1024
  s_and_b32 s34, s34, 0x7fff
  s_sub_u32 s36, s36, 1
  s_cmp_lg_u32 s36, 0
  s_cbranch_scc1 XC_64
  s_waitcnt vmcnt(0)
  s_barrier
  v_lshrrev_b32 v2, 3, v0
  v_lshlrev_b32 v2, 10, v2
  v_and_b32 v30, 7, v0
  v_lshl_add_u32 v2, v30, 4, v2
  s_lshl_b32 s33, s20, 8
  s_lshl_b32 s34, s23, 6
  s_add_u32 s33, s33, s34
  s_lshl_b32 s33, s33, 10
  s_lshl_b32 s34, s24, 7
  s_add_u32 s33, s33, s34
  s_mov_b32 m0, 0x0
  s_nop 0
  buffer_load_dwordx4 v2, s[8:11], s33 offen lds
  s_mov_b32 m0, 0x400
  s_add_u32 s33, s33, 8192
  buffer_load_dwordx4 v2, s[8:11], s33 offen lds
  s_mov_b32 m0, 0x800
  s_add_u32 s33, s33, 8192
  buffer_load_dwordx4 v2, s[8:11], s33 offen lds
  s_mov_b32 m0, 0xc00
  s_add_u32 s33, s33, 8192
  buffer_load_dwordx4 v2, s[8:11], s33 offen lds
  s_mov_b32 m0, 0x1000
  s_add_u32 s33, s33, 8192
  buffer_load_dwordx4 v2, s[8:11], s33 offen lds
  s_mov_b32 m0, 0x1400
  s_add_u32 s33, s33, 8192
  buffer_load_dwordx4 v2, s[8:11], s33 offen lds
  s_mov_b32 m0, 0x1800
  s_add_u32 s33, s33, 8192
  buffer_load_dwordx4 v2, s[8:11], s33 offen lds
  s_mov_b32 m0, 0x1c00
  s_add_u32 s33, s33, 8192
  buffer_load_dwordx4 v2, s[8:11], s33 offen lds
  s_waitcnt vmcnt(0)
  s_barrier
  s_barrier
  s_barrier
  s_mul_i32 s33, s2, 2048
  buffer_load_dwordx4 v[64:67], v31, s[40:43], s33 offen
  s_add_u32 s33, s33, 1024
  buffer_load_dwordx4 v[68:71], v31, s[40:43], s33 offen
  s_mul_i32 s33, s2, 2048
  buffer_load_dwordx4 v[72:75], v31, s[48:51], s33 offen
  s_add_u32 s33, s33, 1024
  buffer_load_dwordx4 v[76:79], v31, s[48:51], s33 offen
  s_mul_i32 s33, s2, 7168
  buffer_load_dwordx4 v[80:83], v31, s[56:59], s33 offen
  s_add_u32 s33, s33, 1024
  buffer_load_dwordx4 v[84:87], v31, s[56:59], s33 offen
  s_add_u32 s33, s33, 1024
  buffer_load_dwordx4 v[88:91], v31, s[56:59], s33 offen
  s_add_u32 s33, s33, 1024
  buffer_load_dwordx4 v[92:95], v31, s[56:59], s33 offen
  s_add_u32 s33, s33, 1024
  buffer_load_dwordx4 v[96:99], v31, s[56:59], s33 offen
  s_add_u32 s33, s33, 1024
  buffer_load_dwordx4 v[100:103], v31, s[56:59], s33 offen
  s_add_u32 s33, s33, 1024
  buffer_load_dwordx4 v[104:107], v31, s[56:59], s33 offen
  s_barrier
  s_barrier
  s_add_u32 s60, s31, 16
  s_mov_b32 s61, 131072
AP_65:
  buffer_load_dword v30, v6, s[4:7], 0 offen sc1
  s_waitcnt vmcnt(0)
  v_subrev_u32 v30, s60, v30
  v_cmp_gt_u32 vcc, 0x80, v30
  s_sub_u32 s61, s61, 1
  s_cbranch_scc1 APD_66
  s_cmp_eq_u64 vcc, -1
  s_cbranch_scc0 AP_65
APD_66:
  s_mov_b32 m0, 0x0
  s_add_u32 s33, s64, s76
  s_add_u32 s33, s33, 0x0
  buffer_load_dwordx4 v3, s[4:7], s33 offen offset:0 sc1 lds
  buffer_load_dwordx4 v3, s[4:7], s33 offen offset:1024 sc1 lds
  buffer_load_dwordx4 v3, s[4:7], s33 offen offset:2048 sc1 lds
  buffer_load_dwordx4 v3, s[4:7], s33 offen offset:3072 sc1 lds
  s_mov_b32 m0, 0x1000
  s_add_u32 s33, s64, s76
  s_add_u32 s33, s33, 0x4000
  buffer_load_dwordx4 v3, s[4:7], s33 offen offset:0 sc1 lds
  buffer_load_dwordx4 v3, s[4:7], s33 offen offset:1024 sc1 lds
  buffer_load_dwordx4 v3, s[4:7], s33 offen offset:2048 sc1 lds
  buffer_load_dwordx4 v3, s[4:7], s33 offen offset:3072 sc1 lds
  s_mov_b32 m0, 0x2000
  s_add_u32 s33, s64, s76
  s_add_u32 s33, s33, 0x8000
  buffer_load_dwordx4 v3, s[4:7], s33 offen offset:0 sc1 lds
  buffer_load_dwordx4 v3, s[4:7], s33 offen offset:1024 sc1 lds
  buffer_load_dwordx4 v3, s[4:7], s33 offen offset:2048 sc1 lds
  buffer_load_dwordx4 v3, s[4:7], s33 offen offset:3072 sc1 lds
  s_mov_b32 m0, 0x3000
  s_add_u32 s33, s64, s76
  s_add_u32 s33, s33, 0xc000
  buffer_load_dwordx4 v3, s[4:7], s33 offen offset:0 sc1 lds
  buffer_load_dwordx4 v3, s[4:7], s33 offen offset:1024 sc1 lds
  buffer_load_dwordx4 v3, s[4:7], s33 offen offset:2048 sc1 lds
  buffer_load_dwordx4 v3, s[4:7], s33 offen offset:3072 sc1 lds
  s_mov_b32 m0, 0x4000
  s_add_u32 s33, s65, s76
  s_add_u32 s33, s33, 0x0
  buffer_load_dwordx4 v3, s[4:7], s33 offen offset:0 sc1 lds
  buffer_load_dwordx4 v3, s[4:7], s33 offen offset:1024 sc1 lds
  buffer_load_dwordx4 v3, s[4:7], s33 offen offset:2048 sc1 lds
  buffer_load_dwordx4 v3, s[4:7], s33 offen offset:3072 sc1 lds
  s_mov_b32 m0, 0x5000
  s_add_u32 s33, s65, s76
  s_add_u32 s33, s33, 0x4000
  buffer_load_dwordx4 v3, s[4:7], s33 offen offset:0 sc1 lds
  buffer_load_dwordx4 v3, s[4:7], s33 offen offset:1024 sc1 lds
  buffer_load_dwordx4 v3, s[4:7], s33 offen offset:2048 sc1 lds
  buffer_load_dwordx4 v3, s[4:7], s33 offen offset:3072 sc1 lds
  s_mov_b32 m0, 0x6000
  s_add_u32 s33, s65, s76
  s_add_u32 s33, s33, 0x8000
  buffer_load_dwordx4 v3, s[4:7], s33 offen offset:0 sc1 lds
  buffer_load_dwordx4 v3, s[4:7], s33 offen offset:1024 sc1 lds
  buffer_load_dwordx4 v3, s[4:7], s33 offen offset:2048 sc1 lds
  buffer_load_dwordx4 v3, s[4:7], s33 offen offset:3072 sc1 lds
  s_mov_b32 m0, 0x7000
  s_add_u32 s33, s65, s76
  s_add_u32 s33, s33, 0xc000
  buffer_load_dwordx4 v3, s[4:7], s33 offen offset:0 sc1 lds
  buffer_load_dwordx4 v3, s[4:7], s33 offen offset:1024 sc1 lds
  buffer_load_dwordx4 v3, s[4:7], s33 offen offset:2048 sc1 lds
  buffer_load_dwordx4 v3, s[4:7], s33 offen offset:3072 sc1 lds
  s_waitcnt vmcnt(16)
  s_barrier
  s_mov_b32 m0, 0x8000
  s_add_u32 s33, s66, s76
  s_add_u32 s33, s33, 0x0
  buffer_load_dwordx4 v3, s[4:7], s33 offen offset:0 sc1 lds
  buffer_load_dwordx4 v3, s[4:7], s33 offen offset:1024 sc1 lds
  buffer_load_dwordx4 v3, s[4:7], s33 offen offset:2048 sc1 lds
  buffer_load_dwordx4 v3, s[4:7], s33 offen offset:3072 sc1 lds
  s_mov_b32 m0, 0x9000
  s_add_u32 s33, s66, s76
  s_add_u32 s33, s33, 0x4000
  buffer_load_dwordx4 v3, s[4:7], s33 offen offset:0 sc1 lds
  buffer_load_dwordx4 v3, s[4:7], s33 offen offset:1024 sc1 lds
  buffer_load_dwordx4 v3, s[4:7], s33 offen offset:2048 sc1 lds
  buffer_load_dwordx4 v3, s[4:7], s33 offen offset:3072 sc1 lds
  s_mov_b32 m0, 0xa000
  s_add_u32 s33, s66, s76
  s_add_u32 s33, s33, 0x8000
  buffer_load_dwordx4 v3, s[4:7], s33 offen offset:0 sc1 lds
  buffer_load_dwordx4 v3, s[4:7], s33 offen offset:1024 sc1 lds
  buffer_load_dwordx4 v3, s[4:7], s33 offen offset:2048 sc1 lds
  buffer_load_dwordx4 v3, s[4:7], s33 offen offset:3072 sc1 lds
  s_mov_b32 m0, 0xb000
  s_add_u32 s33, s66, s76
  s_add_u32 s33, s33, 0xc000
  buffer_load_dwordx4 v3, s[4:7], s33 offen offset:0 sc1 lds
  buffer_load_dwordx4 v3, s[4:7], s33 offen offset:1024 sc1 lds
  buffer_load_dwordx4 v3, s[4:7], s33 offen offset:2048 sc1 lds
  buffer_load_dwordx4 v3, s[4:7], s33 offen offset:3072 sc1 lds
  s_waitcnt vmcnt(16)
  s_barrier
  s_mov_b32 m0, 0xc000
  s_add_u32 s33, s67, s76
  s_add_u32 s33, s33, 0x0
  buffer_load_dwordx4 v3, s[4:7], s33 offen offset:0 sc1 lds
  buffer_load_dwordx4 v3, s[4:7], s33 offen offset:1024 sc1 lds
  buffer_load_dwordx4 v3, s[4:7], s33 offen offset:2048 sc1 lds
  buffer_load_dwordx4 v3, s[4:7], s33 offen offset:3072 sc1 lds
  s_mov_b32 m0, 0xd000
  s_add_u32 s33, s67, s76
  s_add_u32 s33, s33, 0x4000
  buffer_load_dwordx4 v3, s[4:7], s33 offen offset:0 sc1 lds
  buffer_load_dwordx4 v3, s[4:7], s33 offen offset:1024 sc1 lds
  buffer_load_dwordx4 v3, s[4:7], s33 offen offset:2048 sc1 lds
  buffer_load_dwordx4 v3, s[4:7], s33 offen offset:3072 sc1 lds
  s_mov_b32 m0, 0xe000
  s_add_u32 s33, s67, s76
  s_add_u32 s33, s33, 0x8000
  buffer_load_dwordx4 v3, s[4:7], s33 offen offset:0 sc1 lds
  buffer_load_dwordx4 v3, s[4:7], s33 offen offset:1024 sc1 lds
  buffer_load_dwordx4 v3, s[4:7], s33 offen offset:2048 sc1 lds
  buffer_load_dwordx4 v3, s[4:7], s33 offen offset:3072 sc1 lds
  s_mov_b32 m0, 0xf000
  s_add_u32 s33, s67, s76
  s_add_u32 s33, s33, 0xc000
  buffer_load_dwordx4 v3, s[4:7], s33 offen offset:0 sc1 lds
  buffer_load_dwordx4 v3, s[4:7], s33 offen offset:1024 sc1 lds
  buffer_load_dwordx4 v3, s[4:7], s33 offen offset:2048 sc1 lds
  buffer_load_dwordx4 v3, s[4:7], s33 offen offset:3072 sc1 lds
  s_waitcnt vmcnt(16)
  s_barrier
  s_waitcnt vmcnt(0)
  s_barrier
  s_lshl_b32 s35, s20, 9
  s_add_u32 s35, s35, 0xf00000
  s_lshl_b32 s36, s23, 5
  s_add_u32 s36, s36, s35
  s_sub_u32 s77, s36, 32
  s_add_u32 s77, s77, 256
  s_mov_b32 s79, 128
  s_add_u32 s78, s36, 32
  s_mov_b32 s80, 128
  s_lshl_b32 s37, s20, 8
  s_add_u32 s37, s37, 0xf02000
  s_cmp_eq_u32 s23, 0
  s_cbranch_scc0 FH_67
  s_mov_b32 s77, s36
  s_cmp_eq_u32 s20, 0
  s_cbranch_scc1 FH_67
  s_mov_b32 s77, s37
  s_mov_b32 s79, 0
FH_67:
  s_cmp_eq_u32 s23, 3
  s_cbranch_scc0 FH_68
  s_mov_b32 s78, s36
  s_cmp_eq_u32 s20, 7
  s_cbranch_scc1 FH_68
  s_add_u32 s78, s37, 128
  s_mov_b32 s80, 0
FH_68:
  v_bfe_u32 v25, v0, 3, 1
  v_and_b32 v26, 7, v0
  v_lshlrev_b32 v26, 2, v26
  v_mul_u32_u24 v27, s79, v25
  v_add_u32 v27, v27, v26
  v_add_u32 v27, s77, v27
  v_lshrrev_b32 v28, 4, v0
  v_cmp_eq_u32 vcc, 2, v28
  s_nop 1
  v_cndmask_b32 v7, v5, v27, vcc
  v_mul_u32_u24 v27, s80, v25
  v_add_u32 v27, v27, v26
  v_add_u32 v27, s78, v27
  v_lshrrev_b32 v28, 4, v0
  v_cmp_eq_u32 vcc, 3, v28
  s_nop 1
  v_cndmask_b32 v7, v7, v27, vcc
  s_add_u32 s60, s31, 24
  s_mov_b32 s61, 131072
AP_69:
  buffer_load_dword v30, v5, s[4:7], 0 offen sc1
  s_waitcnt vmcnt(0)
  v_subrev_u32 v30, s60, v30
  v_cmp_gt_u32 vcc, 0x80, v30
  s_sub_u32 s61, s61, 1
  s_cbranch_scc1 APD_70
  s_cmp_eq_u64 vcc, -1
  s_cbranch_scc0 AP_69
APD_70:
  s_mov_b32 m0, 0x0
  s_add_u32 s33, s64, 0x280000
  buffer_load_dwordx4 v3, s[4:7], s33 offen offset:0 sc1 lds
  buffer_load_dwordx4 v3, s[4:7], s33 offen offset:1024 sc1 lds
  buffer_load_dwordx4 v3, s[4:7], s33 offen offset:2048 sc1 lds
  buffer_load_dwordx4 v3, s[4:7], s33 offen offset:3072 sc1 lds
  s_mov_b32 m0, 0x1000
  s_add_u32 s33, s64, 0x284000
  buffer_load_dwordx4 v3, s[4:7], s33 offen offset:0 sc1 lds
  buffer_load_dwordx4 v3, s[4:7], s33 offen offset:1024 sc1 lds
  buffer_load_dwordx4 v3, s[4:7], s33 offen offset:2048 sc1 lds
  buffer_load_dwordx4 v3, s[4:7], s33 offen offset:3072 sc1 lds
  s_mov_b32 m0, 0x2000
  s_add_u32 s33, s64, 0x288000
  buffer_load_dwordx4 v3, s[4:7], s33 offen offset:0 sc1 lds
  buffer_load_dwordx4 v3, s[4:7], s33 offen offset:1024 sc1 lds
  buffer_load_dwordx4 v3, s[4:7], s33 offen offset:2048 sc1 lds
  buffer_load_dwordx4 v3, s[4:7], s33 offen offset:3072 sc1 lds
  s_mov_b32 m0, 0x3000
  s_add_u32 s33, s64, 0x28c000
  buffer_load_dwordx4 v3, s[4:7], s33 offen offset:0 sc1 lds
  buffer_load_dwordx4 v3, s[4:7], s33 offen offset:1024 sc1 lds
  buffer_load_dwordx4 v3, s[4:7], s33 offen offset:2048 sc1 lds
  buffer_load_dwordx4 v3, s[4:7], s33 offen offset:3072 sc1 lds
  s_mov_b32 m0, 0x4000
  s_add_u32 s33, s65, 0x280000
  buffer_load_dwordx4 v3, s[4:7], s33 offen offset:0 sc1 lds
  buffer_load_dwordx4 v3, s[4:7], s33 offen offset:1024 sc1 lds
  buffer_load_dwordx4 v3, s[4:7], s33 offen offset:2048 sc1 lds
  buffer_load_dwordx4 v3, s[4:7], s33 offen offset:3072 sc1 lds
  s_mov_b32 m0, 0x5000
  s_add_u32 s33, s65, 0x284000
  buffer_load_dwordx4 v3, s[4:7], s33 offen offset:0 sc1 lds
  buffer_load_dwordx4 v3, s[4:7], s33 offen offset:1024 sc1 lds
  buffer_load_dwordx4 v3, s[4:7], s33 offen offset:2048 sc1 lds
  buffer_load_dwordx4 v3, s[4:7], s33 offen offset:3072 sc1 lds
  s_mov_b32 m0, 0x6000
  s_add_u32 s33, s65, 0x288000
  buffer_load_dwordx4 v3, s[4:7], s33 offen offset:0 sc1 lds
  buffer_load_dwordx4 v3, s[4:7], s33 offen offset:1024 sc1 lds
  buffer_load_dwordx4 v3, s[4:7], s33 offen offset:2048 sc1 lds
  buffer_load_dwordx4 v3, s[4:7], s33 offen offset:3072 sc1 lds
  s_mov_b32 m0, 0x7000
  s_add_u32 s33, s65, 0x28c000
  buffer_load_dwordx4 v3, s[4:7], s33 offen offset:0 sc1 lds
  buffer_load_dwordx4 v3, s[4:7], s33 offen offset:1024 sc1 lds
  buffer_load_dwordx4 v3, s[4:7], s33 offen offset:2048 sc1 lds
  buffer_load_dwordx4 v3, s[4:7], s33 offen offset:3072 sc1 lds
  s_waitcnt vmcnt(16)
  s_barrier
  s_mov_b32 m0, 0x8000
  s_add_u32 s33, s66, 0x280000
  buffer_load_dwordx4 v3, s[4:7], s33 offen offset:0 sc1 lds
  buffer_load_dwordx4 v3, s[4:7], s33 offen offset:1024 sc1 lds
  buffer_load_dwordx4 v3, s[4:7], s33 offen offset:2048 sc1 lds
  buffer_load_dwordx4 v3, s[4:7], s33 offen offset:3072 sc1 lds
  s_mov_b32 m0, 0x9000
  s_add_u32 s33, s66, 0x284000
  buffer_load_dwordx4 v3, s[4:7], s33 offen offset:0 sc1 lds
  buffer_load_dwordx4 v3, s[4:7], s33 offen offset:1024 sc1 lds
  buffer_load_dwordx4 v3, s[4:7], s33 offen offset:2048 sc1 lds
  buffer_load_dwordx4 v3, s[4:7], s33 offen offset:3072 sc1 lds
  s_mov_b32 m0, 0xa000
  s_add_u32 s33, s66, 0x288000
  buffer_load_dwordx4 v3, s[4:7], s33 offen offset:0 sc1 lds
  buffer_load_dwordx4 v3, s[4:7], s33 offen offset:1024 sc1 lds
  buffer_load_dwordx4 v3, s[4:7], s33 offen offset:2048 sc1 lds
  buffer_load_dwordx4 v3, s[4:7], s33 offen offset:3072 sc1 lds
  s_mov_b32 m0, 0xb000
  s_add_u32 s33, s66, 0x28c000
  buffer_load_dwordx4 v3, s[4:7], s33 offen offset:0 sc1 lds
  buffer_load_dwordx4 v3, s[4:7], s33 offen offset:1024 sc1 lds
  buffer_load_dwordx4 v3, s[4:7], s33 offen offset:2048 sc1 lds
  buffer_load_dwordx4 v3, s[4:7], s33 offen offset:3072 sc1 lds
  s_waitcnt vmcnt(16)
  s_barrier
  s_mov_b32 m0, 0xc000
  s_add_u32 s33, s67, 0x280000
  buffer_load_dwordx4 v3, s[4:7], s33 offen offset:0 sc1 lds
  buffer_load_dwordx4 v3, s[4:7], s33 offen offset:1024 sc1 lds
  buffer_load_dwordx4 v3, s[4:7], s33 offen offset:2048 sc1 lds
  buffer_load_dwordx4 v3, s[4:7], s33 offen offset:3072 sc1 lds
  s_mov_b32 m0, 0xd000
  s_add_u32 s33, s67, 0x284000
  buffer_load_dwordx4 v3, s[4:7], s33 offen offset:0 sc1 lds
  buffer_load_dwordx4 v3, s[4:7], s33 offen offset:1024 sc1 lds
  buffer_load_dwordx4 v3, s[4:7], s33 offen offset:2048 sc1 lds
  buffer_load_dwordx4 v3, s[4:7], s33 offen offset:3072 sc1 lds
  s_mov_b32 m0, 0xe000
  s_add_u32 s33, s67, 0x288000
  buffer_load_dwordx4 v3, s[4:7], s33 offen offset:0 sc1 lds
  buffer_load_dwordx4 v3, s[4:7], s33 offen offset:1024 sc1 lds
  buffer_load_dwordx4 v3, s[4:7], s33 offen offset:2048 sc1 lds
  buffer_load_dwordx4 v3, s[4:7], s33 offen offset:3072 sc1 lds
  s_mov_b32 m0, 0xf000
  s_add_u32 s33, s67, 0x28c000
  buffer_load_dwordx4 v3, s[4:7], s33 offen offset:0 sc1 lds
  buffer_load_dwordx4 v3, s[4:7], s33 offen offset:1024 sc1 lds
  buffer_load_dwordx4 v3, s[4:7], s33 offen offset:2048 sc1 lds
  buffer_load_dwordx4 v3, s[4:7], s33 offen offset:3072 sc1 lds
  s_waitcnt vmcnt(16)
  s_barrier
  s_waitcnt vmcnt(0)
  s_barrier
  s_add_u32 s60, s31, 32
  s_mov_b32 s61, 131072
AP_71:
  buffer_load_dword v30, v7, s[4:7], 0 offen sc1
  s_waitcnt vmcnt(0)
  v_subrev_u32 v30, s60, v30
  v_cmp_gt_u32 vcc, 0x80, v30
  s_sub_u32 s61, s61, 1
  s_cbranch_scc1 APD_72
  s_cmp_eq_u64 vcc, -1
  s_cbranch_scc0 AP_71
APD_72:
  s_mov_b32 m0, 0x0
  s_mov_b32 s33, s64
  buffer_load_dwordx4 v8, s[4:7], s33 offen offset:0 sc1 lds
  buffer_load_dwordx4 v8, s[4:7], s33 offen offset:1024 sc1 lds
  buffer_load_dwordx4 v8, s[4:7], s33 offen offset:2048 sc1 lds
  buffer_load_dwordx4 v8, s[4:7], s33 offen offset:3072 sc1 lds
  s_mov_b32 m0, 0x1000
  s_mov_b32 s33, s64
  buffer_load_dwordx4 v9, s[4:7], s33 offen offset:0 sc1 lds
  buffer_load_dwordx4 v9, s[4:7], s33 offen offset:1024 sc1 lds
  buffer_load_dwordx4 v9, s[4:7], s33 offen offset:2048 sc1 lds
  buffer_load_dwordx4 v9, s[4:7], s33 offen offset:3072 sc1 lds
  s_mov_b32 m0, 0x2000
  s_mov_b32 s33, s64
  buffer_load_dwordx4 v10, s[4:7], s33 offen offset:0 sc1 lds
  buffer_load_dwordx4 v10, s[4:7], s33 offen offset:1024 sc1 lds
  buffer_load_dwordx4 v10, s[4:7], s33 offen offset:2048 sc1 lds
  buffer_load_dwordx4 v10, s[4:7], s33 offen offset:3072 sc1 lds
  s_mov_b32 m0, 0x3000
  s_mov_b32 s33, s64
  buffer_load_dwordx4 v11, s[4:7], s33 offen offset:0 sc1 lds
  buffer_load_dwordx4 v11, s[4:7], s33 offen offset:1024 sc1 lds
  buffer_load_dwordx4 v11, s[4:7], s33 offen offset:2048 sc1 lds
  buffer_load_dwordx4 v11, s[4:7], s33 offen offset:3072 sc1 lds
  s_mov_b32 m0, 0x4000
  s_mov_b32 s33, s65
  buffer_load_dwordx4 v12, s[4:7], s33 offen offset:0 sc1 lds
  buffer_load_dwordx4 v12, s[4:7], s33 offen offset:1024 sc1 lds
  buffer_load_dwordx4 v12, s[4:7], s33 offen offset:2048 sc1 lds
  buffer_load_dwordx4 v12, s[4:7], s33 offen offset:3072 sc1 lds
  s_mov_b32 m0, 0x5000
  s_mov_b32 s33, s65
  buffer_load_dwordx4 v13, s[4:7], s33 offen offset:0 sc1 lds
  buffer_load_dwordx4 v13, s[4:7], s33 offen offset:1024 sc1 lds
  buffer_load_dwordx4 v13, s[4:7], s33 offen offset:2048 sc1 lds
  buffer_load_dwordx4 v13, s[4:7], s33 offen offset:3072 sc1 lds
  s_mov_b32 m0, 0x6000
  s_mov_b32 s33, s65
  buffer_load_dwordx4 v14, s[4:7], s33 offen offset:0 sc1 lds
  buffer_load_dwordx4 v14, s[4:7], s33 offen offset:1024 sc1 lds
  buffer_load_dwordx4 v14, s[4:7], s33 offen offset:2048 sc1 lds
  buffer_load_dwordx4 v14, s[4:7], s33 offen offset:3072 sc1 lds
  s_mov_b32 m0, 0x7000
  s_mov_b32 s33, s65
  buffer_load_dwordx4 v15, s[4:7], s33 offen offset:0 sc1 lds
  buffer_load_dwordx4 v15, s[4:7], s33 offen offset:1024 sc1 lds
  buffer_load_dwordx4 v15, s[4:7], s33 offen offset:2048 sc1 lds
  buffer_load_dwordx4 v15, s[4:7], s33 offen offset:3072 sc1 lds
  s_waitcnt vmcnt(16)
  s_barrier
  s_mov_b32 m0, 0x8000
  s_mov_b32 s33, s66
  buffer_load_dwordx4 v16, s[4:7], s33 offen offset:0 sc1 lds
  buffer_load_dwordx4 v16, s[4:7], s33 offen offset:1024 sc1 lds
  buffer_load_dwordx4 v16, s[4:7], s33 offen offset:2048 sc1 lds
  buffer_load_dwordx4 v16, s[4:7], s33 offen offset:3072 sc1 lds
  s_mov_b32 m0, 0x9000
  s_mov_b32 s33, s66
  buffer_load_dwordx4 v17, s[4:7], s33 offen offset:0 sc1 lds
  buffer_load_dwordx4 v17, s[4:7], s33 offen offset:1024 sc1 lds
  buffer_load_dwordx4 v17, s[4:7], s33 offen offset:2048 sc1 lds
  buffer_load_dwordx4 v17, s[4:7], s33 offen offset:3072 sc1 lds
  s_mov_b32 m0, 0xa000
  s_mov_b32 s33, s66
  buffer_load_dwordx4 v18, s[4:7], s33 offen offset:0 sc1 lds
  buffer_load_dwordx4 v18, s[4:7], s33 offen offset:1024 sc1 lds
  buffer_load_dwordx4 v18, s[4:7], s33 offen offset:2048 sc1 lds
  buffer_load_dwordx4 v18, s[4:7], s33 offen offset:3072 sc1 lds
  s_mov_b32 m0, 0xb000
  s_mov_b32 s33, s66
  buffer_load_dwordx4 v19, s[4:7], s33 offen offset:0 sc1 lds
  buffer_load_dwordx4 v19, s[4:7], s33 offen offset:1024 sc1 lds
  buffer_load_dwordx4 v19, s[4:7], s33 offen offset:2048 sc1 lds
  buffer_load_dwordx4 v19, s[4:7], s33 offen offset:3072 sc1 lds
  s_waitcnt vmcnt(16)
  s_barrier
  s_mov_b32 m0, 0xc000
  s_mov_b32 s33, s67
  buffer_load_dwordx4 v20, s[4:7], s33 offen offset:0 sc1 lds
  buffer_load_dwordx4 v20, s[4:7], s33 offen offset:1024 sc1 lds
  buffer_load_dwordx4 v20, s[4:7], s33 offen offset:2048 sc1 lds
  buffer_load_dwordx4 v20, s[4:7], s33 offen offset:3072 sc1 lds
  s_mov_b32 m0, 0xd000
  s_mov_b32 s33, s67
  buffer_load_dwordx4 v21, s[4:7], s33 offen offset:0 sc1 lds
  buffer_load_dwordx4 v21, s[4:7], s33 offen offset:1024 sc1 lds
  buffer_load_dwordx4 v21, s[4:7], s33 offen offset:2048 sc1 lds
  buffer_load_dwordx4 v21, s[4:7], s33 offen offset:3072 sc1 lds
  s_mov_b32 m0, 0xe000
  s_mov_b32 s33, s67
  buffer_load_dwordx4 v22, s[4:7], s33 offen offset:0 sc1 lds
  buffer_load_dwordx4 v22, s[4:7], s33 offen offset:1024 sc1 lds
  buffer_load_dwordx4 v22, s[4:7], s33 offen offset:2048 sc1 lds
  buffer_load_dwordx4 v22, s[4:7], s33 offen offset:3072 sc1 lds
  s_mov_b32 m0, 0xf000
  s_mov_b32 s33, s67
  buffer_load_dwordx4 v23, s[4:7], s33 offen offset:0 sc1 lds
  buffer_load_dwordx4 v23, s[4:7], s33 offen offset:1024 sc1 lds
  buffer_load_dwordx4 v23, s[4:7], s33 offen offset:2048 sc1 lds
  buffer_load_dwordx4 v23, s[4:7], s33 offen offset:3072 sc1 lds
  s_waitcnt vmcnt(16)
  s_barrier
  s_waitcnt vmcnt(0)
  s_barrier
  s_barrier
  s_barrier
  s_barrier
  s_barrier
  s_barrier
  s_barrier
  s_barrier
  s_barrier
  s_barrier
  s_barrier
  s_barrier
  s_barrier
  s_barrier
  s_barrier
  s_barrier
  s_barrier
  s_barrier
  s_barrier
  s_barrier
  s_barrier
  s_barrier
  s_barrier
  s_barrier
  s_barrier
  s_barrier
  s_barrier
  s_barrier
  s_barrier
  s_barrier
  s_add_u32 s60, s31, 64
  s_mov_b32 s61, 131072
AP_73:
  buffer_load_dword v30, v6, s[4:7], 0 offen sc1
  s_waitcnt vmcnt(0)
  v_subrev_u32 v30, s60, v30
  v_cmp_gt_u32 vcc, 0x80, v30
  s_sub_u32 s61, s61, 1
  s_cbranch_scc1 APD_74
  s_cmp_eq_u64 vcc, -1
  s_cbranch_scc0 AP_73
APD_74:
  s_mov_b32 m0, 0x0
  s_add_u32 s33, s64, s76
  s_add_u32 s33, s33, 0x0
  buffer_load_dwordx4 v3, s[4:7], s33 offen offset:0 sc1 lds
  buffer_load_dwordx4 v3, s[4:7], s33 offen offset:1024 sc1 lds
  buffer_load_dwordx4 v3, s[4:7], s33 offen offset:2048 sc1 lds
  buffer_load_dwordx4 v3, s[4:7], s33 offen offset:3072 sc1 lds
  s_mov_b32 m0, 0x1000
  s_add_u32 s33, s64, s76
  s_add_u32 s33, s33, 0x4000
  buffer_load_dwordx4 v3, s[4:7], s33 offen offset:0 sc1 lds
  buffer_load_dwordx4 v3, s[4:7], s33 offen offset:1024 sc1 lds
  buffer_load_dwordx4 v3, s[4:7], s33 offen offset:2048 sc1 lds
  buffer_load_dwordx4 v3, s[4:7], s33 offen offset:3072 sc1 lds
  s_mov_b32 m0, 0x2000
  s_add_u32 s33, s64, s76
  s_add_u32 s33, s33, 0x8000
  buffer_load_dwordx4 v3, s[4:7], s33 offen offset:0 sc1 lds
  buffer_load_dwordx4 v3, s[4:7], s33 offen offset:1024 sc1 lds
  buffer_load_dwordx4 v3, s[4:7], s33 offen offset:2048 sc1 lds
  buffer_load_dwordx4 v3, s[4:7], s33 offen offset:3072 sc1 lds
  s_mov_b32 m0, 0x3000
  s_add_u32 s33, s64, s76
  s_add_u32 s33, s33, 0xc000
  buffer_load_dwordx4 v3, s[4:7], s33 offen offset:0 sc1 lds
  buffer_load_dwordx4 v3, s[4:7], s33 offen offset:1024 sc1 lds
  buffer_load_dwordx4 v3, s[4:7], s33 offen offset:2048 sc1 lds
  buffer_load_dwordx4 v3, s[4:7], s33 offen offset:3072 sc1 lds
  s_mov_b32 m0, 0x4000
  s_add_u32 s33, s65, s76
  s_add_u32 s33, s33, 0x0
  buffer_load_dwordx4 v3, s[4:7], s33 offen offset:0 sc1 lds
  buffer_load_dwordx4 v3, s[4:7], s33 offen offset:1024 sc1 lds
  buffer_load_dwordx4 v3, s[4:7], s33 offen offset:2048 sc1 lds
  buffer_load_dwordx4 v3, s[4:7], s33 offen offset:3072 sc1 lds
  s_mov_b32 m0, 0x5000
  s_add_u32 s33, s65, s76
  s_add_u32 s33, s33, 0x4000
  buffer_load_dwordx4 v3, s[4:7], s33 offen offset:0 sc1 lds
  buffer_load_dwordx4 v3, s[4:7], s33 offen offset:1024 sc1 lds
  buffer_load_dwordx4 v3, s[4:7], s33 offen offset:2048 sc1 lds
  buffer_load_dwordx4 v3, s[4:7], s33 offen offset:3072 sc1 lds
  s_mov_b32 m0, 0x6000
  s_add_u32 s33, s65, s76
  s_add_u32 s33, s33, 0x8000
  buffer_load_dwordx4 v3, s[4:7], s33 offen offset:0 sc1 lds
  buffer_load_dwordx4 v3, s[4:7], s33 offen offset:1024 sc1 lds
  buffer_load_dwordx4 v3, s[4:7], s33 offen offset:2048 sc1 lds
  buffer_load_dwordx4 v3, s[4:7], s33 offen offset:3072 sc1 lds
  s_mov_b32 m0, 0x7000
  s_add_u32 s33, s65, s76
  s_add_u32 s33, s33, 0xc000
  buffer_load_dwordx4 v3, s[4:7], s33 offen offset:0 sc1 lds
  buffer_load_dwordx4 v3, s[4:7], s33 offen offset:1024 sc1 lds
  buffer_load_dwordx4 v3, s[4:7], s33 offen offset:2048 sc1 lds
  buffer_load_dwordx4 v3, s[4:7], s33 offen offset:3072 sc1 lds
  s_waitcnt vmcnt(16)
  s_barrier
  s_mov_b32 m0, 0x8000
  s_add_u32 s33, s66, s76
  s_add_u32 s33, s33, 0x0
  buffer_load_dwordx4 v3, s[4:7], s33 offen offset:0 sc1 lds
  buffer_load_dwordx4 v3, s[4:7], s33 offen offset:1024 sc1 lds
  buffer_load_dwordx4 v3, s[4:7], s33 offen offset:2048 sc1 lds
  buffer_load_dwordx4 v3, s[4:7], s33 offen offset:3072 sc1 lds
  s_mov_b32 m0, 0x9000
  s_add_u32 s33, s66, s76
  s_add_u32 s33, s33, 0x4000
  buffer_load_dwordx4 v3, s[4:7], s33 offen offset:0 sc1 lds
  buffer_load_dwordx4 v3, s[4:7], s33 offen offset:1024 sc1 lds
  buffer_load_dwordx4 v3, s[4:7], s33 offen offset:2048 sc1 lds
  buffer_load_dwordx4 v3, s[4:7], s33 offen offset:3072 sc1 lds
  s_mov_b32 m0, 0xa000
  s_add_u32 s33, s66, s76
  s_add_u32 s33, s33, 0x8000
  buffer_load_dwordx4 v3, s[4:7], s33 offen offset:0 sc1 lds
  buffer_load_dwordx4 v3, s[4:7], s33 offen offset:1024 sc1 lds
  buffer_load_dwordx4 v3, s[4:7], s33 offen offset:2048 sc1 lds
  buffer_load_dwordx4 v3, s[4:7], s33 offen offset:3072 sc1 lds
  s_mov_b32 m0, 0xb000
  s_add_u32 s33, s66, s76
  s_add_u32 s33, s33, 0xc000
  buffer_load_dwordx4 v3, s[4:7], s33 offen offset:0 sc1 lds
  buffer_load_dwordx4 v3, s[4:7], s33 offen offset:1024 sc1 lds
  buffer_load_dwordx4 v3, s[4:7], s33 offen offset:2048 sc1 lds
  buffer_load_dwordx4 v3, s[4:7], s33 offen offset:3072 sc1 lds
  s_waitcnt vmcnt(16)
  s_barrier
  s_mov_b32 m0, 0xc000
  s_add_u32 s33, s67, s76
  s_add_u32 s33, s33, 0x0
  buffer_load_dwordx4 v3, s[4:7], s33 offen offset:0 sc1 lds
  buffer_load_dwordx4 v3, s[4:7], s33 offen offset:1024 sc1 lds
  buffer_load_dwordx4 v3, s[4:7], s33 offen offset:2048 sc1 lds
  buffer_load_dwordx4 v3, s[4:7], s33 offen offset:3072 sc1 lds
  s_mov_b32 m0, 0xd000
  s_add_u32 s33, s67, s76
  s_add_u32 s33, s33, 0x4000
  buffer_load_dwordx4 v3, s[4:7], s33 offen offset:0 sc1 lds
  buffer_load_dwordx4 v3, s[4:7], s33 offen offset:1024 sc1 lds
  buffer_load_dwordx4 v3, s[4:7], s33 offen offset:2048 sc1 lds
  buffer_load_dwordx4 v3, s[4:7], s33 offen offset:3072 sc1 lds
  s_mov_b32 m0, 0xe000
  s_add_u32 s33, s67, s76
  s_add_u32 s33, s33, 0x8000
  buffer_load_dwordx4 v3, s[4:7], s33 offen offset:0 sc1 lds
  buffer_load_dwordx4 v3, s[4:7], s33 offen offset:1024 sc1 lds
  buffer_load_dwordx4 v3, s[4:7], s33 offen offset:2048 sc1 lds
  buffer_load_dwordx4 v3, s[4:7], s33 offen offset:3072 sc1 lds
  s_mov_b32 m0, 0xf000
  s_add_u32 s33, s67, s76
  s_add_u32 s33, s33, 0xc000
  buffer_load_dwordx4 v3, s[4:7], s33 offen offset:0 sc1 lds
  buffer_load_dwordx4 v3, s[4:7], s33 offen offset:1024 sc1 lds
  buffer_load_dwordx4 v3, s[4:7], s33 offen offset:2048 sc1 lds
  buffer_load_dwordx4 v3, s[4:7], s33 offen offset:3072 sc1 lds
  s_waitcnt vmcnt(16)
  s_barrier
  s_waitcnt vmcnt(0)
  s_barrier
  s_lshl_b32 s35, s20, 9
  s_add_u32 s35, s35, 0xf00000
  s_lshl_b32 s36, s23, 5
  s_add_u32 s36, s36, s35
  s_sub_u32 s77, s36, 32
  s_add_u32 s77, s77, 256
  s_mov_b32 s79, 128
  s_add_u32 s78, s36, 32
  s_mov_b32 s80, 128
  s_lshl_b32 s37, s20, 8
  s_add_u32 s37, s37, 0xf02800
  s_cmp_eq_u32 s23, 0
  s_cbranch_scc0 FH_75
  s_mov_b32 s77, s36
  s_cmp_eq_u32 s20, 0
  s_cbranch_scc1 FH_75
  s_mov_b32 s77, s37
  s_mov_b32 s79, 0
FH_75:
  s_cmp_eq_u32 s23, 3
  s_cbranch_scc0 FH_76
  s_mov_b32 s78, s36
  s_cmp_eq_u32 s20, 7
  s_cbranch_scc1 FH_76
  s_add_u32 s78, s37, 128
  s_mov_b32 s80, 0
FH_76:
  v_bfe_u32 v25, v0, 3, 1
  v_and_b32 v26, 7, v0
  v_lshlrev_b32 v26, 2, v26
  v_mul_u32_u24 v27, s79, v25
  v_add_u32 v27, v27, v26
  v_add_u32 v27, s77, v27
  v_lshrrev_b32 v28, 4, v0
  v_cmp_eq_u32 vcc, 2, v28
  s_nop 1
  v_cndmask_b32 v7, v5, v27, vcc
  v_mul_u32_u24 v27, s80, v25
  v_add_u32 v27, v27, v26
  v_add_u32 v27, s78, v27
  v_lshrrev_b32 v28, 4, v0
  v_cmp_eq_u32 vcc, 3, v28
  s_nop 1
  v_cndmask_b32 v7, v7, v27, vcc
  s_add_u32 s60, s31, 72
  s_mov_b32 s61, 131072
AP_77:
  buffer_load_dword v30, v5, s[4:7], 0 offen sc1
  s_waitcnt vmcnt(0)
  v_subrev_u32 v30, s60, v30
  v_cmp_gt_u32 vcc, 0x80, v30
  s_sub_u32 s61, s61, 1
  s_cbranch_scc1 APD_78
  s_cmp_eq_u64 vcc, -1
  s_cbranch_scc0 AP_77
APD_78:
  s_mov_b32 m0, 0x0
  s_add_u32 s33, s64, 0x280000
  buffer_load_dwordx4 v3, s[4:7], s33 offen offset:0 sc1 lds
  buffer_load_dwordx4 v3, s[4:7], s33 offen offset:1024 sc1 lds
  buffer_load_dwordx4 v3, s[4:7], s33 offen offset:2048 sc1 lds
  buffer_load_dwordx4 v3, s[4:7], s33 offen offset:3072 sc1 lds
  s_mov_b32 m0, 0x1000
  s_add_u32 s33, s64, 0x284000
  buffer_load_dwordx4 v3, s[4:7], s33 offen offset:0 sc1 lds
  buffer_load_dwordx4 v3, s[4:7], s33 offen offset:1024 sc1 lds
  buffer_load_dwordx4 v3, s[4:7], s33 offen offset:2048 sc1 lds
  buffer_load_dwordx4 v3, s[4:7], s33 offen offset:3072 sc1 lds
  s_mov_b32 m0, 0x2000
  s_add_u32 s33, s64, 0x288000
  buffer_load_dwordx4 v3, s[4:7], s33 offen offset:0 sc1 lds
  buffer_load_dwordx4 v3, s[4:7], s33 offen offset:1024 sc1 lds
  buffer_load_dwordx4 v3, s[4:7], s33 offen offset:2048 sc1 lds
  buffer_load_dwordx4 v3, s[4:7], s33 offen offset:3072 sc1 lds
  s_mov_b32 m0, 0x3000
  s_add_u32 s33, s64, 0x28c000
  buffer_load_dwordx4 v3, s[4:7], s33 offen offset:0 sc1 lds
  buffer_load_dwordx4 v3, s[4:7], s33 offen offset:1024 sc1 lds
  buffer_load_dwordx4 v3, s[4:7], s33 offen offset:2048 sc1 lds
  buffer_load_dwordx4 v3, s[4:7], s33 offen offset:3072 sc1 lds
  s_mov_b32 m0, 0x4000
  s_add_u32 s33, s65, 0x280000
  buffer_load_dwordx4 v3, s[4:7], s33 offen offset:0 sc1 lds
  buffer_load_dwordx4 v3, s[4:7], s33 offen offset:1024 sc1 lds
  buffer_load_dwordx4 v3, s[4:7], s33 offen offset:2048 sc1 lds
  buffer_load_dwordx4 v3, s[4:7], s33 offen offset:3072 sc1 lds
  s_mov_b32 m0, 0x5000
  s_add_u32 s33, s65, 0x284000
  buffer_load_dwordx4 v3, s[4:7], s33 offen offset:0 sc1 lds
  buffer_load_dwordx4 v3, s[4:7], s33 offen offset:1024 sc1 lds
  buffer_load_dwordx4 v3, s[4:7], s33 offen offset:2048 sc1 lds
  buffer_load_dwordx4 v3, s[4:7], s33 offen offset:3072 sc1 lds
  s_mov_b32 m0, 0x6000
  s_add_u32 s33, s65, 0x288000
  buffer_load_dwordx4 v3, s[4:7], s33 offen offset:0 sc1 lds
  buffer_load_dwordx4 v3, s[4:7], s33 offen offset:1024 sc1 lds
  buffer_load_dwordx4 v3, s[4:7], s33 offen offset:2048 sc1 lds
  buffer_load_dwordx4 v3, s[4:7], s33 offen offset:3072 sc1 lds
  s_mov_b32 m0, 0x7000
  s_add_u32 s33, s65, 0x28c000
  buffer_load_dwordx4 v3, s[4:7], s33 offen offset:0 sc1 lds
  buffer_load_dwordx4 v3, s[4:7], s33 offen offset:1024 sc1 lds
  buffer_load_dwordx4 v3, s[4:7], s33 offen offset:2048 sc1 lds
  buffer_load_dwordx4 v3, s[4:7], s33 offen offset:3072 sc1 lds
  s_waitcnt vmcnt(16)
  s_barrier
  s_mov_b32 m0, 0x8000
  s_add_u32 s33, s66, 0x280000
  buffer_load_dwordx4 v3, s[4:7], s33 offen offset:0 sc1 lds
  buffer_load_dwordx4 v3, s[4:7], s33 offen offset:1024 sc1 lds
  buffer_load_dwordx4 v3, s[4:7], s33 offen offset:2048 sc1 lds
  buffer_load_dwordx4 v3, s[4:7], s33 offen offset:3072 sc1 lds
  s_mov_b32 m0, 0x9000
  s_add_u32 s33, s66, 0x284000
  buffer_load_dwordx4 v3, s[4:7], s33 offen offset:0 sc1 lds
  buffer_load_dwordx4 v3, s[4:7], s33 offen offset:1024 sc1 lds
  buffer_load_dwordx4 v3, s[4:7], s33 offen offset:2048 sc1 lds
  buffer_load_dwordx4 v3, s[4:7], s33 offen offset:3072 sc1 lds
  s_mov_b32 m0, 0xa000
  s_add_u32 s33, s66, 0x288000
  buffer_load_dwordx4 v3, s[4:7], s33 offen offset:0 sc1 lds
  buffer_load_dwordx4 v3, s[4:7], s33 offen offset:1024 sc1 lds
  buffer_load_dwordx4 v3, s[4:7], s33 offen offset:2048 sc1 lds
  buffer_load_dwordx4 v3, s[4:7], s33 offen offset:3072 sc1 lds
  s_mov_b32 m0, 0xb000
  s_add_u32 s33, s66, 0x28c000
  buffer_load_dwordx4 v3, s[4:7], s33 offen offset:0 sc1 lds
  buffer_load_dwordx4 v3, s[4:7], s33 offen offset:1024 sc1 lds
  buffer_load_dwordx4 v3, s[4:7], s33 offen offset:2048 sc1 lds
  buffer_load_dwordx4 v3, s[4:7], s33 offen offset:3072 sc1 lds
  s_waitcnt vmcnt(16)
  s_barrier
  s_mov_b32 m0, 0xc000
  s_add_u32 s33, s67, 0x280000
  buffer_load_dwordx4 v3, s[4:7], s33 offen offset:0 sc1 lds
  buffer_load_dwordx4 v3, s[4:7], s33 offen offset:1024 sc1 lds
  buffer_load_dwordx4 v3, s[4:7], s33 offen offset:2048 sc1 lds
  buffer_load_dwordx4 v3, s[4:7], s33 offen offset:3072 sc1 lds
  s_mov_b32 m0, 0xd000
  s_add_u32 s33, s67, 0x284000
  buffer_load_dwordx4 v3, s[4:7], s33 offen offset:0 sc1 lds
  buffer_load_dwordx4 v3, s[4:7], s33 offen offset:1024 sc1 lds
  buffer_load_dwordx4 v3, s[4:7], s33 offen offset:2048 sc1 lds
  buffer_load_dwordx4 v3, s[4:7], s33 offen offset:3072 sc1 lds
  s_mov_b32 m0, 0xe000
  s_add_u32 s33, s67, 0x288000
  buffer_load_dwordx4 v3, s[4:7], s33 offen offset:0 sc1 lds
  buffer_load_dwordx4 v3, s[4:7], s33 offen offset:1024 sc1 lds
  buffer_load_dwordx4 v3, s[4:7], s33 offen offset:2048 sc1 lds
  buffer_load_dwordx4 v3, s[4:7], s33 offen offset:3072 sc1 lds
  s_mov_b32 m0, 0xf000
  s_add_u32 s33, s67, 0x28c000
  buffer_load_dwordx4 v3, s[4:7], s33 offen offset:0 sc1 lds
  buffer_load_dwordx4 v3, s[4:7], s33 offen offset:1024 sc1 lds
  buffer_load_dwordx4 v3, s[4:7], s33 offen offset:2048 sc1 lds
  buffer_load_dwordx4 v3, s[4:7], s33 offen offset:3072 sc1 lds
  s_waitcnt vmcnt(16)
  s_barrier
  s_waitcnt vmcnt(0)
  s_barrier
  s_add_u32 s60, s31, 80
  s_mov_b32 s61, 131072
AP_79:
  buffer_load_dword v30, v7, s[4:7], 0 offen sc1
  s_waitcnt vmcnt(0)
  v_subrev_u32 v30, s60, v30
  v_cmp_gt_u32 vcc, 0x80, v30
  s_sub_u32 s61, s61, 1
  s_cbranch_scc1 APD_80
  s_cmp_eq_u64 vcc, -1
  s_cbranch_scc0 AP_79
APD_80:
  s_mov_b32 m0, 0x0
  s_mov_b32 s33, s64
  buffer_load_dwordx4 v8, s[4:7], s33 offen offset:0 sc1 lds
  buffer_load_dwordx4 v8, s[4:7], s33 offen offset:1024 sc1 lds
  buffer_load_dwordx4 v8, s[4:7], s33 offen offset:2048 sc1 lds
  buffer_load_dwordx4 v8, s[4:7], s33 offen offset:3072 sc1 lds
  s_mov_b32 m0, 0x1000
  s_mov_b32 s33, s64
  buffer_load_dwordx4 v9, s[4:7], s33 offen offset:0 sc1 lds
  buffer_load_dwordx4 v9, s[4:7], s33 offen offset:1024 sc1 lds
  buffer_load_dwordx4 v9, s[4:7], s33 offen offset:2048 sc1 lds
  buffer_load_dwordx4 v9, s[4:7], s33 offen offset:3072 sc1 lds
  s_mov_b32 m0, 0x2000
  s_mov_b32 s33, s64
  buffer_load_dwordx4 v10, s[4:7], s33 offen offset:0 sc1 lds
  buffer_load_dwordx4 v10, s[4:7], s33 offen offset:1024 sc1 lds
  buffer_load_dwordx4 v10, s[4:7], s33 offen offset:2048 sc1 lds
  buffer_load_dwordx4 v10, s[4:7], s33 offen offset:3072 sc1 lds
  s_mov_b32 m0, 0x3000
  s_mov_b32 s33, s64
  buffer_load_dwordx4 v11, s[4:7], s33 offen offset:0 sc1 lds
  buffer_load_dwordx4 v11, s[4:7], s33 offen offset:1024 sc1 lds
  buffer_load_dwordx4 v11, s[4:7], s33 offen offset:2048 sc1 lds
  buffer_load_dwordx4 v11, s[4:7], s33 offen offset:3072 sc1 lds
  s_mov_b32 m0, 0x4000
  s_mov_b32 s33, s65
  buffer_load_dwordx4 v12, s[4:7], s33 offen offset:0 sc1 lds
  buffer_load_dwordx4 v12, s[4:7], s33 offen offset:1024 sc1 lds
  buffer_load_dwordx4 v12, s[4:7], s33 offen offset:2048 sc1 lds
  buffer_load_dwordx4 v12, s[4:7], s33 offen offset:3072 sc1 lds
  s_mov_b32 m0, 0x5000
  s_mov_b32 s33, s65
  buffer_load_dwordx4 v13, s[4:7], s33 offen offset:0 sc1 lds
  buffer_load_dwordx4 v13, s[4:7], s33 offen offset:1024 sc1 lds
  buffer_load_dwordx4 v13, s[4:7], s33 offen offset:2048 sc1 lds
  buffer_load_dwordx4 v13, s[4:7], s33 offen offset:3072 sc1 lds
  s_mov_b32 m0, 0x6000
  s_mov_b32 s33, s65
  buffer_load_dwordx4 v14, s[4:7], s33 offen offset:0 sc1 lds
  buffer_load_dwordx4 v14, s[4:7], s33 offen offset:1024 sc1 lds
  buffer_load_dwordx4 v14, s[4:7], s33 offen offset:2048 sc1 lds
  buffer_load_dwordx4 v14, s[4:7], s33 offen offset:3072 sc1 lds
  s_mov_b32 m0, 0x7000
  s_mov_b32 s33, s65
  buffer_load_dwordx4 v15, s[4:7], s33 offen offset:0 sc1 lds
  buffer_load_dwordx4 v15, s[4:7], s33 offen offset:1024 sc1 lds
  buffer_load_dwordx4 v15, s[4:7], s33 offen offset:2048 sc1 lds
  buffer_load_dwordx4 v15, s[4:7], s33 offen offset:3072 sc1 lds
  s_waitcnt vmcnt(16)
  s_barrier
  s_mov_b32 m0, 0x8000
  s_mov_b32 s33, s66
  buffer_load_dwordx4 v16, s[4:7], s33 offen offset:0 sc1 lds
  buffer_load_dwordx4 v16, s[4:7], s33 offen offset:1024 sc1 lds
  buffer_load_dwordx4 v16, s[4:7], s33 offen offset:2048 sc1 lds
  buffer_load_dwordx4 v16, s[4:7], s33 offen offset:3072 sc1 lds
  s_mov_b32 m0, 0x9000
  s_mov_b32 s33, s66
  buffer_load_dwordx4 v17, s[4:7], s33 offen offset:0 sc1 lds
  buffer_load_dwordx4 v17, s[4:7], s33 offen offset:1024 sc1 lds
  buffer_load_dwordx4 v17, s[4:7], s33 offen offset:2048 sc1 lds
  buffer_load_dwordx4 v17, s[4:7], s33 offen offset:3072 sc1 lds
  s_mov_b32 m0, 0xa000
  s_mov_b32 s33, s66
  buffer_load_dwordx4 v18, s[4:7], s33 offen offset:0 sc1 lds
  buffer_load_dwordx4 v18, s[4:7], s33 offen offset:1024 sc1 lds
  buffer_load_dwordx4 v18, s[4:7], s33 offen offset:2048 sc1 lds
  buffer_load_dwordx4 v18, s[4:7], s33 offen offset:3072 sc1 lds
  s_mov_b32 m0, 0xb000
  s_mov_b32 s33, s66
  buffer_load_dwordx4 v19, s[4:7], s33 offen offset:0 sc1 lds
  buffer_load_dwordx4 v19, s[4:7], s33 offen offset:1024 sc1 lds
  buffer_load_dwordx4 v19, s[4:7], s33 offen offset:2048 sc1 lds
  buffer_load_dwordx4 v19, s[4:7], s33 offen offset:3072 sc1 lds
  s_waitcnt vmcnt(16)
  s_barrier
  s_mov_b32 m0, 0xc000
  s_mov_b32 s33, s67
  buffer_load_dwordx4 v20, s[4:7], s33 offen offset:0 sc1 lds
  buffer_load_dwordx4 v20, s[4:7], s33 offen offset:1024 sc1 lds
  buffer_load_dwordx4 v20, s[4:7], s33 offen offset:2048 sc1 lds
  buffer_load_dwordx4 v20, s[4:7], s33 offen offset:3072 sc1 lds
  s_mov_b32 m0, 0xd000
  s_mov_b32 s33, s67
  buffer_load_dwordx4 v21, s[4:7], s33 offen offset:0 sc1 lds
  buffer_load_dwordx4 v21, s[4:7], s33 offen offset:1024 sc1 lds
  buffer_load_dwordx4 v21, s[4:7], s33 offen offset:2048 sc1 lds
  buffer_load_dwordx4 v21, s[4:7], s33 offen offset:3072 sc1 lds
  s_mov_b32 m0, 0xe000
  s_mov_b32 s33, s67
  buffer_load_dwordx4 v22, s[4:7], s33 offen offset:0 sc1 lds
  buffer_load_dwordx4 v22, s[4:7], s33 offen offset:1024 sc1 lds
  buffer_load_dwordx4 v22, s[4:7], s33 offen offset:2048 sc1 lds
  buffer_load_dwordx4 v22, s[4:7], s33 offen offset:3072 sc1 lds
  s_mov_b32 m0, 0xf000
  s_mov_b32 s33, s67
  buffer_load_dwordx4 v23, s[4:7], s33 offen offset:0 sc1 lds
  buffer_load_dwordx4 v23, s[4:7], s33 offen offset:1024 sc1 lds
  buffer_load_dwordx4 v23, s[4:7], s33 offen offset:2048 sc1 lds
  buffer_load_dwordx4 v23, s[4:7], s33 offen offset:3072 sc1 lds
  s_waitcnt vmcnt(16)
  s_barrier
  s_waitcnt vmcnt(0)
  s_barrier
  s_barrier
  s_barrier
  s_barrier
  s_barrier
  s_barrier
  s_barrier
  s_barrier
  s_barrier
  s_barrier
  s_barrier
  s_barrier
  s_barrier
  s_barrier
  s_barrier
  s_barrier
  s_barrier
  s_barrier
  s_barrier
  s_barrier
  s_barrier
  s_waitcnt vmcnt(0)
  s_endpgm
L_PARKER6:
  s_mov_b32 s48, s66
  s_mov_b32 s49, s67
  s_mov_b32 s50, 0x180000
  s_mov_b32 s51, 0x20000
  s_mov_b32 s40, s76
  s_mov_b32 s41, s77
  s_mov_b32 s42, 0x1c0000
  s_mov_b32 s43, 0x20000
  s_mov_b32 s44, s78
  s_mov_b32 s45, s79
  s_mov_b32 s46, 0x1c0000
  s_mov_b32 s47, 0x20000
  v_lshlrev_b32 v1, 4, v0
  s_lshl_b32 s64, s25, 1
  s_and_b32 s64, s64, 3
  s_xor_b32 s64, s64, 0
  s_mul_i32 s64, s64, 458752
  s_lshl_b32 s65, s25, 1
  s_and_b32 s65, s65, 3
  s_xor_b32 s65, s65, 1
  s_mul_i32 s65, s65, 458752
  s_lshl_b32 s66, s25, 1
  s_and_b32 s66, s66, 3
  s_xor_b32 s66, s66, 2
  s_mul_i32 s66, s66, 458752
  s_lshl_b32 s67, s25, 1
  s_and_b32 s67, s67, 3
  s_xor_b32 s67, s67, 3
  s_mul_i32 s67, s67, 458752
  s_and_b32 s68, s23, 3
  s_lshl_b32 s68, s68, 1
  s_xor_b32 s68, s68, 0
  s_mul_i32 s68, s68, 229376
  s_and_b32 s69, s23, 3
  s_lshl_b32 s69, s69, 1
  s_xor_b32 s69, s69, 1
  s_mul_i32 s69, s69, 229376
  s_and_b32 s70, s23, 3
  s_lshl_b32 s70, s70, 1
  s_xor_b32 s70, s70, 2
  s_mul_i32 s70, s70, 229376
  s_and_b32 s71, s23, 3
  s_lshl_b32 s71, s71, 1
  s_xor_b32 s71, s71, 3
  s_mul_i32 s71, s71, 229376
  s_and_b32 s72, s23, 3
  s_lshl_b32 s72, s72, 1
  s_xor_b32 s72, s72, 4
  s_mul_i32 s72, s72, 229376
  s_and_b32 s73, s23, 3
  s_lshl_b32 s73, s73, 1
  s_xor_b32 s73, s73, 5
  s_mul_i32 s73, s73, 229376
  s_and_b32 s74, s23, 3
  s_lshl_b32 s74, s74, 1
  s_xor_b32 s74, s74, 6
  s_mul_i32 s74, s74, 229376
  s_and_b32 s75, s23, 3
  s_lshl_b32 s75, s75, 1
  s_xor_b32 s75, s75, 7
  s_mul_i32 s75, s75, 229376
  v_lshrrev_b32 v11, 3, v0
  v_bfe_u32 v12, v11, 1, 1
  v_lshlrev_b32 v12, 2, v12
  v_and_b32 v13, 7, v0
  v_xor_b32 v13, v13, v12
  v_lshlrev_b32 v2, 10, v11
  v_lshl_add_u32 v2, v13, 4, v2
  s_lshl_b32 s33, s24, 7
  v_add_u32 v2, s33, v2
  v_add_u32 v3, 0x1c00, v2
  s_mul_i32 s33, s26, 224
  s_mov_b32 s34, 0x12493
  v_add_u32 v11, 0, v0
  v_mul_lo_u32 v12, v11, s34
  v_lshrrev_b32 v12, 20, v12
  v_mul_u32_u24 v13, 14, v12
  v_sub_u32 v13, v11, v13
  v_mul_u32_u24 v4, 3584, v12
  v_lshl_add_u32 v4, v13, 4, v4
  v_add_u32 v4, s33, v4
  v_add_u32 v11, 64, v0
  v_mul_lo_u32 v12, v11, s34
  v_lshrrev_b32 v12, 20, v12
  v_mul_u32_u24 v13, 14, v12
  v_sub_u32 v13, v11, v13
  v_mul_u32_u24 v5, 3584, v12
  v_lshl_add_u32 v5, v13, 4, v5
  v_add_u32 v5, s33, v5
  v_add_u32 v11, 128, v0
  v_mul_lo_u32 v12, v11, s34
  v_lshrrev_b32 v12, 20, v12
  v_mul_u32_u24 v13, 14, v12
  v_sub_u32 v13, v11, v13
  v_mul_u32_u24 v6, 3584, v12
  v_lshl_add_u32 v6, v13, 4, v6
  v_add_u32 v6, s33, v6
  v_add_u32 v11, 192, v0
  v_mul_lo_u32 v12, v11, s34
  v_lshrrev_b32 v12, 20, v12
  v_mul_u32_u24 v13, 14, v12
  v_sub_u32 v13, v11, v13
  v_mul_u32_u24 v7, 3584, v12
  v_lshl_add_u32 v7, v13, 4, v7
  v_add_u32 v7, s33, v7
  v_lshlrev_b32 v8, 4, v0
  v_add_u32 v9, 0x10000, v8
  v_add_u32 v10, 0x20000, v8
  s_waitcnt lgkmcnt(0)
  s_mul_i32 s31, s3, 0x9e3779b1
  s_add_u32 s31, s31, 0x7f4a7c15
  s_and_b32 s31, s31, 0xffffff00
  s_barrier
  s_barrier
  s_barrier
  s_mul_i32 s33, s20, 294912
  s_mul_i32 s34, s21, 9216
  s_add_u32 s33, s33, s34
  buffer_load_dwordx4 v[240:243], v8, s[4:7], s33 offen sc1
  s_add_u32 s33, s33, 1024
  buffer_load_dwordx4 v[244:247], v8, s[4:7], s33 offen sc1
  s_add_u32 s33, s33, 1024
  buffer_load_dwordx4 v[248:251], v8, s[4:7], s33 offen sc1
  s_add_u32 s33, s33, 1024
  buffer_load_dwordx4 v[252:255], v8, s[4:7], s33 offen sc1
  s_add_u32 s33, s33, 1024
  buffer_load_dwordx4 v[240:243], v8, s[4:7], s33 offen sc1
  s_add_u32 s33, s33, 1024
  buffer_load_dwordx4 v[244:247], v8, s[4:7], s33 offen sc1
  s_add_u32 s33, s33, 1024
  buffer_load_dwordx4 v[248:251], v8, s[4:7], s33 offen sc1
  s_add_u32 s33, s33, 1024
  buffer_load_dwordx4 v[252:255], v8, s[4:7], s33 offen sc1
  s_add_u32 s33, s33, 1024
  buffer_load_dwordx4 v[240:243], v8, s[4:7], s33 offen sc1
  s_mul_i32 s33, s20, 32768
  s_mul_i32 s34, s21, 1024
  s_add_u32 s33, s33, s34
  s_add_u32 s33, s33, 0xd80000
  buffer_load_dwordx4 v[240:243], v8, s[4:7], s33 offen sc1
  s_barrier
  s_barrier
  s_add_u32 s33, s65, 0x0
  buffer_load_dwordx4 v[16:19], v4, s[40:43], s33 offen
  buffer_load_dwordx4 v[20:23], v5, s[40:43], s33 offen
  buffer_load_dwordx4 v[24:27], v6, s[40:43], s33 offen
  buffer_load_dwordx4 v[28:31], v7, s[40:43], s33 offen
  s_add_u32 s33, s65, 0x1c000
  buffer_load_dwordx4 v[32:35], v4, s[40:43], s33 offen
  buffer_load_dwordx4 v[36:39], v5, s[40:43], s33 offen
  buffer_load_dwordx4 v[40:43], v6, s[40:43], s33 offen
  buffer_load_dwordx4 v[44:47], v7, s[40:43], s33 offen
  s_barrier
  v_lshlrev_b32 v11, 2, v0
  v_add_u32 v12, 0xc000, v11
  v_add_u32 v13, 0xe000, v11
  ds_read_b32 v216, v12 offset:0
  ds_read_b32 v217, v12 offset:256
  ds_read_b32 v218, v12 offset:512
  ds_read_b32 v219, v12 offset:768
  ds_read_b32 v220, v12 offset:2048
  ds_read_b32 v221, v12 offset:2304
  ds_read_b32 v222, v12 offset:2560
  ds_read_b32 v223, v12 offset:2816
  ds_read_b32 v224, v12 offset:4096
  ds_read_b32 v225, v12 offset:4352
  ds_read_b32 v226, v12 offset:4608
  ds_read_b32 v227, v12 offset:4864
  s_waitcnt lgkmcnt(4)
  ds_read_b32 v228, v12 offset:6144
  ds_read_b32 v229, v12 offset:6400
  ds_read_b32 v230, v12 offset:6656
  ds_read_b32 v231, v12 offset:6912
  ds_read_b32 v232, v13 offset:0
  ds_read_b32 v233, v13 offset:128
  ds_read_b32 v234, v13 offset:256
  ds_read_b32 v235, v13 offset:384
  s_mul_i32 s33, s26, 2176
  s_add_u32 s33, s33, 0xed0000
  s_add_u32 s34, s33, 0
  s_add_u32 s35, s33, 2048
  s_waitcnt lgkmcnt(0)
  v_pk_add_f32 v[216:217], v[216:217], v[220:221]
  v_pk_add_f32 v[224:225], v[224:225], v[228:229]
  v_pk_add_f32 v[216:217], v[216:217], v[224:225]
  v_pk_add_f32 v[218:219], v[218:219], v[222:223]
  v_pk_add_f32 v[226:227], v[226:227], v[230:231]
  v_pk_add_f32 v[218:219], v[218:219], v[226:227]
  v_pk_add_f32 v[232:233], v[232:233], v[234:235]
  v_add_f32 v232, v232, v233
  buffer_atomic_add_f32 v216, v11, s[4:7], s34 offen offset:0
  buffer_atomic_add_f32 v217, v11, s[4:7], s34 offen offset:256
  buffer_atomic_add_f32 v218, v11, s[4:7], s34 offen offset:512
  buffer_atomic_add_f32 v219, v11, s[4:7], s34 offen offset:768
  s_mov_b64 exec, 0xffff
  buffer_atomic_add_f32 v232, v11, s[4:7], s35 offen
  s_mov_b64 exec, -1
  s_add_u32 s33, s65, 0x38000
  buffer_load_dwordx4 v[48:51], v4, s[40:43], s33 offen
  buffer_load_dwordx4 v[52:55], v5, s[40:43], s33 offen
  buffer_load_dwordx4 v[56:59], v6, s[40:43], s33 offen
  buffer_load_dwordx4 v[60:63], v7, s[40:43], s33 offen
  s_add_u32 s33, s65, 0x54000
  buffer_load_dwordx4 v[64:67], v4, s[40:43], s33 offen
  buffer_load_dwordx4 v[68:71], v5, s[40:43], s33 offen
  buffer_load_dwordx4 v[72:75], v6, s[40:43], s33 offen
  buffer_load_dwordx4 v[76:79], v7, s[40:43], s33 offen
  s_barrier
  s_barrier
  s_lshl_b32 s33, s26, 7
  s_lshl_b32 s34, s20, 3
  s_add_u32 s33, s33, s34
  s_lshl_b32 s34, s25, 2
  s_add_u32 s33, s33, s34
  s_add_u32 s33, s33, 0xf01000
  v_mov_b32 v12, s33
  s_add_u32 s34, s31, 8
  s_add_u32 s34, s34, s32
  v_mov_b32 v13, s34
  s_waitcnt vmcnt(8)
  s_mov_b64 exec, 1
  buffer_store_dword v13, v12, s[4:7], 0 offen sc1
  s_mov_b64 exec, -1
  s_barrier
  s_add_u32 s33, s66, 0x0
  buffer_load_dwordx4 v[80:83], v4, s[40:43], s33 offen
  buffer_load_dwordx4 v[84:87], v5, s[40:43], s33 offen
  buffer_load_dwordx4 v[88:91], v6, s[40:43], s33 offen
  buffer_load_dwordx4 v[92:95], v7, s[40:43], s33 offen
  s_add_u32 s33, s66, 0x1c000
  buffer_load_dwordx4 v[96:99], v4, s[40:43], s33 offen
  buffer_load_dwordx4 v[100:103], v5, s[40:43], s33 offen
  buffer_load_dwordx4 v[104:107], v6, s[40:43], s33 offen
  buffer_load_dwordx4 v[108:111], v7, s[40:43], s33 offen
  s_add_u32 s33, s66, 0x38000
  buffer_load_dwordx4 v[112:115], v4, s[40:43], s33 offen
  buffer_load_dwordx4 v[116:119], v5, s[40:43], s33 offen
  buffer_load_dwordx4 v[120:123], v6, s[40:43], s33 offen
  buffer_load_dwordx4 v[124:127], v7, s[40:43], s33 offen
  s_add_u32 s33, s66, 0x54000
  buffer_load_dwordx4 v[128:131], v4, s[40:43], s33 offen
  buffer_load_dwordx4 v[132:135], v5, s[40:43], s33 offen
  buffer_load_dwordx4 v[136:139], v6, s[40:43], s33 offen
  buffer_load_dwordx4 v[140:143], v7, s[40:43], s33 offen
  s_add_u32 s33, s67, 0x0
  buffer_load_dwordx4 v[144:147], v4, s[40:43], s33 offen
  buffer_load_dwordx4 v[148:151], v5, s[40:43], s33 offen
  buffer_load_dwordx4 v[152:155], v6, s[40:43], s33 offen
  buffer_load_dwordx4 v[156:159], v7, s[40:43], s33 offen
  s_add_u32 s33, s67, 0x1c000
  buffer_load_dwordx4 v[160:163], v4, s[40:43], s33 offen
  buffer_load_dwordx4 v[164:167], v5, s[40:43], s33 offen
  buffer_load_dwordx4 v[168:171], v6, s[40:43], s33 offen
  buffer_load_dwordx4 v[172:175], v7, s[40:43], s33 offen
  s_add_u32 s33, s67, 0x38000
  buffer_load_dwordx4 v[176:179], v4, s[40:43], s33 offen
  buffer_load_dwordx4 v[180:183], v5, s[40:43], s33 offen
  buffer_load_dwordx4 v[184:187], v6, s[40:43], s33 offen
  buffer_load_dwordx4 v[188:191], v7, s[40:43], s33 offen
  s_add_u32 s33, s67, 0x54000
  buffer_load_dwordx4 v[192:195], v4, s[40:43], s33 offen
  buffer_load_dwordx4 v[196:199], v5, s[40:43], s33 offen
  buffer_load_dwordx4 v[200:203], v6, s[40:43], s33 offen
  buffer_load_dwordx4 v[204:207], v7, s[40:43], s33 offen
  s_barrier
  s_barrier
  s_barrier
  s_barrier
  s_barrier
  s_barrier
  s_barrier
  s_barrier
  s_barrier
  s_barrier
  s_barrier
  ds_write_b128 v9, v[16:19] offset:14336
  ds_write_b128 v9, v[20:23] offset:15360
  ds_write_b128 v9, v[24:27] offset:16384
  ds_write_b128 v9, v[28:31] offset:17408
  ds_write_b128 v9, v[32:35] offset:21504
  ds_write_b128 v9, v[36:39] offset:22528
  ds_write_b128 v9, v[40:43] offset:23552
  ds_write_b128 v9, v[44:47] offset:24576
  s_mul_i32 s33, s20, 917504
  s_mul_i32 s34, s21, 28672
  s_add_u32 s33, s33, s34
  s_add_u32 s33, s33, 0x680000
  buffer_load_dwordx4 v[240:243], v8, s[4:7], s33 offen sc1
  s_add_u32 s33, s33, 1024
  buffer_load_dwordx4 v[244:247], v8, s[4:7], s33 offen sc1
  s_add_u32 s33, s33, 1024
  buffer_load_dwordx4 v[248:251], v8, s[4:7], s33 offen sc1
  s_add_u32 s33, s33, 1024
  buffer_load_dwordx4 v[252:255], v8, s[4:7], s33 offen sc1
  s_add_u32 s33, s33, 1024
  buffer_load_dwordx4 v[240:243], v8, s[4:7], s33 offen sc1
  s_add_u32 s33, s33, 1024
  buffer_load_dwordx4 v[244:247], v8, s[4:7], s33 offen sc1
  s_add_u32 s33, s33, 1024
  buffer_load_dwordx4 v[248:251], v8, s[4:7], s33 offen sc1
  s_add_u32 s33, s33, 1024
  buffer_load_dwordx4 v[252:255], v8, s[4:7], s33 offen sc1
  s_add_u32 s33, s33, 1024
  buffer_load_dwordx4 v[240:243], v8, s[4:7], s33 offen sc1
  s_add_u32 s33, s33, 1024
  buffer_load_dwordx4 v[244:247], v8, s[4:7], s33 offen sc1
  s_add_u32 s33, s33, 1024
  buffer_load_dwordx4 v[248:251], v8, s[4:7], s33 offen sc1
  s_add_u32 s33, s33, 1024
  buffer_load_dwordx4 v[252:255], v8, s[4:7], s33 offen sc1
  s_add_u32 s33, s33, 1024
  buffer_load_dwordx4 v[240:243], v8, s[4:7], s33 offen sc1
  s_add_u32 s33, s33, 1024
  buffer_load_dwordx4 v[244:247], v8, s[4:7], s33 offen sc1
  s_barrier
  s_waitcnt vmcnt(51)
  ds_write_b128 v9, v[48:51] offset:28672
  ds_write_b128 v9, v[52:55] offset:29696
  ds_write_b128 v9, v[56:59] offset:30720
  ds_write_b128 v9, v[60:63] offset:31744
  s_waitcnt vmcnt(47)
  ds_write_b128 v9, v[64:67] offset:35840
  ds_write_b128 v9, v[68:71] offset:36864
  ds_write_b128 v9, v[72:75] offset:37888
  ds_write_b128 v9, v[76:79] offset:38912
  s_barrier
  s_waitcnt vmcnt(42)
  ds_write_b128 v9, v[80:83] offset:43008
  ds_write_b128 v9, v[84:87] offset:44032
  ds_write_b128 v9, v[88:91] offset:45056
  ds_write_b128 v9, v[92:95] offset:46080
  s_waitcnt vmcnt(38)
  ds_write_b128 v9, v[96:99] offset:50176
  ds_write_b128 v9, v[100:103] offset:51200
  ds_write_b128 v9, v[104:107] offset:52224
  ds_write_b128 v9, v[108:111] offset:53248
  s_waitcnt vmcnt(34)
  ds_write_b128 v9, v[112:115] offset:57344
  ds_write_b128 v9, v[116:119] offset:58368
  ds_write_b128 v9, v[120:123] offset:59392
  ds_write_b128 v9, v[124:127] offset:60416
  s_waitcnt vmcnt(30)
  ds_write_b128 v9, v[128:131] offset:64512
  ds_write_b128 v10, v[132:135] offset:0
  ds_write_b128 v10, v[136:139] offset:1024
  ds_write_b128 v10, v[140:143] offset:2048
  s_waitcnt lgkmcnt(0)
  s_barrier
  s_barrier
  s_waitcnt vmcnt(26)
  ds_write_b128 v10, v[144:147] offset:6144
  ds_write_b128 v10, v[148:151] offset:7168
  ds_write_b128 v10, v[152:155] offset:8192
  ds_write_b128 v10, v[156:159] offset:9216
  s_waitcnt vmcnt(22)
  ds_write_b128 v10, v[160:163] offset:13312
  ds_write_b128 v10, v[164:167] offset:14336
  ds_write_b128 v10, v[168:171] offset:15360
  ds_write_b128 v10, v[172:175] offset:16384
  s_waitcnt vmcnt(18)
  ds_write_b128 v10, v[176:179] offset:20480
  ds_write_b128 v10, v[180:183] offset:21504
  ds_write_b128 v10, v[184:187] offset:22528
  ds_write_b128 v10, v[188:191] offset:23552
  s_waitcnt vmcnt(14)
  ds_write_b128 v9, v[192:195] offset:0
  ds_write_b128 v9, v[196:199] offset:1024
  ds_write_b128 v9, v[200:203] offset:2048
  ds_write_b128 v9, v[204:207] offset:3072
  s_waitcnt lgkmcnt(0)
  s_barrier
  s_barrier
  s_barrier
  s_barrier
  s_barrier
  s_barrier
  s_barrier
  s_barrier
  s_barrier
  s_barrier
  s_barrier
  s_barrier
  s_barrier
  s_barrier
  s_barrier
  s_barrier
  s_barrier
  s_barrier
  s_barrier
  s_barrier
  s_barrier
  s_barrier
  s_add_u32 s33, s65, 0x0
  buffer_load_dwordx4 v[208:211], v4, s[40:43], s33 offen
  buffer_load_dwordx4 v[212:215], v5, s[40:43], s33 offen
  buffer_load_dwordx4 v[16:19], v6, s[40:43], s33 offen
  buffer_load_dwordx4 v[20:23], v7, s[40:43], s33 offen
  s_add_u32 s33, s65, 0x1c000
  buffer_load_dwordx4 v[24:27], v4, s[40:43], s33 offen
  buffer_load_dwordx4 v[28:31], v5, s[40:43], s33 offen
  buffer_load_dwordx4 v[32:35], v6, s[40:43], s33 offen
  buffer_load_dwordx4 v[36:39], v7, s[40:43], s33 offen
  s_barrier
  v_lshlrev_b32 v11, 2, v0
  v_add_u32 v12, 0xc000, v11
  v_add_u32 v13, 0xe000, v11
  ds_read_b32 v216, v12 offset:0
  ds_read_b32 v217, v12 offset:256
  ds_read_b32 v218, v12 offset:512
  ds_read_b32 v219, v12 offset:768
  ds_read_b32 v220, v12 offset:2048
  ds_read_b32 v221, v12 offset:2304
  ds_read_b32 v222, v12 offset:2560
  ds_read_b32 v223, v12 offset:2816
  ds_read_b32 v224, v12 offset:4096
  ds_read_b32 v225, v12 offset:4352
  ds_read_b32 v226, v12 offset:4608
  ds_read_b32 v227, v12 offset:4864
  s_waitcnt lgkmcnt(4)
  ds_read_b32 v228, v12 offset:6144
  ds_read_b32 v229, v12 offset:6400
  ds_read_b32 v230, v12 offset:6656
  ds_read_b32 v231, v12 offset:6912
  ds_read_b32 v232, v13 offset:0
  ds_read_b32 v233, v13 offset:128
  ds_read_b32 v234, v13 offset:256
  ds_read_b32 v235, v13 offset:384
  s_mul_i32 s33, s26, 2176
  s_add_u32 s33, s33, 0xed8800
  s_add_u32 s34, s33, 0
  s_add_u32 s35, s33, 2048
  s_waitcnt lgkmcnt(0)
  v_pk_add_f32 v[216:217], v[216:217], v[220:221]
  v_pk_add_f32 v[224:225], v[224:225], v[228:229]
  v_pk_add_f32 v[216:217], v[216:217], v[224:225]
  v_pk_add_f32 v[218:219], v[218:219], v[222:223]
  v_pk_add_f32 v[226:227], v[226:227], v[230:231]
  v_pk_add_f32 v[218:219], v[218:219], v[226:227]
  v_pk_add_f32 v[232:233], v[232:233], v[234:235]
  v_add_f32 v232, v232, v233
  buffer_atomic_add_f32 v216, v11, s[4:7], s34 offen offset:0
  buffer_atomic_add_f32 v217, v11, s[4:7], s34 offen offset:256
  buffer_atomic_add_f32 v218, v11, s[4:7], s34 offen offset:512
  buffer_atomic_add_f32 v219, v11, s[4:7], s34 offen offset:768
  s_mov_b64 exec, 0xffff
  buffer_atomic_add_f32 v232, v11, s[4:7], s35 offen
  s_mov_b64 exec, -1
  s_add_u32 s33, s65, 0x38000
  buffer_load_dwordx4 v[40:43], v4, s[40:43], s33 offen
  buffer_load_dwordx4 v[44:47], v5, s[40:43], s33 offen
  buffer_load_dwordx4 v[48:51], v6, s[40:43], s33 offen
  buffer_load_dwordx4 v[52:55], v7, s[40:43], s33 offen
  s_add_u32 s33, s65, 0x54000
  buffer_load_dwordx4 v[56:59], v4, s[40:43], s33 offen
  buffer_load_dwordx4 v[60:63], v5, s[40:43], s33 offen
  buffer_load_dwordx4 v[64:67], v6, s[40:43], s33 offen
  buffer_load_dwordx4 v[68:71], v7, s[40:43], s33 offen
  s_barrier
  s_barrier
  s_lshl_b32 s33, s26, 7
  s_lshl_b32 s34, s20, 3
  s_add_u32 s33, s33, s34
  s_lshl_b32 s34, s25, 2
  s_add_u32 s33, s33, s34
  s_add_u32 s33, s33, 0xf01800
  v_mov_b32 v12, s33
  s_add_u32 s34, s31, 8
  s_add_u32 s34, s34, s32
  v_mov_b32 v13, s34
  s_waitcnt vmcnt(8)
  s_mov_b64 exec, 1
  buffer_store_dword v13, v12, s[4:7], 0 offen sc1
  s_mov_b64 exec, -1
  s_barrier
  s_add_u32 s33, s66, 0x0
  buffer_load_dwordx4 v[72:75], v4, s[40:43], s33 offen
  buffer_load_dwordx4 v[76:79], v5, s[40:43], s33 offen
  buffer_load_dwordx4 v[80:83], v6, s[40:43], s33 offen
  buffer_load_dwordx4 v[84:87], v7, s[40:43], s33 offen
  s_add_u32 s33, s66, 0x1c000
  buffer_load_dwordx4 v[88:91], v4, s[40:43], s33 offen
  buffer_load_dwordx4 v[92:95], v5, s[40:43], s33 offen
  buffer_load_dwordx4 v[96:99], v6, s[40:43], s33 offen
  buffer_load_dwordx4 v[100:103], v7, s[40:43], s33 offen
  s_add_u32 s33, s66, 0x38000
  buffer_load_dwordx4 v[104:107], v4, s[40:43], s33 offen
  buffer_load_dwordx4 v[108:111], v5, s[40:43], s33 offen
  buffer_load_dwordx4 v[112:115], v6, s[40:43], s33 offen
  buffer_load_dwordx4 v[116:119], v7, s[40:43], s33 offen
  s_add_u32 s33, s66, 0x54000
  buffer_load_dwordx4 v[120:123], v4, s[40:43], s33 offen
  buffer_load_dwordx4 v[124:127], v5, s[40:43], s33 offen
  buffer_load_dwordx4 v[128:131], v6, s[40:43], s33 offen
  buffer_load_dwordx4 v[132:135], v7, s[40:43], s33 offen
  s_add_u32 s33, s67, 0x0
  buffer_load_dwordx4 v[136:139], v4, s[40:43], s33 offen
  buffer_load_dwordx4 v[140:143], v5, s[40:43], s33 offen
  buffer_load_dwordx4 v[144:147], v6, s[40:43], s33 offen
  buffer_load_dwordx4 v[148:151], v7, s[40:43], s33 offen
  s_add_u32 s33, s67, 0x1c000
  buffer_load_dwordx4 v[152:155], v4, s[40:43], s33 offen
  buffer_load_dwordx4 v[156:159], v5, s[40:43], s33 offen
  buffer_load_dwordx4 v[160:163], v6, s[40:43], s33 offen
  buffer_load_dwordx4 v[164:167], v7, s[40:43], s33 offen
  s_add_u32 s33, s67, 0x38000
  buffer_load_dwordx4 v[168:171], v4, s[40:43], s33 offen
  buffer_load_dwordx4 v[172:175], v5, s[40:43], s33 offen
  buffer_load_dwordx4 v[176:179], v6, s[40:43], s33 offen
  buffer_load_dwordx4 v[180:183], v7, s[40:43], s33 offen
  s_add_u32 s33, s67, 0x54000
  buffer_load_dwordx4 v[184:187], v4, s[40:43], s33 offen
  buffer_load_dwordx4 v[188:191], v5, s[40:43], s33 offen
  buffer_load_dwordx4 v[192:195], v6, s[40:43], s33 offen
  buffer_load_dwordx4 v[196:199], v7, s[40:43], s33 offen
  s_barrier
  s_barrier
  s_barrier
  s_barrier
  s_barrier
  s_barrier
  s_barrier
  s_barrier
  s_barrier
  s_barrier
  s_barrier
  ds_write_b128 v9, v[208:211] offset:14336
  ds_write_b128 v9, v[212:215] offset:15360
  ds_write_b128 v9, v[16:19] offset:16384
  ds_write_b128 v9, v[20:23] offset:17408
  ds_write_b128 v9, v[24:27] offset:21504
  ds_write_b128 v9, v[28:31] offset:22528
  ds_write_b128 v9, v[32:35] offset:23552
  ds_write_b128 v9, v[36:39] offset:24576
  s_barrier
  s_waitcnt vmcnt(37)
  ds_write_b128 v9, v[40:43] offset:28672
  ds_write_b128 v9, v[44:47] offset:29696
  ds_write_b128 v9, v[48:51] offset:30720
  ds_write_b128 v9, v[52:55] offset:31744
  s_waitcnt vmcnt(33)
  ds_write_b128 v9, v[56:59] offset:35840
  ds_write_b128 v9, v[60:63] offset:36864
  ds_write_b128 v9, v[64:67] offset:37888
  ds_write_b128 v9, v[68:71] offset:38912
  s_barrier
  s_waitcnt vmcnt(28)
  ds_write_b128 v9, v[72:75] offset:43008
  ds_write_b128 v9, v[76:79] offset:44032
  ds_write_b128 v9, v[80:83] offset:45056
  ds_write_b128 v9, v[84:87] offset:46080
  s_waitcnt vmcnt(24)
  ds_write_b128 v9, v[88:91] offset:50176
  ds_write_b128 v9, v[92:95] offset:51200
  ds_write_b128 v9, v[96:99] offset:52224
  ds_write_b128 v9, v[100:103] offset:53248
  s_waitcnt vmcnt(20)
  ds_write_b128 v9, v[104:107] offset:57344
  ds_write_b128 v9, v[108:111] offset:58368
  ds_write_b128 v9, v[112:115] offset:59392
  ds_write_b128 v9, v[116:119] offset:60416
  s_waitcnt vmcnt(16)
  ds_write_b128 v9, v[120:123] offset:64512
  ds_write_b128 v10, v[124:127] offset:0
  ds_write_b128 v10, v[128:131] offset:1024
  ds_write_b128 v10, v[132:135] offset:2048
  s_waitcnt lgkmcnt(0)
  s_barrier
  s_barrier
  s_waitcnt vmcnt(12)
  ds_write_b128 v10, v[136:139] offset:6144
  ds_write_b128 v10, v[140:143] offset:7168
  ds_write_b128 v10, v[144:147] offset:8192
  ds_write_b128 v10, v[148:151] offset:9216
  s_waitcnt vmcnt(8)
  ds_write_b128 v10, v[152:155] offset:13312
  ds_write_b128 v10, v[156:159] offset:14336
  ds_write_b128 v10, v[160:163] offset:15360
  ds_write_b128 v10, v[164:167] offset:16384
  s_waitcnt vmcnt(4)
  ds_write_b128 v10, v[168:171] offset:20480
  ds_write_b128 v10, v[172:175] offset:21504
  ds_write_b128 v10, v[176:179] offset:22528
  ds_write_b128 v10, v[180:183] offset:23552
  s_waitcnt vmcnt(0)
  ds_write_b128 v9, v[184:187] offset:0
  ds_write_b128 v9, v[188:191] offset:1024
  ds_write_b128 v9, v[192:195] offset:2048
  ds_write_b128 v9, v[196:199] offset:3072
  s_waitcnt lgkmcnt(0)
  s_barrier
  s_barrier
  s_barrier
  s_barrier
  s_barrier
  s_barrier
  s_barrier
  s_barrier
  s_barrier
  s_barrier
  s_barrier
  s_barrier
  s_barrier
  s_barrier
  s_barrier
  s_barrier
  s_barrier
  s_waitcnt vmcnt(0) lgkmcnt(0)
  s_endpgm
L_PARKER7:
  s_mov_b32 s48, s66
  s_mov_b32 s49, s67
  s_mov_b32 s50, 0x180000
  s_mov_b32 s51, 0x20000
  s_mov_b32 s40, s76
  s_mov_b32 s41, s77
  s_mov_b32 s42, 0x1c0000
  s_mov_b32 s43, 0x20000
  s_mov_b32 s44, s78
  s_mov_b32 s45, s79
  s_mov_b32 s46, 0x1c0000
  s_mov_b32 s47, 0x20000
  v_lshlrev_b32 v1, 4, v0
  s_lshl_b32 s64, s25, 1
  s_and_b32 s64, s64, 3
  s_xor_b32 s64, s64, 0
  s_mul_i32 s64, s64, 458752
  s_lshl_b32 s65, s25, 1
  s_and_b32 s65, s65, 3
  s_xor_b32 s65, s65, 1
  s_mul_i32 s65, s65, 458752
  s_lshl_b32 s66, s25, 1
  s_and_b32 s66, s66, 3
  s_xor_b32 s66, s66, 2
  s_mul_i32 s66, s66, 458752
  s_lshl_b32 s67, s25, 1
  s_and_b32 s67, s67, 3
  s_xor_b32 s67, s67, 3
  s_mul_i32 s67, s67, 458752
  s_and_b32 s68, s23, 3
  s_lshl_b32 s68, s68, 1
  s_xor_b32 s68, s68, 0
  s_mul_i32 s68, s68, 229376
  s_and_b32 s69, s23, 3
  s_lshl_b32 s69, s69, 1
  s_xor_b32 s69, s69, 1
  s_mul_i32 s69, s69, 229376
  s_and_b32 s70, s23, 3
  s_lshl_b32 s70, s70, 1
  s_xor_b32 s70, s70, 2
  s_mul_i32 s70, s70, 229376
  s_and_b32 s71, s23, 3
  s_lshl_b32 s71, s71, 1
  s_xor_b32 s71, s71, 3
  s_mul_i32 s71, s71, 229376
  s_and_b32 s72, s23, 3
  s_lshl_b32 s72, s72, 1
  s_xor_b32 s72, s72, 4
  s_mul_i32 s72, s72, 229376
  s_and_b32 s73, s23, 3
  s_lshl_b32 s73, s73, 1
  s_xor_b32 s73, s73, 5
  s_mul_i32 s73, s73, 229376
  s_and_b32 s74, s23, 3
  s_lshl_b32 s74, s74, 1
  s_xor_b32 s74, s74, 6
  s_mul_i32 s74, s74, 229376
  s_and_b32 s75, s23, 3
  s_lshl_b32 s75, s75, 1
  s_xor_b32 s75, s75, 7
  s_mul_i32 s75, s75, 229376
  v_lshrrev_b32 v11, 3, v0
  v_bfe_u32 v12, v11, 1, 1
  v_lshlrev_b32 v12, 2, v12
  v_and_b32 v13, 7, v0
  v_xor_b32 v13, v13, v12
  v_lshlrev_b32 v2, 10, v11
  v_lshl_add_u32 v2, v13, 4, v2
  s_lshl_b32 s33, s24, 7
  v_add_u32 v2, s33, v2
  v_add_u32 v3, 0x1c00, v2
  s_mul_i32 s33, s26, 224
  s_mov_b32 s34, 0x12493
  v_add_u32 v11, 256, v0
  v_mul_lo_u32 v12, v11, s34
  v_lshrrev_b32 v12, 20, v12
  v_mul_u32_u24 v13, 14, v12
  v_sub_u32 v13, v11, v13
  v_mul_u32_u24 v4, 3584, v12
  v_lshl_add_u32 v4, v13, 4, v4
  v_add_u32 v4, s33, v4
  v_add_u32 v11, 320, v0
  v_mul_lo_u32 v12, v11, s34
  v_lshrrev_b32 v12, 20, v12
  v_mul_u32_u24 v13, 14, v12
  v_sub_u32 v13, v11, v13
  v_mul_u32_u24 v5, 3584, v12
  v_lshl_add_u32 v5, v13, 4, v5
  v_add_u32 v5, s33, v5
  v_add_u32 v11, 384, v0
  v_mul_lo_u32 v12, v11, s34
  v_lshrrev_b32 v12, 20, v12
  v_mul_u32_u24 v13, 14, v12
  v_sub_u32 v13, v11, v13
  v_mul_u32_u24 v6, 3584, v12
  v_lshl_add_u32 v6, v13, 4, v6
  v_add_u32 v6, s33, v6
  v_lshlrev_b32 v8, 4, v0
  v_add_u32 v9, 0x10000, v8
  v_add_u32 v10, 0x20000, v8
  s_waitcnt lgkmcnt(0)
  s_mul_i32 s31, s3, 0x9e3779b1
  s_add_u32 s31, s31, 0x7f4a7c15
  s_and_b32 s31, s31, 0xffffff00
  s_barrier
  s_barrier
  s_barrier
  s_mul_i32 s33, s20, 262144
  s_mul_i32 s34, s21, 8192
  s_add_u32 s33, s33, s34
  s_add_u32 s33, s33, 0x280000
  buffer_load_dwordx4 v[240:243], v8, s[4:7], s33 offen sc1
  s_add_u32 s33, s33, 1024
  buffer_load_dwordx4 v[244:247], v8, s[4:7], s33 offen sc1
  s_add_u32 s33, s33, 1024
  buffer_load_dwordx4 v[248:251], v8, s[4:7], s33 offen sc1
  s_add_u32 s33, s33, 1024
  buffer_load_dwordx4 v[252:255], v8, s[4:7], s33 offen sc1
  s_add_u32 s33, s33, 1024
  buffer_load_dwordx4 v[240:243], v8, s[4:7], s33 offen sc1
  s_add_u32 s33, s33, 1024
  buffer_load_dwordx4 v[244:247], v8, s[4:7], s33 offen sc1
  s_add_u32 s33, s33, 1024
  buffer_load_dwordx4 v[248:251], v8, s[4:7], s33 offen sc1
  s_add_u32 s33, s33, 1024
  buffer_load_dwordx4 v[252:255], v8, s[4:7], s33 offen sc1
  s_barrier
  s_barrier
  s_add_u32 s33, s65, 0x0
  buffer_load_dwordx4 v[16:19], v4, s[40:43], s33 offen
  buffer_load_dwordx4 v[20:23], v5, s[40:43], s33 offen
  buffer_load_dwordx4 v[24:27], v6, s[40:43], s33 offen
  s_add_u32 s33, s65, 0x1c000
  buffer_load_dwordx4 v[28:31], v4, s[40:43], s33 offen
  buffer_load_dwordx4 v[32:35], v5, s[40:43], s33 offen
  buffer_load_dwordx4 v[36:39], v6, s[40:43], s33 offen
  s_barrier
  v_lshlrev_b32 v11, 2, v0
  v_add_u32 v12, 0xc400, v11
  v_add_u32 v13, 0xe040, v11
  ds_read_b32 v216, v12 offset:0
  ds_read_b32 v217, v12 offset:256
  ds_read_b32 v218, v12 offset:512
  ds_read_b32 v219, v12 offset:768
  ds_read_b32 v220, v12 offset:2048
  ds_read_b32 v221, v12 offset:2304
  ds_read_b32 v222, v12 offset:2560
  ds_read_b32 v223, v12 offset:2816
  ds_read_b32 v224, v12 offset:4096
  ds_read_b32 v225, v12 offset:4352
  ds_read_b32 v226, v12 offset:4608
  ds_read_b32 v227, v12 offset:4864
  s_waitcnt lgkmcnt(4)
  ds_read_b32 v228, v12 offset:6144
  ds_read_b32 v229, v12 offset:6400
  ds_read_b32 v230, v12 offset:6656
  ds_read_b32 v231, v12 offset:6912
  ds_read_b32 v232, v13 offset:0
  ds_read_b32 v233, v13 offset:128
  ds_read_b32 v234, v13 offset:256
  ds_read_b32 v235, v13 offset:384
  s_mul_i32 s33, s26, 2176
  s_add_u32 s33, s33, 0xed0000
  s_add_u32 s34, s33, 1024
  s_add_u32 s35, s33, 2112
  s_waitcnt lgkmcnt(0)
  v_pk_add_f32 v[216:217], v[216:217], v[220:221]
  v_pk_add_f32 v[224:225], v[224:225], v[228:229]
  v_pk_add_f32 v[216:217], v[216:217], v[224:225]
  v_pk_add_f32 v[218:219], v[218:219], v[222:223]
  v_pk_add_f32 v[226:227], v[226:227], v[230:231]
  v_pk_add_f32 v[218:219], v[218:219], v[226:227]
  v_pk_add_f32 v[232:233], v[232:233], v[234:235]
  v_add_f32 v232, v232, v233
  buffer_atomic_add_f32 v216, v11, s[4:7], s34 offen offset:0
  buffer_atomic_add_f32 v217, v11, s[4:7], s34 offen offset:256
  buffer_atomic_add_f32 v218, v11, s[4:7], s34 offen offset:512
  buffer_atomic_add_f32 v219, v11, s[4:7], s34 offen offset:768
  s_mov_b64 exec, 0xffff
  buffer_atomic_add_f32 v232, v11, s[4:7], s35 offen
  s_mov_b64 exec, -1
  s_add_u32 s33, s65, 0x38000
  buffer_load_dwordx4 v[40:43], v4, s[40:43], s33 offen
  buffer_load_dwordx4 v[44:47], v5, s[40:43], s33 offen
  buffer_load_dwordx4 v[48:51], v6, s[40:43], s33 offen
  s_add_u32 s33, s65, 0x54000
  buffer_load_dwordx4 v[52:55], v4, s[40:43], s33 offen
  buffer_load_dwordx4 v[56:59], v5, s[40:43], s33 offen
  buffer_load_dwordx4 v[60:63], v6, s[40:43], s33 offen
  s_barrier
  s_barrier
  s_lshl_b32 s33, s26, 7
  s_lshl_b32 s34, s20, 3
  s_add_u32 s33, s33, s34
  s_lshl_b32 s34, s25, 2
  s_add_u32 s33, s33, s34
  s_add_u32 s33, s33, 0xf01040
  v_mov_b32 v12, s33
  s_add_u32 s34, s31, 8
  s_add_u32 s34, s34, s32
  v_mov_b32 v13, s34
  s_waitcnt vmcnt(6)
  s_mov_b64 exec, 1
  buffer_store_dword v13, v12, s[4:7], 0 offen sc1
  s_mov_b64 exec, -1
  s_barrier
  s_add_u32 s33, s66, 0x0
  buffer_load_dwordx4 v[64:67], v4, s[40:43], s33 offen
  buffer_load_dwordx4 v[68:71], v5, s[40:43], s33 offen
  buffer_load_dwordx4 v[72:75], v6, s[40:43], s33 offen
  s_add_u32 s33, s66, 0x1c000
  buffer_load_dwordx4 v[76:79], v4, s[40:43], s33 offen
  buffer_load_dwordx4 v[80:83], v5, s[40:43], s33 offen
  buffer_load_dwordx4 v[84:87], v6, s[40:43], s33 offen
  s_add_u32 s33, s66, 0x38000
  buffer_load_dwordx4 v[88:91], v4, s[40:43], s33 offen
  buffer_load_dwordx4 v[92:95], v5, s[40:43], s33 offen
  buffer_load_dwordx4 v[96:99], v6, s[40:43], s33 offen
  s_add_u32 s33, s66, 0x54000
  buffer_load_dwordx4 v[100:103], v4, s[40:43], s33 offen
  buffer_load_dwordx4 v[104:107], v5, s[40:43], s33 offen
  buffer_load_dwordx4 v[108:111], v6, s[40:43], s33 offen
  s_add_u32 s33, s67, 0x0
  buffer_load_dwordx4 v[112:115], v4, s[40:43], s33 offen
  buffer_load_dwordx4 v[116:119], v5, s[40:43], s33 offen
  buffer_load_dwordx4 v[120:123], v6, s[40:43], s33 offen
  s_add_u32 s33, s67, 0x1c000
  buffer_load_dwordx4 v[124:127], v4, s[40:43], s33 offen
  buffer_load_dwordx4 v[128:131], v5, s[40:43], s33 offen
  buffer_load_dwordx4 v[132:135], v6, s[40:43], s33 offen
  s_add_u32 s33, s67, 0x38000
  buffer_load_dwordx4 v[136:139], v4, s[40:43], s33 offen
  buffer_load_dwordx4 v[140:143], v5, s[40:43], s33 offen
  buffer_load_dwordx4 v[144:147], v6, s[40:43], s33 offen
  s_add_u32 s33, s67, 0x54000
  buffer_load_dwordx4 v[148:151], v4, s[40:43], s33 offen
  buffer_load_dwordx4 v[152:155], v5, s[40:43], s33 offen
  buffer_load_dwordx4 v[156:159], v6, s[40:43], s33 offen
  s_barrier
  s_barrier
  s_barrier
  s_barrier
  s_barrier
  s_barrier
  s_barrier
  s_barrier
  s_barrier
  s_barrier
  s_barrier
  ds_write_b128 v9, v[16:19] offset:18432
  ds_write_b128 v9, v[20:23] offset:19456
  ds_write_b128 v9, v[24:27] offset:20480
  ds_write_b128 v9, v[28:31] offset:25600
  ds_write_b128 v9, v[32:35] offset:26624
  ds_write_b128 v9, v[36:39] offset:27648
  s_mul_i32 s33, s20, 917504
  s_mul_i32 s34, s21, 28672
  s_add_u32 s33, s33, s34
  s_add_u32 s33, s33, 0x683800
  buffer_load_dwordx4 v[240:243], v8, s[4:7], s33 offen sc1
  s_add_u32 s33, s33, 1024
  buffer_load_dwordx4 v[244:247], v8, s[4:7], s33 offen sc1
  s_add_u32 s33, s33, 1024
  buffer_load_dwordx4 v[248:251], v8, s[4:7], s33 offen sc1
  s_add_u32 s33, s33, 1024
  buffer_load_dwordx4 v[252:255], v8, s[4:7], s33 offen sc1
  s_add_u32 s33, s33, 1024
  buffer_load_dwordx4 v[240:243], v8, s[4:7], s33 offen sc1
  s_add_u32 s33, s33, 1024
  buffer_load_dwordx4 v[244:247], v8, s[4:7], s33 offen sc1
  s_add_u32 s33, s33, 1024
  buffer_load_dwordx4 v[248:251], v8, s[4:7], s33 offen sc1
  s_add_u32 s33, s33, 1024
  buffer_load_dwordx4 v[252:255], v8, s[4:7], s33 offen sc1
  s_add_u32 s33, s33, 1024
  buffer_load_dwordx4 v[240:243], v8, s[4:7], s33 offen sc1
  s_add_u32 s33, s33, 1024
  buffer_load_dwordx4 v[244:247], v8, s[4:7], s33 offen sc1
  s_add_u32 s33, s33, 1024
  buffer_load_dwordx4 v[248:251], v8, s[4:7], s33 offen sc1
  s_add_u32 s33, s33, 1024
  buffer_load_dwordx4 v[252:255], v8, s[4:7], s33 offen sc1
  s_add_u32 s33, s33, 1024
  buffer_load_dwordx4 v[240:243], v8, s[4:7], s33 offen sc1
  s_add_u32 s33, s33, 1024
  buffer_load_dwordx4 v[244:247], v8, s[4:7], s33 offen sc1
  s_barrier
  s_waitcnt vmcnt(42)
  ds_write_b128 v9, v[40:43] offset:32768
  ds_write_b128 v9, v[44:47] offset:33792
  ds_write_b128 v9, v[48:51] offset:34816
  s_waitcnt vmcnt(39)
  ds_write_b128 v9, v[52:55] offset:39936
  ds_write_b128 v9, v[56:59] offset:40960
  ds_write_b128 v9, v[60:63] offset:41984
  s_barrier
  s_waitcnt vmcnt(35)
  ds_write_b128 v9, v[64:67] offset:47104
  ds_write_b128 v9, v[68:71] offset:48128
  ds_write_b128 v9, v[72:75] offset:49152
  s_waitcnt vmcnt(32)
  ds_write_b128 v9, v[76:79] offset:54272
  ds_write_b128 v9, v[80:83] offset:55296
  ds_write_b128 v9, v[84:87] offset:56320
  s_waitcnt vmcnt(29)
  ds_write_b128 v9, v[88:91] offset:61440
  ds_write_b128 v9, v[92:95] offset:62464
  ds_write_b128 v9, v[96:99] offset:63488
  s_waitcnt vmcnt(26)
  ds_write_b128 v10, v[100:103] offset:3072
  ds_write_b128 v10, v[104:107] offset:4096
  ds_write_b128 v10, v[108:111] offset:5120
  s_waitcnt lgkmcnt(0)
  s_barrier
  s_barrier
  s_waitcnt vmcnt(23)
  ds_write_b128 v10, v[112:115] offset:10240
  ds_write_b128 v10, v[116:119] offset:11264
  ds_write_b128 v10, v[120:123] offset:12288
  s_waitcnt vmcnt(20)
  ds_write_b128 v10, v[124:127] offset:17408
  ds_write_b128 v10, v[128:131] offset:18432
  ds_write_b128 v10, v[132:135] offset:19456
  s_waitcnt vmcnt(17)
  ds_write_b128 v10, v[136:139] offset:24576
  ds_write_b128 v10, v[140:143] offset:25600
  ds_write_b128 v10, v[144:147] offset:26624
  s_waitcnt vmcnt(14)
  ds_write_b128 v9, v[148:151] offset:4096
  ds_write_b128 v9, v[152:155] offset:5120
  ds_write_b128 v9, v[156:159] offset:6144
  s_waitcnt lgkmcnt(0)
  s_barrier
  s_mul_i32 s33, s20, 262144
  s_mul_i32 s34, s21, 8192
  s_add_u32 s33, s33, s34
  s_add_u32 s33, s33, 0x480000
  buffer_load_dwordx4 v[240:243], v8, s[4:7], s33 offen sc1
  s_add_u32 s33, s33, 1024
  buffer_load_dwordx4 v[244:247], v8, s[4:7], s33 offen sc1
  s_add_u32 s33, s33, 1024
  buffer_load_dwordx4 v[248:251], v8, s[4:7], s33 offen sc1
  s_add_u32 s33, s33, 1024
  buffer_load_dwordx4 v[252:255], v8, s[4:7], s33 offen sc1
  s_add_u32 s33, s33, 1024
  buffer_load_dwordx4 v[240:243], v8, s[4:7], s33 offen sc1
  s_add_u32 s33, s33, 1024
  buffer_load_dwordx4 v[244:247], v8, s[4:7], s33 offen sc1
  s_add_u32 s33, s33, 1024
  buffer_load_dwordx4 v[248:251], v8, s[4:7], s33 offen sc1
  s_add_u32 s33, s33, 1024
  buffer_load_dwordx4 v[252:255], v8, s[4:7], s33 offen sc1
  s_barrier
  s_barrier
  s_barrier
  s_barrier
  s_barrier
  s_barrier
  s_barrier
  s_barrier
  s_barrier
  s_barrier
  s_barrier
  s_barrier
  s_barrier
  s_barrier
  s_barrier
  s_barrier
  s_barrier
  s_barrier
  s_barrier
  s_barrier
  s_barrier
  s_add_u32 s33, s65, 0x0
  buffer_load_dwordx4 v[160:163], v4, s[40:43], s33 offen
  buffer_load_dwordx4 v[164:167], v5, s[40:43], s33 offen
  buffer_load_dwordx4 v[168:171], v6, s[40:43], s33 offen
  s_add_u32 s33, s65, 0x1c000
  buffer_load_dwordx4 v[172:175], v4, s[40:43], s33 offen
  buffer_load_dwordx4 v[176:179], v5, s[40:43], s33 offen
  buffer_load_dwordx4 v[180:183], v6, s[40:43], s33 offen
  s_barrier
  v_lshlrev_b32 v11, 2, v0
  v_add_u32 v12, 0xc400, v11
  v_add_u32 v13, 0xe040, v11
  ds_read_b32 v216, v12 offset:0
  ds_read_b32 v217, v12 offset:256
  ds_read_b32 v218, v12 offset:512
  ds_read_b32 v219, v12 offset:768
  ds_read_b32 v220, v12 offset:2048
  ds_read_b32 v221, v12 offset:2304
  ds_read_b32 v222, v12 offset:2560
  ds_read_b32 v223, v12 offset:2816
  ds_read_b32 v224, v12 offset:4096
  ds_read_b32 v225, v12 offset:4352
  ds_read_b32 v226, v12 offset:4608
  ds_read_b32 v227, v12 offset:4864
  s_waitcnt lgkmcnt(4)
  ds_read_b32 v228, v12 offset:6144
  ds_read_b32 v229, v12 offset:6400
  ds_read_b32 v230, v12 offset:6656
  ds_read_b32 v231, v12 offset:6912
  ds_read_b32 v232, v13 offset:0
  ds_read_b32 v233, v13 offset:128
  ds_read_b32 v234, v13 offset:256
  ds_read_b32 v235, v13 offset:384
  s_mul_i32 s33, s26, 2176
  s_add_u32 s33, s33, 0xed8800
  s_add_u32 s34, s33, 1024
  s_add_u32 s35, s33, 2112
  s_waitcnt lgkmcnt(0)
  v_pk_add_f32 v[216:217], v[216:217], v[220:221]
  v_pk_add_f32 v[224:225], v[224:225], v[228:229]
  v_pk_add_f32 v[216:217], v[216:217], v[224:225]
  v_pk_add_f32 v[218:219], v[218:219], v[222:223]
  v_pk_add_f32 v[226:227], v[226:227], v[230:231]
  v_pk_add_f32 v[218:219], v[218:219], v[226:227]
  v_pk_add_f32 v[232:233], v[232:233], v[234:235]
  v_add_f32 v232, v232, v233
  buffer_atomic_add_f32 v216, v11, s[4:7], s34 offen offset:0
  buffer_atomic_add_f32 v217, v11, s[4:7], s34 offen offset:256
  buffer_atomic_add_f32 v218, v11, s[4:7], s34 offen offset:512
  buffer_atomic_add_f32 v219, v11, s[4:7], s34 offen offset:768
  s_mov_b64 exec, 0xffff
  buffer_atomic_add_f32 v232, v11, s[4:7], s35 offen
  s_mov_b64 exec, -1
  s_add_u32 s33, s65, 0x38000
  buffer_load_dwordx4 v[184:187], v4, s[40:43], s33 offen
  buffer_load_dwordx4 v[188:191], v5, s[40:43], s33 offen
  buffer_load_dwordx4 v[192:195], v6, s[40:43], s33 offen
  s_add_u32 s33, s65, 0x54000
  buffer_load_dwordx4 v[196:199], v4, s[40:43], s33 offen
  buffer_load_dwordx4 v[200:203], v5, s[40:43], s33 offen
  buffer_load_dwordx4 v[204:207], v6, s[40:43], s33 offen
  s_barrier
  s_barrier
  s_lshl_b32 s33, s26, 7
  s_lshl_b32 s34, s20, 3
  s_add_u32 s33, s33, s34
  s_lshl_b32 s34, s25, 2
  s_add_u32 s33, s33, s34
  s_add_u32 s33, s33, 0xf01840
  v_mov_b32 v12, s33
  s_add_u32 s34, s31, 8
  s_add_u32 s34, s34, s32
  v_mov_b32 v13, s34
  s_waitcnt vmcnt(6)
  s_mov_b64 exec, 1
  buffer_store_dword v13, v12, s[4:7], 0 offen sc1
  s_mov_b64 exec, -1
  s_barrier
  s_add_u32 s33, s66, 0x0
  buffer_load_dwordx4 v[208:211], v4, s[40:43], s33 offen
  buffer_load_dwordx4 v[212:215], v5, s[40:43], s33 offen
  buffer_load_dwordx4 v[16:19], v6, s[40:43], s33 offen
  s_add_u32 s33, s66, 0x1c000
  buffer_load_dwordx4 v[20:23], v4, s[40:43], s33 offen
  buffer_load_dwordx4 v[24:27], v5, s[40:43], s33 offen
  buffer_load_dwordx4 v[28:31], v6, s[40:43], s33 offen
  s_add_u32 s33, s66, 0x38000
  buffer_load_dwordx4 v[32:35], v4, s[40:43], s33 offen
  buffer_load_dwordx4 v[36:39], v5, s[40:43], s33 offen
  buffer_load_dwordx4 v[40:43], v6, s[40:43], s33 offen
  s_add_u32 s33, s66, 0x54000
  buffer_load_dwordx4 v[44:47], v4, s[40:43], s33 offen
  buffer_load_dwordx4 v[48:51], v5, s[40:43], s33 offen
  buffer_load_dwordx4 v[52:55], v6, s[40:43], s33 offen
  s_add_u32 s33, s67, 0x0
  buffer_load_dwordx4 v[56:59], v4, s[40:43], s33 offen
  buffer_load_dwordx4 v[60:63], v5, s[40:43], s33 offen
  buffer_load_dwordx4 v[64:67], v6, s[40:43], s33 offen
  s_add_u32 s33, s67, 0x1c000
  buffer_load_dwordx4 v[68:71], v4, s[40:43], s33 offen
  buffer_load_dwordx4 v[72:75], v5, s[40:43], s33 offen
  buffer_load_dwordx4 v[76:79], v6, s[40:43], s33 offen
  s_add_u32 s33, s67, 0x38000
  buffer_load_dwordx4 v[80:83], v4, s[40:43], s33 offen
  buffer_load_dwordx4 v[84:87], v5, s[40:43], s33 offen
  buffer_load_dwordx4 v[88:91], v6, s[40:43], s33 offen
  s_add_u32 s33, s67, 0x54000
  buffer_load_dwordx4 v[92:95], v4, s[40:43], s33 offen
  buffer_load_dwordx4 v[96:99], v5, s[40:43], s33 offen
  buffer_load_dwordx4 v[100:103], v6, s[40:43], s33 offen
  s_barrier
  s_barrier
  s_barrier
  s_barrier
  s_barrier
  s_barrier
  s_barrier
  s_barrier
  s_barrier
  s_barrier
  s_barrier
  ds_write_b128 v9, v[160:163] offset:18432
  ds_write_b128 v9, v[164:167] offset:19456
  ds_write_b128 v9, v[168:171] offset:20480
  ds_write_b128 v9, v[172:175] offset:25600
  ds_write_b128 v9, v[176:179] offset:26624
  ds_write_b128 v9, v[180:183] offset:27648
  s_barrier
  s_waitcnt vmcnt(28)
  ds_write_b128 v9, v[184:187] offset:32768
  ds_write_b128 v9, v[188:191] offset:33792
  ds_write_b128 v9, v[192:195] offset:34816
  s_waitcnt vmcnt(25)
  ds_write_b128 v9, v[196:199] offset:39936
  ds_write_b128 v9, v[200:203] offset:40960
  ds_write_b128 v9, v[204:207] offset:41984
  s_barrier
  s_waitcnt vmcnt(21)
  ds_write_b128 v9, v[208:211] offset:47104
  ds_write_b128 v9, v[212:215] offset:48128
  ds_write_b128 v9, v[16:19] offset:49152
  s_waitcnt vmcnt(18)
  ds_write_b128 v9, v[20:23] offset:54272
  ds_write_b128 v9, v[24:27] offset:55296
  ds_write_b128 v9, v[28:31] offset:56320
  s_waitcnt vmcnt(15)
  ds_write_b128 v9, v[32:35] offset:61440
  ds_write_b128 v9, v[36:39] offset:62464
  ds_write_b128 v9, v[40:43] offset:63488
  s_waitcnt vmcnt(12)
  ds_write_b128 v10, v[44:47] offset:3072
  ds_write_b128 v10, v[48:51] offset:4096
  ds_write_b128 v10, v[52:55] offset:5120
  s_waitcnt lgkmcnt(0)
  s_barrier
  s_barrier
  s_waitcnt vmcnt(9)
  ds_write_b128 v10, v[56:59] offset:10240
  ds_write_b128 v10, v[60:63] offset:11264
  ds_write_b128 v10, v[64:67] offset:12288
  s_waitcnt vmcnt(6)
  ds_write_b128 v10, v[68:71] offset:17408
  ds_write_b128 v10, v[72:75] offset:18432
  ds_write_b128 v10, v[76:79] offset:19456
  s_waitcnt vmcnt(3)
  ds_write_b128 v10, v[80:83] offset:24576
  ds_write_b128 v10, v[84:87] offset:25600
  ds_write_b128 v10, v[88:91] offset:26624
  s_waitcnt vmcnt(0)
  ds_write_b128 v9, v[92:95] offset:4096
  ds_write_b128 v9, v[96:99] offset:5120
  ds_write_b128 v9, v[100:103] offset:6144
  s_waitcnt lgkmcnt(0)
  s_barrier
  s_barrier
  s_barrier
  s_barrier
  s_barrier
  s_barrier
  s_barrier
  s_barrier
  s_barrier
  s_barrier
  s_barrier
  s_barrier
  s_barrier
  s_barrier
  s_barrier
  s_barrier
  s_barrier
  s_waitcnt vmcnt(0) lgkmcnt(0)
  s_endpgm
L_CODE_END:
.section .rodata,"a"
.p2align 6
.amdhsa_kernel interleave_layers__linear_attn_block__mixer_s_mlp__prompt_kernel
  .amdhsa_next_free_vgpr 256
  .amdhsa_next_free_sgpr 102
  .amdhsa_accum_offset 256
  .amdhsa_group_segment_fixed_size 0
  .amdhsa_kernarg_size 88
  .amdhsa_user_sgpr_count 2
  .amdhsa_user_sgpr_kernarg_segment_ptr 1
  .amdhsa_system_sgpr_workgroup_id_x 1
.end_amdhsa_kernel
```
